```python
import torch

def _softmax(x, axis=-1):
    return torch.softmax(x, dim=axis)
def _gelu(x):
    return torch.nn.functional.gelu(x, approximate="tanh")
def _silu(x):
    return torch.nn.functional.silu(x)
def _sigmoid(x):
    return torch.sigmoid(x)
def _layernorm(x, axis=-1, eps=1e-5):
    m = x.mean(dim=axis, keepdim=True)
    v = x.var(dim=axis, keepdim=True, unbiased=False)
    return (x - m) / torch.sqrt(v + eps)
def _scatter_add(tgt, idx, src, axis=0):
    return tgt.clone().index_add_(axis, idx, src)
def _segment_sum(src, seg, n):
    out = torch.zeros((n,) + src.shape[1:], dtype=src.dtype)
    return out.index_add_(0, seg, src)
def _pad(x, pw):
    flat = tuple(v for pair in reversed(pw) for v in pair)
    return torch.nn.functional.pad(x, flat)

kernel_name = 'sequential_preLN__spectral_gfnet__mixer_channel_mlp__prompt'

def setup_inputs():

    _w = (lambda a: (lambda t: t.to(torch.bfloat16) if t.is_floating_point() else t)(torch.as_tensor(a)))
    def _A_setup():
        B, S, D = 1, 2048, 640
        Df = D // 2 + 1
        return {
            "x": _w((lambda *s: torch.randn(*s, dtype=torch.bfloat16) * 0.05)(B, S, D)),
            "w_r": _w((lambda *s: torch.randn(*s, dtype=torch.bfloat16) * 0.8)(S, Df) * 0.02),
            "w_i": _w((lambda *s: torch.randn(*s, dtype=torch.bfloat16) * 0.8)(S, Df) * 0.02),
        }
    _A_in = _A_setup()

    def _B_setup():
        B, S, D, F = 1, 2048, 640, 1536
        return {
            "x": _w((lambda *s: torch.randn(*s, dtype=torch.bfloat16) * 0.05)(B, S, D)),
            "w1": _w((lambda *s: torch.randn(*s, dtype=torch.bfloat16) * 0.8)(D, F) * (D ** -0.5)),
            "b1": _w((lambda *s: torch.randn(*s, dtype=torch.bfloat16) * 0.4)(F)),
            "w2": _w((lambda *s: torch.randn(*s, dtype=torch.bfloat16) * 0.05)(F, D) * (F ** -0.5)),
            "b2": _w((lambda *s: torch.randn(*s, dtype=torch.bfloat16) * 0.05)(D)),
        }
    _B_in = _B_setup()

    return {
        "A_x": _A_in["x"],
        "A_w_r": _A_in["w_r"],
        "A_w_i": _A_in["w_i"],
        "B_x": _B_in["x"],
        "B_w1": _B_in["w1"],
        "B_b1": _B_in["b1"],
        "B_w2": _B_in["w2"],
        "B_b2": _B_in["b2"],
    }

def reference(A_x, A_w_r, A_w_i, B_x, B_w1, B_b1, B_w2, B_b2):
    def _A_ref(x, w_r, w_i):
        B, S, D = x.shape
        X = (lambda x, axes=(-2,-1): torch.fft.rfft2(x.float(), dim=axes))(x, axes=(-2, -1))
        W = w_r + 1j * w_i
        X = X * W
        y = (lambda x, s, axes=(-2,-1): torch.fft.irfft2(x, s=s, dim=axes).to(torch.bfloat16))(X, (S, D), axes=(-2, -1))
        return y

    def _B_ref(x, w1, b1, w2, b2):
        y = _layernorm(x, axis=-1)
        h = _gelu(torch.einsum("bsd,df->bsf", y, w1) + b1)
        return torch.einsum("bsf,fd->bsd", h, w2) + b2

    x = A_x
    h = x + _A_ref(_layernorm(x, axis=-1), A_w_r, A_w_i)
    h2 = h + _B_ref(_layernorm(h, axis=-1), B_w1, B_b1, B_w2, B_b2)
    return h2
```

```asm
; @launch grid=(256,1,1) block=(256,1,1) lds=163840
.amdgcn_target "amdgcn-amd-amdhsa--gfx950"
.text
.globl sequential_preLN__spectral_gfnet__mixer_channel_mlp__prompt_kernel
.p2align 8
.type sequential_preLN__spectral_gfnet__mixer_channel_mlp__prompt_kernel,@function
sequential_preLN__spectral_gfnet__mixer_channel_mlp__prompt_kernel:
    s_cmp_ge_u32 s2, 256
    s_cbranch_scc1 kf_exit
    s_add_u32 s2, s2, 240
    s_and_b32 s2, s2, 255
    s_load_dwordx4 s[4:7], s[0:1], 0
    s_load_dwordx2 s[8:9], s[0:1], 16
    s_load_dwordx8 s[52:59], s[0:1], 32
    s_load_dwordx4 s[60:63], s[0:1], 64
    s_load_dwordx2 s[14:15], s[0:1], 80
    s_memrealtime s[94:95]
    v_lshrrev_b32 v2, 6, v0
    v_and_b32_e64 v1, 63, v0
    v_readfirstlane_b32 s28, v2
    s_and_b32 s29, s2, 7
    s_lshl_b32 s29, s29, 2
    s_bfe_u32 s32, s2, 0x20003
    s_add_u32 s29, s29, s32
    s_lshr_b32 s30, s2, 5
    s_mov_b32 s50, 1048576
    s_getpc_b64 s[32:33]
kf_pc:
    s_lshr_b32 s34, s2, 3
    s_lshl_b32 s34, s34, 11
    v_and_b32 v2, 127, v0
    v_lshl_add_u32 v2, v2, 4, s34
    s_mov_b32 s35, kf_last-kf_pc-16
    v_min_u32 v2, s35, v2
    v_and_b32 v2, -16, v2
    v_mov_b32 v3, s33
    v_add_co_u32 v2, vcc, s32, v2
    s_nop 1
    v_addc_co_u32 v3, vcc, 0, v3, vcc
    global_load_dwordx4 v[240:243], v[2:3], off
    s_cmp_ge_u32 s2, 160
    s_cbranch_scc1 kf_notx
    s_lshr_b32 s32, s29, 2
    s_lshl_b32 s32, s32, 8
    s_and_b32 s33, s29, 3
    s_lshl_b32 s33, s33, 3
    s_add_u32 s32, s32, s33
    s_lshl_b32 s33, s28, 5
    s_add_u32 s32, s32, s33
    v_lshrrev_b32 v2, 3, v1
    v_add_u32 v5, s32, v2
    v_mul_u32_u24 v5, 1280, v5
    v_bfe_u32 v3, v1, 4, 1
    s_lshl_b32 s33, s28, 1
    v_or_b32_e64 v3, s33, v3
    v_and_b32 v4, 7, v1
    v_xor_b32 v3, v3, v4
    v_lshl_add_u32 v17, v3, 4, v5
    v_add_u32 v19, 163840, v17
    s_lshl_b32 s41, s28, 10
    s_lshl_b32 s43, s30, 7
    s_mov_b32 s42, s43
    s_add_u32 s44, s43, 640
    s_waitcnt lgkmcnt(0)
    s_mov_b32 s16, s4
    s_and_b32 s17, s5, 0xffff
    s_mov_b32 s18, 2621440
    s_mov_b32 s19, 0x20000
    s_add_u32 m0, s41, 0
    s_nop 0
    buffer_load_dwordx4 v17, s[16:19], s42 offen  lds
    s_add_u32 m0, s41, 4096
    s_nop 0
    buffer_load_dwordx4 v19, s[16:19], s42 offen  lds
    s_add_u32 m0, s41, 40960
    s_nop 0
    buffer_load_dwordx4 v17, s[16:19], s44 offen  lds
    s_add_u32 m0, s41, 45056
    s_nop 0
    buffer_load_dwordx4 v19, s[16:19], s44 offen  lds
    s_lshl_b32 s31, s30, 6
    s_add_u32 s32, s31, s28
    s_add_u32 s32, s32, 1
    v_and_b32 v2, 15, v1
    v_lshl_add_u32 v2, v2, 2, s32
    v_cvt_f32_u32 v2, v2
    v_mul_f32 v2, 0x3acccccd, v2
    v_lshrrev_b32 v3, 4, v1
    v_lshl_add_u32 v3, v3, 3, s31
    v_cvt_f32_u32 v3, v3
    v_mul_f32 v3, v3, v2
    v_cos_f32 v120, v2
    v_sin_f32_e64 v121, -v2
    v_fmamk_f32 v4, v2, 0x00000000, v3
    v_cos_f32_e64 v100, v4
    v_sin_f32_e64 v101, -v4
    v_fmamk_f32 v5, v2, 0x42000000, v3
    v_cos_f32_e64 v104, v5
    v_sin_f32_e64 v105, -v5
    v_fmamk_f32 v4, v2, 0x42800000, v3
    v_cos_f32_e64 v108, v4
    v_sin_f32_e64 v109, -v4
    v_fmamk_f32 v5, v2, 0x42c00000, v3
    v_cos_f32_e64 v112, v5
    v_sin_f32_e64 v113, -v5
    v_fmamk_f32 v4, v2, 0x43000000, v3
    v_cos_f32 v116, v4
    v_sin_f32_e64 v117, -v4
    s_mov_b32 s20, s14
    s_and_b32 s21, s15, 0xffff
    s_mov_b32 s22, 19398656
    s_mov_b32 s23, 0x20000
    s_mov_b32 s24, s6
    s_and_b32 s25, s7, 0xffff
    s_mov_b32 s26, 1314816
    s_mov_b32 s27, 0x20000
    s_mov_b32 s4, s8
    s_and_b32 s5, s9, 0xffff
    s_mov_b32 s6, 1314816
    s_mov_b32 s7, 0x20000
    s_or_b32 s32, s2, s28
    s_cmp_lg_u32 s32, 0
    s_cbranch_scc1 kf_nononce
    s_or_b32 s12, s94, 1
    v_mov_b32 v2, s12
    v_mov_b32 v3, s95
    v_mov_b32_e64 v4, 0
    global_store_dwordx2 v4, v[2:3], s[62:63] sc1
kf_nononce:
    v_pk_mul_f32 v[102:103], v[100:101], v[120:121] op_sel_hi:[1,0]
    s_add_u32 m0, s41, 8192
    s_add_u32 s42, s42, 128
    buffer_load_dwordx4 v17, s[16:19], s42 offen  lds
    v_pk_mul_f32 v[106:107], v[104:105], v[120:121] op_sel_hi:[1,0]
    v_pk_mul_f32 v[110:111], v[108:109], v[120:121] op_sel_hi:[1,0]
    v_pk_mul_f32 v[114:115], v[112:113], v[120:121] op_sel_hi:[1,0]
    v_pk_mul_f32 v[118:119], v[116:117], v[120:121] op_sel_hi:[1,0]
    v_pk_fma_f32 v[102:103], v[100:101], v[120:121], v[102:103] op_sel:[1,1,0] op_sel_hi:[0,1,1] neg_lo:[1,0,0]
    v_pk_fma_f32 v[106:107], v[104:105], v[120:121], v[106:107] op_sel:[1,1,0] op_sel_hi:[0,1,1] neg_lo:[1,0,0]
    v_pk_fma_f32 v[110:111], v[108:109], v[120:121], v[110:111] op_sel:[1,1,0] op_sel_hi:[0,1,1] neg_lo:[1,0,0]
    v_pk_fma_f32 v[114:115], v[112:113], v[120:121], v[114:115] op_sel:[1,1,0] op_sel_hi:[0,1,1] neg_lo:[1,0,0]
    v_pk_fma_f32 v[118:119], v[116:117], v[120:121], v[118:119] op_sel:[1,1,0] op_sel_hi:[0,1,1] neg_lo:[1,0,0]
    v_cvt_pk_bf16_f32 v20, v100, v102
    v_cvt_pk_bf16_f32 v24, v101, v103
    s_add_u32 m0, s41, 12288
    s_nop 0
    buffer_load_dwordx4 v19, s[16:19], s42 offen  lds
    v_cvt_pk_bf16_f32 v28, v104, v106
    v_cvt_pk_bf16_f32 v32, v105, v107
    v_cvt_pk_bf16_f32 v36, v108, v110
    v_cvt_pk_bf16_f32 v40, v109, v111
    v_cvt_pk_bf16_f32 v44, v112, v114
    v_cvt_pk_bf16_f32 v48, v113, v115
    v_cvt_pk_bf16_f32 v52, v116, v118
    v_cvt_pk_bf16_f32 v56, v117, v119
    v_pk_mul_f32 v[100:101], v[102:103], v[120:121] op_sel_hi:[1,0]
    v_pk_mul_f32 v[104:105], v[106:107], v[120:121] op_sel_hi:[1,0]
    v_pk_mul_f32 v[108:109], v[110:111], v[120:121] op_sel_hi:[1,0]
    s_add_u32 m0, s41, 49152
    s_add_u32 s44, s44, 128
    s_cmp_eq_u32 s44, 1280
    s_cselect_b32 s44, 0, s44
    buffer_load_dwordx4 v17, s[16:19], s44 offen  lds
    v_pk_mul_f32 v[112:113], v[114:115], v[120:121] op_sel_hi:[1,0]
    v_pk_mul_f32 v[116:117], v[118:119], v[120:121] op_sel_hi:[1,0]
    v_pk_fma_f32 v[100:101], v[102:103], v[120:121], v[100:101] op_sel:[1,1,0] op_sel_hi:[0,1,1] neg_lo:[1,0,0]
    v_pk_fma_f32 v[104:105], v[106:107], v[120:121], v[104:105] op_sel:[1,1,0] op_sel_hi:[0,1,1] neg_lo:[1,0,0]
    v_pk_fma_f32 v[108:109], v[110:111], v[120:121], v[108:109] op_sel:[1,1,0] op_sel_hi:[0,1,1] neg_lo:[1,0,0]
    v_pk_fma_f32 v[112:113], v[114:115], v[120:121], v[112:113] op_sel:[1,1,0] op_sel_hi:[0,1,1] neg_lo:[1,0,0]
    v_pk_fma_f32 v[116:117], v[118:119], v[120:121], v[116:117] op_sel:[1,1,0] op_sel_hi:[0,1,1] neg_lo:[1,0,0]
    v_pk_mul_f32 v[102:103], v[100:101], v[120:121] op_sel_hi:[1,0]
    v_pk_mul_f32 v[106:107], v[104:105], v[120:121] op_sel_hi:[1,0]
    v_pk_mul_f32 v[110:111], v[108:109], v[120:121] op_sel_hi:[1,0]
    v_pk_mul_f32 v[114:115], v[112:113], v[120:121] op_sel_hi:[1,0]
    s_add_u32 m0, s41, 53248
    s_nop 0
    buffer_load_dwordx4 v19, s[16:19], s44 offen  lds
    v_pk_mul_f32 v[118:119], v[116:117], v[120:121] op_sel_hi:[1,0]
    v_pk_fma_f32 v[102:103], v[100:101], v[120:121], v[102:103] op_sel:[1,1,0] op_sel_hi:[0,1,1] neg_lo:[1,0,0]
    v_pk_fma_f32 v[106:107], v[104:105], v[120:121], v[106:107] op_sel:[1,1,0] op_sel_hi:[0,1,1] neg_lo:[1,0,0]
    v_pk_fma_f32 v[110:111], v[108:109], v[120:121], v[110:111] op_sel:[1,1,0] op_sel_hi:[0,1,1] neg_lo:[1,0,0]
    v_pk_fma_f32 v[114:115], v[112:113], v[120:121], v[114:115] op_sel:[1,1,0] op_sel_hi:[0,1,1] neg_lo:[1,0,0]
    v_pk_fma_f32 v[118:119], v[116:117], v[120:121], v[118:119] op_sel:[1,1,0] op_sel_hi:[0,1,1] neg_lo:[1,0,0]
    v_cvt_pk_bf16_f32 v21, v100, v102
    v_cvt_pk_bf16_f32 v25, v101, v103
    v_cvt_pk_bf16_f32 v29, v104, v106
    v_cvt_pk_bf16_f32 v33, v105, v107
    v_cvt_pk_bf16_f32 v37, v108, v110
    s_add_u32 m0, s41, 16384
    s_add_u32 s42, s42, 128
    buffer_load_dwordx4 v17, s[16:19], s42 offen  lds
    v_cvt_pk_bf16_f32 v41, v109, v111
    v_cvt_pk_bf16_f32 v45, v112, v114
    v_cvt_pk_bf16_f32 v49, v113, v115
    v_cvt_pk_bf16_f32 v53, v116, v118
    v_cvt_pk_bf16_f32 v57, v117, v119
    v_pk_mul_f32 v[100:101], v[102:103], v[120:121] op_sel_hi:[1,0]
    v_pk_mul_f32 v[104:105], v[106:107], v[120:121] op_sel_hi:[1,0]
    v_pk_mul_f32 v[108:109], v[110:111], v[120:121] op_sel_hi:[1,0]
    v_pk_mul_f32 v[112:113], v[114:115], v[120:121] op_sel_hi:[1,0]
    v_pk_mul_f32 v[116:117], v[118:119], v[120:121] op_sel_hi:[1,0]
    v_pk_fma_f32 v[100:101], v[102:103], v[120:121], v[100:101] op_sel:[1,1,0] op_sel_hi:[0,1,1] neg_lo:[1,0,0]
    s_add_u32 m0, s41, 20480
    s_nop 0
    buffer_load_dwordx4 v19, s[16:19], s42 offen  lds
    v_pk_fma_f32 v[104:105], v[106:107], v[120:121], v[104:105] op_sel:[1,1,0] op_sel_hi:[0,1,1] neg_lo:[1,0,0]
    v_pk_fma_f32 v[108:109], v[110:111], v[120:121], v[108:109] op_sel:[1,1,0] op_sel_hi:[0,1,1] neg_lo:[1,0,0]
    v_pk_fma_f32 v[112:113], v[114:115], v[120:121], v[112:113] op_sel:[1,1,0] op_sel_hi:[0,1,1] neg_lo:[1,0,0]
    v_pk_fma_f32 v[116:117], v[118:119], v[120:121], v[116:117] op_sel:[1,1,0] op_sel_hi:[0,1,1] neg_lo:[1,0,0]
    v_pk_mul_f32 v[102:103], v[100:101], v[120:121] op_sel_hi:[1,0]
    v_pk_mul_f32 v[106:107], v[104:105], v[120:121] op_sel_hi:[1,0]
    v_pk_mul_f32 v[110:111], v[108:109], v[120:121] op_sel_hi:[1,0]
    v_pk_mul_f32 v[114:115], v[112:113], v[120:121] op_sel_hi:[1,0]
    v_pk_mul_f32 v[118:119], v[116:117], v[120:121] op_sel_hi:[1,0]
    v_pk_fma_f32 v[102:103], v[100:101], v[120:121], v[102:103] op_sel:[1,1,0] op_sel_hi:[0,1,1] neg_lo:[1,0,0]
    v_pk_fma_f32 v[106:107], v[104:105], v[120:121], v[106:107] op_sel:[1,1,0] op_sel_hi:[0,1,1] neg_lo:[1,0,0]
    s_add_u32 m0, s41, 57344
    s_add_u32 s44, s44, 128
    s_cmp_eq_u32 s44, 1280
    s_cselect_b32 s44, 0, s44
    buffer_load_dwordx4 v17, s[16:19], s44 offen  lds
    v_pk_fma_f32 v[110:111], v[108:109], v[120:121], v[110:111] op_sel:[1,1,0] op_sel_hi:[0,1,1] neg_lo:[1,0,0]
    v_pk_fma_f32 v[114:115], v[112:113], v[120:121], v[114:115] op_sel:[1,1,0] op_sel_hi:[0,1,1] neg_lo:[1,0,0]
    v_pk_fma_f32 v[118:119], v[116:117], v[120:121], v[118:119] op_sel:[1,1,0] op_sel_hi:[0,1,1] neg_lo:[1,0,0]
    v_cvt_pk_bf16_f32 v22, v100, v102
    v_cvt_pk_bf16_f32 v26, v101, v103
    v_cvt_pk_bf16_f32 v30, v104, v106
    v_cvt_pk_bf16_f32 v34, v105, v107
    v_cvt_pk_bf16_f32 v38, v108, v110
    v_cvt_pk_bf16_f32 v42, v109, v111
    v_cvt_pk_bf16_f32 v46, v112, v114
    v_cvt_pk_bf16_f32 v50, v113, v115
    s_add_u32 m0, s41, 61440
    s_nop 0
    buffer_load_dwordx4 v19, s[16:19], s44 offen  lds
    v_cvt_pk_bf16_f32 v54, v116, v118
    v_cvt_pk_bf16_f32 v58, v117, v119
    v_pk_mul_f32 v[100:101], v[102:103], v[120:121] op_sel_hi:[1,0]
    v_pk_mul_f32 v[104:105], v[106:107], v[120:121] op_sel_hi:[1,0]
    v_pk_mul_f32 v[108:109], v[110:111], v[120:121] op_sel_hi:[1,0]
    v_pk_mul_f32 v[112:113], v[114:115], v[120:121] op_sel_hi:[1,0]
    v_pk_mul_f32 v[116:117], v[118:119], v[120:121] op_sel_hi:[1,0]
    v_pk_fma_f32 v[100:101], v[102:103], v[120:121], v[100:101] op_sel:[1,1,0] op_sel_hi:[0,1,1] neg_lo:[1,0,0]
    v_pk_fma_f32 v[104:105], v[106:107], v[120:121], v[104:105] op_sel:[1,1,0] op_sel_hi:[0,1,1] neg_lo:[1,0,0]
    v_pk_fma_f32 v[108:109], v[110:111], v[120:121], v[108:109] op_sel:[1,1,0] op_sel_hi:[0,1,1] neg_lo:[1,0,0]
    v_pk_fma_f32 v[112:113], v[114:115], v[120:121], v[112:113] op_sel:[1,1,0] op_sel_hi:[0,1,1] neg_lo:[1,0,0]
    s_add_u32 m0, s41, 24576
    s_add_u32 s42, s42, 128
    buffer_load_dwordx4 v17, s[16:19], s42 offen  lds
    v_pk_fma_f32 v[116:117], v[118:119], v[120:121], v[116:117] op_sel:[1,1,0] op_sel_hi:[0,1,1] neg_lo:[1,0,0]
    v_pk_mul_f32 v[102:103], v[100:101], v[120:121] op_sel_hi:[1,0]
    v_pk_mul_f32 v[106:107], v[104:105], v[120:121] op_sel_hi:[1,0]
    v_pk_mul_f32 v[110:111], v[108:109], v[120:121] op_sel_hi:[1,0]
    v_pk_mul_f32 v[114:115], v[112:113], v[120:121] op_sel_hi:[1,0]
    v_pk_mul_f32 v[118:119], v[116:117], v[120:121] op_sel_hi:[1,0]
    v_pk_fma_f32 v[102:103], v[100:101], v[120:121], v[102:103] op_sel:[1,1,0] op_sel_hi:[0,1,1] neg_lo:[1,0,0]
    v_pk_fma_f32 v[106:107], v[104:105], v[120:121], v[106:107] op_sel:[1,1,0] op_sel_hi:[0,1,1] neg_lo:[1,0,0]
    v_pk_fma_f32 v[110:111], v[108:109], v[120:121], v[110:111] op_sel:[1,1,0] op_sel_hi:[0,1,1] neg_lo:[1,0,0]
    v_pk_fma_f32 v[114:115], v[112:113], v[120:121], v[114:115] op_sel:[1,1,0] op_sel_hi:[0,1,1] neg_lo:[1,0,0]
    v_pk_fma_f32 v[118:119], v[116:117], v[120:121], v[118:119] op_sel:[1,1,0] op_sel_hi:[0,1,1] neg_lo:[1,0,0]
    s_add_u32 m0, s41, 28672
    s_nop 0
    buffer_load_dwordx4 v19, s[16:19], s42 offen  lds
    v_cvt_pk_bf16_f32 v23, v100, v102
    v_cvt_pk_bf16_f32 v27, v101, v103
    v_cvt_pk_bf16_f32 v31, v104, v106
    v_cvt_pk_bf16_f32 v35, v105, v107
    v_cvt_pk_bf16_f32 v39, v108, v110
    v_cvt_pk_bf16_f32 v43, v109, v111
    v_cvt_pk_bf16_f32 v47, v112, v114
    v_cvt_pk_bf16_f32 v51, v113, v115
    v_cvt_pk_bf16_f32 v55, v116, v118
    v_cvt_pk_bf16_f32 v59, v117, v119
    s_lshl_b32 s32, s30, 2
    s_add_u32 s32, s32, s28
    s_cmp_eq_u32 s32, 19
    s_cbranch_scc0 kx_nofix
    v_and_b32_e64 v2, 15, v1
    v_cmp_eq_u32 vcc, 15, v2
    v_mov_b32 v3, 0xbf353f35
    v_mov_b32 v4, 0
    v_cndmask_b32 v20, v20, v3, vcc
    v_cndmask_b32 v24, v24, v4, vcc
    v_cndmask_b32 v21, v21, v3, vcc
    v_cndmask_b32 v25, v25, v4, vcc
    v_cndmask_b32 v22, v22, v3, vcc
    v_cndmask_b32 v26, v26, v4, vcc
    v_cndmask_b32 v23, v23, v3, vcc
    v_cndmask_b32 v27, v27, v4, vcc
    v_cndmask_b32 v28, v28, v3, vcc
    v_cndmask_b32 v32, v32, v4, vcc
    v_cndmask_b32 v29, v29, v3, vcc
    v_cndmask_b32 v33, v33, v4, vcc
    v_cndmask_b32 v30, v30, v3, vcc
    v_cndmask_b32 v34, v34, v4, vcc
    v_cndmask_b32 v31, v31, v3, vcc
    v_cndmask_b32 v35, v35, v4, vcc
    v_cndmask_b32 v36, v36, v3, vcc
    v_cndmask_b32 v40, v40, v4, vcc
    v_cndmask_b32 v37, v37, v3, vcc
    v_cndmask_b32 v41, v41, v4, vcc
    v_cndmask_b32 v38, v38, v3, vcc
    v_cndmask_b32 v42, v42, v4, vcc
    v_cndmask_b32 v39, v39, v3, vcc
    v_cndmask_b32 v43, v43, v4, vcc
    v_cndmask_b32 v44, v44, v3, vcc
    v_cndmask_b32 v48, v48, v4, vcc
    v_cndmask_b32 v45, v45, v3, vcc
    v_cndmask_b32 v49, v49, v4, vcc
    v_cndmask_b32 v46, v46, v3, vcc
    v_cndmask_b32 v50, v50, v4, vcc
    v_cndmask_b32 v47, v47, v3, vcc
    v_cndmask_b32 v51, v51, v4, vcc
    v_cndmask_b32 v52, v52, v3, vcc
    v_cndmask_b32 v56, v56, v4, vcc
    v_cndmask_b32 v53, v53, v3, vcc
    v_cndmask_b32 v57, v57, v4, vcc
    v_cndmask_b32 v54, v54, v3, vcc
    v_cndmask_b32 v58, v58, v4, vcc
    v_cndmask_b32 v55, v55, v3, vcc
    v_cndmask_b32 v59, v59, v4, vcc
kx_nofix:
    s_add_u32 s32, s28, 1
    s_and_b32 s32, s32, 2
    s_cmp_lg_u32 s32, 0
    s_cselect_b32 s33, 0x80008000, 0
    s_cmp_lt_u32 s28, 2
    s_cselect_b32 s34, 0x80008000, 0
    s_bitcmp1_b32 s28, 0
    s_cselect_b32 s46, 1.0, -1.0
    s_cselect_b32 s47, 1.0, -1.0
    s_cbranch_scc1 kx_keep
    v_xor_b32 v60, s33, v24
    v_xor_b32 v64, s34, v20
    v_xor_b32 v61, s33, v25
    v_xor_b32 v65, s34, v21
    v_xor_b32 v62, s33, v26
    v_xor_b32 v66, s34, v22
    v_xor_b32 v63, s33, v27
    v_xor_b32 v67, s34, v23
    v_xor_b32 v68, s33, v32
    v_xor_b32 v72, s34, v28
    v_xor_b32 v69, s33, v33
    v_xor_b32 v73, s34, v29
    v_xor_b32 v70, s33, v34
    v_xor_b32 v74, s34, v30
    v_xor_b32 v71, s33, v35
    v_xor_b32 v75, s34, v31
    v_xor_b32 v76, s33, v40
    v_xor_b32 v80, s34, v36
    v_xor_b32 v77, s33, v41
    v_xor_b32 v81, s34, v37
    v_xor_b32 v78, s33, v42
    v_xor_b32 v82, s34, v38
    v_xor_b32 v79, s33, v43
    v_xor_b32 v83, s34, v39
    v_xor_b32 v84, s33, v48
    v_xor_b32 v88, s34, v44
    v_xor_b32 v85, s33, v49
    v_xor_b32 v89, s34, v45
    v_xor_b32 v86, s33, v50
    v_xor_b32 v90, s34, v46
    v_xor_b32 v87, s33, v51
    v_xor_b32 v91, s34, v47
    v_xor_b32 v92, s33, v56
    v_xor_b32 v96, s34, v52
    v_xor_b32 v93, s33, v57
    v_xor_b32 v97, s34, v53
    v_xor_b32 v94, s33, v58
    v_xor_b32 v98, s34, v54
    v_xor_b32 v95, s33, v59
    v_xor_b32 v99, s34, v55
    s_branch kx_shifted
kx_keep:
    v_xor_b32 v60, s33, v20
    v_xor_b32 v64, s34, v24
    v_xor_b32 v61, s33, v21
    v_xor_b32 v65, s34, v25
    v_xor_b32 v62, s33, v22
    v_xor_b32 v66, s34, v26
    v_xor_b32 v63, s33, v23
    v_xor_b32 v67, s34, v27
    v_xor_b32 v68, s33, v28
    v_xor_b32 v72, s34, v32
    v_xor_b32 v69, s33, v29
    v_xor_b32 v73, s34, v33
    v_xor_b32 v70, s33, v30
    v_xor_b32 v74, s34, v34
    v_xor_b32 v71, s33, v31
    v_xor_b32 v75, s34, v35
    v_xor_b32 v76, s33, v36
    v_xor_b32 v80, s34, v40
    v_xor_b32 v77, s33, v37
    v_xor_b32 v81, s34, v41
    v_xor_b32 v78, s33, v38
    v_xor_b32 v82, s34, v42
    v_xor_b32 v79, s33, v39
    v_xor_b32 v83, s34, v43
    v_xor_b32 v84, s33, v44
    v_xor_b32 v88, s34, v48
    v_xor_b32 v85, s33, v45
    v_xor_b32 v89, s34, v49
    v_xor_b32 v86, s33, v46
    v_xor_b32 v90, s34, v50
    v_xor_b32 v87, s33, v47
    v_xor_b32 v91, s34, v51
    v_xor_b32 v92, s33, v52
    v_xor_b32 v96, s34, v56
    v_xor_b32 v93, s33, v53
    v_xor_b32 v97, s34, v57
    v_xor_b32 v94, s33, v54
    v_xor_b32 v98, s34, v58
    v_xor_b32 v95, s33, v55
    v_xor_b32 v99, s34, v59
kx_shifted:
    v_and_b32 v2, 15, v1
    v_lshrrev_b32 v3, 2, v2
    v_and_b32 v4, 3, v2
    v_lshlrev_b32 v5, 10, v3
    v_lshl_add_u32 v5, v4, 7, v5
    v_lshrrev_b32 v4, 1, v4
    v_lshl_or_b32 v3, v3, 1, v4
    v_lshrrev_b32 v4, 4, v1
    v_xor_b32 v3, v3, v4
    v_lshl_add_u32 v10, v3, 4, v5
    v_xor_b32 v11, 64, v10
    v_add_u32 v12, 40960, v10
    v_add_u32 v13, 40960, v11
    s_waitcnt vmcnt(10)
    s_barrier
    ds_read_b128 v[100:103], v10 offset:0
    ds_read_b128 v[104:107], v10 offset:512
    ds_read_b128 v[108:111], v10 offset:4096
    ds_read_b128 v[112:115], v10 offset:4608
    ds_read_b128 v[116:119], v12 offset:0
    ds_read_b128 v[120:123], v12 offset:512
    ds_read_b128 v[124:127], v12 offset:4096
    ds_read_b128 v[128:131], v12 offset:4608
    s_waitcnt lgkmcnt(4)
    v_mfma_f32_16x16x32_bf16 v[148:151], v[100:103], v[20:23], 0
    ds_read_b128 v[132:135], v11 offset:0
    s_and_b32 s36, s2, 3
    v_mfma_f32_16x16x32_bf16 v[152:155], v[100:103], v[24:27], 0
    ds_read_b128 v[136:139], v11 offset:512
    s_lshl_b32 s36, s36, 4
    v_mfma_f32_16x16x32_bf16 v[156:159], v[104:107], v[20:23], 0
    ds_read_b128 v[140:143], v11 offset:4096
    s_bfe_u32 s37, s2, 0x30002
    v_mfma_f32_16x16x32_bf16 v[160:163], v[104:107], v[24:27], 0
    ds_read_b128 v[144:147], v11 offset:4608
    s_lshl_b32 s37, s37, 2
    v_mfma_f32_16x16x32_bf16 v[164:167], v[108:111], v[20:23], 0
    s_add_u32 s37, s37, s28
    s_lshl_b32 s37, s37, 6
    v_mfma_f32_16x16x32_bf16 v[168:171], v[108:111], v[24:27], 0
    s_add_u32 s36, s36, s37
    s_mul_i32 s36, s36, 642
    v_mfma_f32_16x16x32_bf16 v[172:175], v[112:115], v[20:23], 0
    s_add_u32 s36, s36, s43
    s_add_u32 s36, s36, 2
    v_mfma_f32_16x16x32_bf16 v[176:179], v[112:115], v[24:27], 0
    s_lshl_b32 s39, s28, 11
    s_add_u32 s39, s39, 81920
    s_waitcnt lgkmcnt(4)
    v_mfma_f32_16x16x32_bf16 v[180:183], v[116:119], v[20:23], 0
    ds_read_b128 v[100:103], v13 offset:0
    v_lshrrev_b32 v2, 3, v1
    v_mfma_f32_16x16x32_bf16 v[184:187], v[116:119], v[24:27], 0
    ds_read_b128 v[104:107], v13 offset:512
    v_mul_u32_u24 v2, 642, v2
    v_mfma_f32_16x16x32_bf16 v[188:191], v[120:123], v[20:23], 0
    ds_read_b128 v[108:111], v13 offset:4096
    v_lshrrev_b32_e64 v3, 4, v1
    v_mfma_f32_16x16x32_bf16 v[192:195], v[120:123], v[24:27], 0
    ds_read_b128 v[112:115], v13 offset:4608
    v_and_b32 v4, 7, v1
    v_mfma_f32_16x16x32_bf16 v[196:199], v[124:127], v[20:23], 0
    v_xor_b32 v3, v3, v4
    v_lshl_add_u32 v15, v3, 4, v2
    v_mfma_f32_16x16x32_bf16 v[200:203], v[124:127], v[24:27], 0
    v_xor_b32_e64 v3, 4, v3
    v_lshl_add_u32 v16, v3, 4, v2
    v_mfma_f32_16x16x32_bf16 v[204:207], v[128:131], v[20:23], 0
    v_add_u32 v16, 5136, v16
    s_add_u32 m0, s39, 0
    v_mfma_f32_16x16x32_bf16 v[208:211], v[128:131], v[24:27], 0
    buffer_load_dwordx4 v15, s[24:27], s36 offen  lds
    s_add_u32 m0, s39, 1024
    s_waitcnt lgkmcnt(4)
    v_mfma_f32_16x16x32_bf16 v[148:151], v[132:135], v[28:31], v[148:151]
    v_mfma_f32_16x16x32_bf16 v[152:155], v[132:135], v[32:35], v[152:155]
    s_waitcnt vmcnt(7)
    s_barrier
    v_mfma_f32_16x16x32_bf16 v[156:159], v[136:139], v[28:31], v[156:159]
    ds_read_b128 v[116:119], v10 offset:8192
    v_mfma_f32_16x16x32_bf16 v[160:163], v[136:139], v[32:35], v[160:163]
    ds_read_b128 v[120:123], v10 offset:8704
    buffer_load_dwordx4 v16, s[24:27], s36 offen  lds
    v_mfma_f32_16x16x32_bf16 v[164:167], v[140:143], v[28:31], v[164:167]
    ds_read_b128 v[124:127], v10 offset:12288
    s_add_u32 m0, s39, 8192
    v_mfma_f32_16x16x32_bf16 v[168:171], v[140:143], v[32:35], v[168:171]
    ds_read_b128 v[128:131], v10 offset:12800
    v_mfma_f32_16x16x32_bf16 v[172:175], v[144:147], v[28:31], v[172:175]
    v_mfma_f32_16x16x32_bf16 v[176:179], v[144:147], v[32:35], v[176:179]
    buffer_load_dwordx4 v15, s[4:7], s36 offen  lds
    s_add_u32 m0, s39, 9216
    s_waitcnt lgkmcnt(4)
    v_mfma_f32_16x16x32_bf16 v[180:183], v[100:103], v[28:31], v[180:183]
    ds_read_b128 v[132:135], v12 offset:8192
    v_mfma_f32_16x16x32_bf16 v[184:187], v[100:103], v[32:35], v[184:187]
    ds_read_b128 v[136:139], v12 offset:8704
    v_mfma_f32_16x16x32_bf16 v[188:191], v[104:107], v[28:31], v[188:191]
    ds_read_b128 v[140:143], v12 offset:12288
    v_mfma_f32_16x16x32_bf16 v[192:195], v[104:107], v[32:35], v[192:195]
    ds_read_b128 v[144:147], v12 offset:12800
    buffer_load_dwordx4 v16, s[4:7], s36 offen  lds
    v_mfma_f32_16x16x32_bf16 v[196:199], v[108:111], v[28:31], v[196:199]
    s_add_u32 m0, s41, 65536
    v_mfma_f32_16x16x32_bf16 v[200:203], v[108:111], v[32:35], v[200:203]
    s_add_u32 s44, s44, 128
    s_cmp_eq_u32 s44, 1280
    v_mfma_f32_16x16x32_bf16 v[204:207], v[112:115], v[28:31], v[204:207]
    s_cselect_b32 s44, 0, s44
    v_mfma_f32_16x16x32_bf16 v[208:211], v[112:115], v[32:35], v[208:211]
    buffer_load_dwordx4 v17, s[16:19], s44 offen  lds
    s_add_u32 m0, s41, 69632
    s_waitcnt lgkmcnt(4)
    v_mfma_f32_16x16x32_bf16 v[148:151], v[116:119], v[36:39], v[148:151]
    ds_read_b128 v[100:103], v11 offset:8192
    v_mfma_f32_16x16x32_bf16 v[152:155], v[116:119], v[40:43], v[152:155]
    ds_read_b128 v[104:107], v11 offset:8704
    v_mfma_f32_16x16x32_bf16 v[156:159], v[120:123], v[36:39], v[156:159]
    ds_read_b128 v[108:111], v11 offset:12288
    v_mfma_f32_16x16x32_bf16 v[160:163], v[120:123], v[40:43], v[160:163]
    ds_read_b128 v[112:115], v11 offset:12800
    buffer_load_dwordx4 v19, s[16:19], s44 offen  lds
    v_mfma_f32_16x16x32_bf16 v[164:167], v[124:127], v[36:39], v[164:167]
    s_add_u32 m0, s41, 32768
    s_add_u32 s42, s42, 128
    v_mfma_f32_16x16x32_bf16 v[168:171], v[124:127], v[40:43], v[168:171]
    v_mfma_f32_16x16x32_bf16 v[172:175], v[128:131], v[36:39], v[172:175]
    v_mfma_f32_16x16x32_bf16 v[176:179], v[128:131], v[40:43], v[176:179]
    buffer_load_dwordx4 v17, s[16:19], s42 offen  lds
    s_add_u32 m0, s41, 36864
    s_waitcnt lgkmcnt(4)
    v_mfma_f32_16x16x32_bf16 v[180:183], v[132:135], v[36:39], v[180:183]
    ds_read_b128 v[116:119], v13 offset:8192
    v_mfma_f32_16x16x32_bf16 v[184:187], v[132:135], v[40:43], v[184:187]
    ds_read_b128 v[120:123], v13 offset:8704
    v_mfma_f32_16x16x32_bf16 v[188:191], v[136:139], v[36:39], v[188:191]
    ds_read_b128 v[124:127], v13 offset:12288
    v_mfma_f32_16x16x32_bf16 v[192:195], v[136:139], v[40:43], v[192:195]
    ds_read_b128 v[128:131], v13 offset:12800
    buffer_load_dwordx4 v19, s[16:19], s42 offen  lds
    v_mfma_f32_16x16x32_bf16 v[196:199], v[140:143], v[36:39], v[196:199]
    s_add_u32 m0, s41, 73728
    s_add_u32 s44, s44, 128
    v_mfma_f32_16x16x32_bf16 v[200:203], v[140:143], v[40:43], v[200:203]
    s_cmp_eq_u32 s44, 1280
    s_cselect_b32 s44, 0, s44
    v_mfma_f32_16x16x32_bf16 v[204:207], v[144:147], v[36:39], v[204:207]
    v_mfma_f32_16x16x32_bf16 v[208:211], v[144:147], v[40:43], v[208:211]
    buffer_load_dwordx4 v17, s[16:19], s44 offen  lds
    s_add_u32 m0, s41, 77824
    s_waitcnt lgkmcnt(4)
    v_mfma_f32_16x16x32_bf16 v[148:151], v[100:103], v[44:47], v[148:151]
    v_mfma_f32_16x16x32_bf16 v[152:155], v[100:103], v[48:51], v[152:155]
    s_waitcnt vmcnt(11)
    s_barrier
    v_mfma_f32_16x16x32_bf16 v[156:159], v[104:107], v[44:47], v[156:159]
    ds_read_b128 v[132:135], v10 offset:16384
    v_mfma_f32_16x16x32_bf16 v[160:163], v[104:107], v[48:51], v[160:163]
    ds_read_b128 v[136:139], v10 offset:16896
    buffer_load_dwordx4 v19, s[16:19], s44 offen  lds
    v_mfma_f32_16x16x32_bf16 v[164:167], v[108:111], v[44:47], v[164:167]
    ds_read_b128 v[140:143], v10 offset:20480
    v_mfma_f32_16x16x32_bf16 v[168:171], v[108:111], v[48:51], v[168:171]
    ds_read_b128 v[144:147], v10 offset:20992
    v_mfma_f32_16x16x32_bf16 v[172:175], v[112:115], v[44:47], v[172:175]
    v_mfma_f32_16x16x32_bf16 v[176:179], v[112:115], v[48:51], v[176:179]
    s_waitcnt lgkmcnt(4)
    v_mfma_f32_16x16x32_bf16 v[180:183], v[116:119], v[44:47], v[180:183]
    ds_read_b128 v[100:103], v12 offset:16384
    v_mfma_f32_16x16x32_bf16 v[184:187], v[116:119], v[48:51], v[184:187]
    ds_read_b128 v[104:107], v12 offset:16896
    v_mfma_f32_16x16x32_bf16 v[188:191], v[120:123], v[44:47], v[188:191]
    ds_read_b128 v[108:111], v12 offset:20480
    v_mfma_f32_16x16x32_bf16 v[192:195], v[120:123], v[48:51], v[192:195]
    ds_read_b128 v[112:115], v12 offset:20992
    v_mfma_f32_16x16x32_bf16 v[196:199], v[124:127], v[44:47], v[196:199]
    v_mfma_f32_16x16x32_bf16 v[200:203], v[124:127], v[48:51], v[200:203]
    v_mfma_f32_16x16x32_bf16 v[204:207], v[128:131], v[44:47], v[204:207]
    v_mfma_f32_16x16x32_bf16 v[208:211], v[128:131], v[48:51], v[208:211]
    s_waitcnt lgkmcnt(4)
    v_mfma_f32_16x16x32_bf16 v[148:151], v[132:135], v[52:55], v[148:151]
    ds_read_b128 v[116:119], v11 offset:16384
    v_mfma_f32_16x16x32_bf16 v[152:155], v[132:135], v[56:59], v[152:155]
    ds_read_b128 v[120:123], v11 offset:16896
    v_and_b32_e64 v2, 15, v0
    v_mfma_f32_16x16x32_bf16 v[156:159], v[136:139], v[52:55], v[156:159]
    ds_read_b128 v[124:127], v11 offset:20480
    v_lshrrev_b32_e64 v3, 4, v0
    v_mfma_f32_16x16x32_bf16 v[160:163], v[136:139], v[56:59], v[160:163]
    ds_read_b128 v[128:131], v11 offset:20992
    v_lshrrev_b32 v4, 1, v3
    v_mfma_f32_16x16x32_bf16 v[164:167], v[140:143], v[52:55], v[164:167]
    v_lshrrev_b32 v5, 1, v2
    v_xor_b32 v4, v4, v5
    v_mfma_f32_16x16x32_bf16 v[168:171], v[140:143], v[56:59], v[168:171]
    v_lshlrev_b32 v4, 4, v4
    v_and_b32_e64 v5, 1, v3
    v_mfma_f32_16x16x32_bf16 v[172:175], v[144:147], v[52:55], v[172:175]
    v_lshl_or_b32 v4, v5, 3, v4
    v_lshl_add_u32 v4, v2, 7, v4
    v_mfma_f32_16x16x32_bf16 v[176:179], v[144:147], v[56:59], v[176:179]
    v_add_u32 v15, 81920, v4
    s_waitcnt lgkmcnt(4)
    v_mfma_f32_16x16x32_bf16 v[180:183], v[100:103], v[52:55], v[180:183]
    ds_read_b128 v[132:135], v13 offset:16384
    v_lshlrev_b32 v3, 13, v3
    v_mfma_f32_16x16x32_bf16 v[184:187], v[100:103], v[56:59], v[184:187]
    ds_read_b128 v[136:139], v13 offset:16896
    v_lshl_add_u32 v16, v2, 4, v3
    v_mfma_f32_16x16x32_bf16 v[188:191], v[104:107], v[52:55], v[188:191]
    ds_read_b128 v[140:143], v13 offset:20480
    s_lshl_b32 s36, s30, 19
    v_mfma_f32_16x16x32_bf16 v[192:195], v[104:107], v[56:59], v[192:195]
    ds_read_b128 v[144:147], v13 offset:20992
    s_and_b32 s37, s2, 3
    v_mfma_f32_16x16x32_bf16 v[196:199], v[108:111], v[52:55], v[196:199]
    s_lshl_b32 s37, s37, 11
    s_add_u32 s36, s36, s37
    v_mfma_f32_16x16x32_bf16 v[200:203], v[108:111], v[56:59], v[200:203]
    s_bfe_u32 s37, s2, 0x10002
    s_lshl_b32 s37, s37, 10
    v_mfma_f32_16x16x32_bf16 v[204:207], v[112:115], v[52:55], v[204:207]
    s_add_u32 s36, s36, s37
    s_bfe_u32 s37, s2, 0x20003
    v_mfma_f32_16x16x32_bf16 v[208:211], v[112:115], v[56:59], v[208:211]
    s_lshl_b32 s37, s37, 8
    s_add_u32 s36, s36, s37
    s_waitcnt lgkmcnt(4)
    v_mfma_f32_16x16x32_bf16 v[148:151], v[116:119], v[60:63], v[148:151]
    s_add_u32 s36, s36, 7340032
    s_mov_b32 s48, 0x05040100
    v_mfma_f32_16x16x32_bf16 v[152:155], v[116:119], v[64:67], v[152:155]
    s_mov_b32 s49, 0x07060302
    v_mov_b32_e64 v250, 0
    s_waitcnt vmcnt(4)
    s_barrier
    v_mfma_f32_16x16x32_bf16 v[156:159], v[120:123], v[60:63], v[156:159]
    ds_read_b128 v[100:103], v10 offset:24576
    global_load_dwordx2 v[250:251], v250, s[62:63] sc1
    v_mfma_f32_16x16x32_bf16 v[160:163], v[120:123], v[64:67], v[160:163]
    ds_read_b128 v[104:107], v10 offset:25088
    v_mfma_f32_16x16x32_bf16 v[164:167], v[124:127], v[60:63], v[164:167]
    ds_read_b128 v[108:111], v10 offset:28672
    v_mfma_f32_16x16x32_bf16 v[168:171], v[124:127], v[64:67], v[168:171]
    ds_read_b128 v[112:115], v10 offset:29184
    v_mfma_f32_16x16x32_bf16 v[172:175], v[128:131], v[60:63], v[172:175]
    v_mfma_f32_16x16x32_bf16 v[176:179], v[128:131], v[64:67], v[176:179]
    s_waitcnt lgkmcnt(4)
    v_mfma_f32_16x16x32_bf16 v[180:183], v[132:135], v[60:63], v[180:183]
    ds_read_b128 v[116:119], v12 offset:24576
    v_mfma_f32_16x16x32_bf16 v[184:187], v[132:135], v[64:67], v[184:187]
    ds_read_b128 v[120:123], v12 offset:25088
    v_mfma_f32_16x16x32_bf16 v[188:191], v[136:139], v[60:63], v[188:191]
    ds_read_b128 v[124:127], v12 offset:28672
    v_mfma_f32_16x16x32_bf16 v[192:195], v[136:139], v[64:67], v[192:195]
    ds_read_b128 v[128:131], v12 offset:29184
    v_mfma_f32_16x16x32_bf16 v[196:199], v[140:143], v[60:63], v[196:199]
    ds_read_b64 v[212:213], v15 offset:0
    v_mfma_f32_16x16x32_bf16 v[200:203], v[140:143], v[64:67], v[200:203]
    ds_read_b64 v[214:215], v15 offset:2048
    v_mfma_f32_16x16x32_bf16 v[204:207], v[144:147], v[60:63], v[204:207]
    ds_read_b64 v[216:217], v15 offset:4096
    v_mfma_f32_16x16x32_bf16 v[208:211], v[144:147], v[64:67], v[208:211]
    ds_read_b64 v[218:219], v15 offset:6144
    s_waitcnt lgkmcnt(4)
    v_mfma_f32_16x16x32_bf16 v[148:151], v[100:103], v[68:71], v[148:151]
    ds_read_b128 v[132:135], v11 offset:24576
    s_mul_i32 s12, s29, 81920
    v_mfma_f32_16x16x32_bf16 v[152:155], v[100:103], v[72:75], v[152:155]
    ds_read_b128 v[136:139], v11 offset:25088
    s_lshl_b32 s37, s30, 2
    v_mfma_f32_16x16x32_bf16 v[156:159], v[104:107], v[68:71], v[156:159]
    ds_read_b128 v[140:143], v11 offset:28672
    s_add_u32 s37, s37, s28
    v_mfma_f32_16x16x32_bf16 v[160:163], v[104:107], v[72:75], v[160:163]
    ds_read_b128 v[144:147], v11 offset:29184
    s_lshl_b32 s37, s37, 12
    v_mfma_f32_16x16x32_bf16 v[164:167], v[108:111], v[68:71], v[164:167]
    ds_read_b64 v[220:221], v15 offset:8192
    s_add_u32 s12, s12, s37
    v_mfma_f32_16x16x32_bf16 v[168:171], v[108:111], v[72:75], v[168:171]
    ds_read_b64 v[222:223], v15 offset:10240
    s_lshl_b32 s37, s28, 12
    v_mfma_f32_16x16x32_bf16 v[172:175], v[112:115], v[68:71], v[172:175]
    ds_read_b64 v[224:225], v15 offset:12288
    s_add_u32 s37, s37, 98304
    v_mfma_f32_16x16x32_bf16 v[176:179], v[112:115], v[72:75], v[176:179]
    ds_read_b64 v[226:227], v15 offset:14336
    v_and_b32 v2, 7, v1
    s_waitcnt lgkmcnt(4)
    v_mfma_f32_16x16x32_bf16 v[180:183], v[116:119], v[68:71], v[180:183]
    ds_read_b128 v[100:103], v13 offset:24576
    v_lshrrev_b32_e64 v3, 4, v1
    v_mfma_f32_16x16x32_bf16 v[184:187], v[116:119], v[72:75], v[184:187]
    ds_read_b128 v[104:107], v13 offset:25088
    v_xor_b32_e64 v3, v3, v2
    v_mfma_f32_16x16x32_bf16 v[188:191], v[120:123], v[68:71], v[188:191]
    ds_read_b128 v[108:111], v13 offset:28672
    v_and_b32_e64 v4, 15, v1
    v_mfma_f32_16x16x32_bf16 v[192:195], v[120:123], v[72:75], v[192:195]
    ds_read_b128 v[112:115], v13 offset:29184
    v_lshlrev_b32_e64 v4, 7, v4
    v_mfma_f32_16x16x32_bf16 v[196:199], v[124:127], v[68:71], v[196:199]
    v_lshl_add_u32 v4, v3, 4, v4
    v_add_u32 v248, s37, v4
    v_mfma_f32_16x16x32_bf16 v[200:203], v[124:127], v[72:75], v[200:203]
    v_xor_b32 v249, 64, v248
    v_lshrrev_b32 v3, 3, v1
    v_mfma_f32_16x16x32_bf16 v[204:207], v[128:131], v[68:71], v[204:207]
    v_xor_b32 v2, v2, v3
    v_lshlrev_b32_e64 v3, 7, v3
    v_mfma_f32_16x16x32_bf16 v[208:211], v[128:131], v[72:75], v[208:211]
    v_lshl_add_u32 v3, v2, 4, v3
    v_add_u32_e64 v18, s37, v3
    s_waitcnt lgkmcnt(4)
    v_mfma_f32_16x16x32_bf16 v[148:151], v[132:135], v[76:79], v[148:151]
    v_lshlrev_b32 v14, 4, v1
    v_perm_b32 v228, v214, v212, s48
    v_mfma_f32_16x16x32_bf16 v[152:155], v[132:135], v[80:83], v[152:155]
    v_perm_b32 v229, v218, v216, s48
    v_perm_b32 v230, v222, v220, s48
    s_waitcnt vmcnt(1)
    s_barrier
    v_mfma_f32_16x16x32_bf16 v[156:159], v[136:139], v[76:79], v[156:159]
    ds_read_b128 v[116:119], v10 offset:32768
    v_perm_b32 v231, v226, v224, s48
    v_mfma_f32_16x16x32_bf16 v[160:163], v[136:139], v[80:83], v[160:163]
    ds_read_b128 v[120:123], v10 offset:33280
    buffer_store_dwordx4 v[228:231], v16, s[20:23], s36 offen sc1
    v_mfma_f32_16x16x32_bf16 v[164:167], v[140:143], v[76:79], v[164:167]
    ds_read_b128 v[124:127], v10 offset:36864
    s_add_u32 s36, s36, 131072
    v_mfma_f32_16x16x32_bf16 v[168:171], v[140:143], v[80:83], v[168:171]
    ds_read_b128 v[128:131], v10 offset:37376
    v_mfma_f32_16x16x32_bf16 v[172:175], v[144:147], v[76:79], v[172:175]
    v_mfma_f32_16x16x32_bf16 v[176:179], v[144:147], v[80:83], v[176:179]
    s_waitcnt lgkmcnt(4)
    v_mfma_f32_16x16x32_bf16 v[180:183], v[100:103], v[76:79], v[180:183]
    ds_read_b128 v[132:135], v12 offset:32768
    v_perm_b32 v232, v214, v212, s49
    v_mfma_f32_16x16x32_bf16 v[184:187], v[100:103], v[80:83], v[184:187]
    ds_read_b128 v[136:139], v12 offset:33280
    v_perm_b32 v233, v218, v216, s49
    v_mfma_f32_16x16x32_bf16 v[188:191], v[104:107], v[76:79], v[188:191]
    ds_read_b128 v[140:143], v12 offset:36864
    v_perm_b32 v234, v222, v220, s49
    v_mfma_f32_16x16x32_bf16 v[192:195], v[104:107], v[80:83], v[192:195]
    ds_read_b128 v[144:147], v12 offset:37376
    v_perm_b32 v235, v226, v224, s49
    v_mfma_f32_16x16x32_bf16 v[196:199], v[108:111], v[76:79], v[196:199]
    buffer_store_dwordx4 v[232:235], v16, s[20:23], s36 offen sc1
    s_add_u32 s36, s36, 131072
    v_mfma_f32_16x16x32_bf16 v[200:203], v[108:111], v[80:83], v[200:203]
    v_mfma_f32_16x16x32_bf16 v[204:207], v[112:115], v[76:79], v[204:207]
    v_mfma_f32_16x16x32_bf16 v[208:211], v[112:115], v[80:83], v[208:211]
    s_waitcnt lgkmcnt(4)
    v_mfma_f32_16x16x32_bf16 v[148:151], v[116:119], v[84:87], v[148:151]
    ds_read_b128 v[100:103], v11 offset:32768
    v_perm_b32 v236, v215, v213, s48
    v_mfma_f32_16x16x32_bf16 v[152:155], v[116:119], v[88:91], v[152:155]
    ds_read_b128 v[104:107], v11 offset:33280
    v_perm_b32 v237, v219, v217, s48
    v_mfma_f32_16x16x32_bf16 v[156:159], v[120:123], v[84:87], v[156:159]
    ds_read_b128 v[108:111], v11 offset:36864
    v_perm_b32 v238, v223, v221, s48
    v_mfma_f32_16x16x32_bf16 v[160:163], v[120:123], v[88:91], v[160:163]
    ds_read_b128 v[112:115], v11 offset:37376
    v_perm_b32 v239, v227, v225, s48
    v_mfma_f32_16x16x32_bf16 v[164:167], v[124:127], v[84:87], v[164:167]
    buffer_store_dwordx4 v[236:239], v16, s[20:23], s36 offen sc1
    s_add_u32 s36, s36, 131072
    v_mfma_f32_16x16x32_bf16 v[168:171], v[124:127], v[88:91], v[168:171]
    v_mfma_f32_16x16x32_bf16 v[172:175], v[128:131], v[84:87], v[172:175]
    v_mfma_f32_16x16x32_bf16 v[176:179], v[128:131], v[88:91], v[176:179]
    s_waitcnt lgkmcnt(4)
    v_mfma_f32_16x16x32_bf16 v[180:183], v[132:135], v[84:87], v[180:183]
    ds_read_b128 v[116:119], v13 offset:32768
    v_perm_b32 v240, v215, v213, s49
    v_mfma_f32_16x16x32_bf16 v[184:187], v[132:135], v[88:91], v[184:187]
    ds_read_b128 v[120:123], v13 offset:33280
    v_perm_b32 v241, v219, v217, s49
    v_mfma_f32_16x16x32_bf16 v[188:191], v[136:139], v[84:87], v[188:191]
    ds_read_b128 v[124:127], v13 offset:36864
    v_perm_b32 v242, v223, v221, s49
    v_mfma_f32_16x16x32_bf16 v[192:195], v[136:139], v[88:91], v[192:195]
    ds_read_b128 v[128:131], v13 offset:37376
    v_perm_b32 v243, v227, v225, s49
    v_mfma_f32_16x16x32_bf16 v[196:199], v[140:143], v[84:87], v[196:199]
    buffer_store_dwordx4 v[240:243], v16, s[20:23], s36 offen sc1
    s_add_u32 s36, s36, 131072
    v_mfma_f32_16x16x32_bf16 v[200:203], v[140:143], v[88:91], v[200:203]
    s_waitcnt vmcnt(4)
    v_mfma_f32_16x16x32_bf16 v[204:207], v[144:147], v[84:87], v[204:207]
kx_n0:
    v_readfirstlane_b32 s10, v250
    v_readfirstlane_b32 s11, v251
    s_add_u32 s32, s10, 1000
    s_addc_u32 s33, s11, 0
    s_sub_u32 s32, s32, s94
    s_subb_u32 s33, s33, s95
    s_cmp_ge_i32 s33, 0
    s_cbranch_scc0 kx_n2
kx_n1:
    v_mfma_f32_16x16x32_bf16 v[208:211], v[144:147], v[88:91], v[208:211]
    s_waitcnt lgkmcnt(4)
    v_mfma_f32_16x16x32_bf16 v[148:151], v[100:103], v[92:95], v[148:151]
    v_mfma_f32_16x16x32_bf16 v[152:155], v[100:103], v[96:99], v[152:155]
    v_mfma_f32_16x16x32_bf16 v[156:159], v[104:107], v[92:95], v[156:159]
    v_mfma_f32_16x16x32_bf16 v[160:163], v[104:107], v[96:99], v[160:163]
    v_mfma_f32_16x16x32_bf16 v[164:167], v[108:111], v[92:95], v[164:167]
    v_mfma_f32_16x16x32_bf16 v[168:171], v[108:111], v[96:99], v[168:171]
    v_mfma_f32_16x16x32_bf16 v[172:175], v[112:115], v[92:95], v[172:175]
    v_mfma_f32_16x16x32_bf16 v[176:179], v[112:115], v[96:99], v[176:179]
    s_waitcnt lgkmcnt(0)
    v_mfma_f32_16x16x32_bf16 v[180:183], v[116:119], v[92:95], v[180:183]
    v_mfma_f32_16x16x32_bf16 v[184:187], v[116:119], v[96:99], v[184:187]
    v_mfma_f32_16x16x32_bf16 v[188:191], v[120:123], v[92:95], v[188:191]
    v_mfma_f32_16x16x32_bf16 v[192:195], v[120:123], v[96:99], v[192:195]
    v_mfma_f32_16x16x32_bf16 v[196:199], v[124:127], v[92:95], v[196:199]
    v_mfma_f32_16x16x32_bf16 v[200:203], v[124:127], v[96:99], v[200:203]
    v_mfma_f32_16x16x32_bf16 v[204:207], v[128:131], v[92:95], v[204:207]
    v_mfma_f32_16x16x32_bf16 v[208:211], v[128:131], v[96:99], v[208:211]
    s_nop 0
    v_pk_fma_f32 v[148:149], v[180:181], s[46:47], v[148:149]
    v_cvt_pk_bf16_f32 v100, v148, v149
    v_pk_fma_f32 v[150:151], v[182:183], s[46:47], v[150:151]
    v_cvt_pk_bf16_f32 v101, v150, v151
    v_pk_fma_f32 v[156:157], v[188:189], s[46:47], v[156:157]
    v_cvt_pk_bf16_f32 v102, v156, v157
    v_pk_fma_f32 v[158:159], v[190:191], s[46:47], v[158:159]
    v_cvt_pk_bf16_f32 v103, v158, v159
    v_and_b32_e64 v100, -2, v100
    ds_write_b128 v248, v[100:103] offset:0
    v_pk_fma_f32 v[164:165], v[196:197], s[46:47], v[164:165]
    v_cvt_pk_bf16_f32 v104, v164, v165
    v_pk_fma_f32 v[166:167], v[198:199], s[46:47], v[166:167]
    v_cvt_pk_bf16_f32 v105, v166, v167
    v_pk_fma_f32 v[172:173], v[204:205], s[46:47], v[172:173]
    v_cvt_pk_bf16_f32 v106, v172, v173
    v_pk_fma_f32 v[174:175], v[206:207], s[46:47], v[174:175]
    v_cvt_pk_bf16_f32 v107, v174, v175
    v_and_b32 v104, -2, v104
    ds_write_b128 v249, v[104:107] offset:0
    s_waitcnt lgkmcnt(0)
    ds_read_b128 v[116:119], v18 offset:0
    ds_read_b128 v[120:123], v18 offset:1024
    v_pk_fma_f32 v[152:153], v[184:185], s[46:47], v[152:153]
    v_cvt_pk_bf16_f32 v108, v152, v153
    v_pk_fma_f32 v[154:155], v[186:187], s[46:47], v[154:155]
    v_cvt_pk_bf16_f32 v109, v154, v155
    v_pk_fma_f32 v[160:161], v[192:193], s[46:47], v[160:161]
    v_cvt_pk_bf16_f32 v110, v160, v161
    v_pk_fma_f32 v[162:163], v[194:195], s[46:47], v[162:163]
    v_cvt_pk_bf16_f32 v111, v162, v163
    s_waitcnt lgkmcnt(0)
    buffer_store_dwordx4 v[116:119], v14, s[20:23], s12 offen offset:0 sc1
    buffer_store_dwordx4 v[120:123], v14, s[20:23], s12 offen offset:1024 sc1
    v_and_b32 v108, -2, v108
    ds_write_b128 v248, v[108:111] offset:2048
    v_pk_fma_f32 v[168:169], v[200:201], s[46:47], v[168:169]
    v_cvt_pk_bf16_f32 v112, v168, v169
    v_pk_fma_f32 v[170:171], v[202:203], s[46:47], v[170:171]
    v_cvt_pk_bf16_f32 v113, v170, v171
    v_pk_fma_f32 v[176:177], v[208:209], s[46:47], v[176:177]
    v_cvt_pk_bf16_f32 v114, v176, v177
    v_pk_fma_f32 v[178:179], v[210:211], s[46:47], v[178:179]
    v_cvt_pk_bf16_f32 v115, v178, v179
    v_and_b32 v112, -2, v112
    ds_write_b128 v249, v[112:115] offset:2048
    s_waitcnt lgkmcnt(0)
    ds_read_b128 v[124:127], v18 offset:2048
    ds_read_b128 v[128:131], v18 offset:3072
    s_waitcnt lgkmcnt(1)
    buffer_store_dwordx4 v[124:127], v14, s[20:23], s12 offen offset:2048 sc1
    s_waitcnt lgkmcnt(0)
    buffer_store_dwordx4 v[128:131], v14, s[20:23], s12 offen offset:3072 sc1
    s_lshl_b32 s32, s2, 4
    s_add_u32 s32, s32, s28
    s_lshl_b32 s32, s32, 3
    s_add_u32 s32, s32, 19136512
    v_mov_b32 v2, s10
    v_mov_b32_e64 v3, s11
    v_mov_b32 v4, 0
    s_waitcnt vmcnt(0)
    buffer_store_dwordx2 v[2:3], v4, s[20:23], s32 offen sc1
    s_and_b32 s32, s2, 0xe0
    s_add_u32 s32, s32, s28
    s_lshl_b32 s32, s32, 7
    s_bfe_u32 s33, s2, 0x20001
    s_lshl_b32 s33, s33, 3
    s_add_u32 s32, s32, s33
    s_add_u32 s32, s32, 19136512
    v_and_b32 v146, 7, v1
    v_lshl_add_u32 v146, v146, 9, s32
    s_lshl_b32 s32, s28, 8
    s_add_u32 s32, s32, 19167232
    v_and_b32_e64 v144, 1, v1
    v_lshl_add_u32 v144, v144, 7, s32
    v_bfe_u32 v145, v1, 1, 1
    v_lshl_add_u32 v144, v145, 10, v144
    v_mov_b32 v143, v146
    v_mov_b32 v146, v144
    s_bfe_u32 s29, s2, 0x20001
    s_lshl_b32 s29, s29, 3
    s_lshr_b32 s32, s2, 5
    s_add_u32 s29, s29, s32
    s_and_b32 s30, s2, 1
    s_lshl_b32 s30, s30, 2
    s_bfe_u32 s32, s2, 0x20003
    s_add_u32 s30, s30, s32
    v_and_b32 v2, 15, v1
    s_lshl_b32 s39, s28, 4
    v_add_u32 v2, s39, v2
    v_cvt_f32_u32 v2, v2
    v_lshrrev_b32 v3, 4, v1
    v_cvt_f32_u32 v3, v3
    v_mul_f32 v4, 0x3c800000, v2
    v_mul_f32 v5, 4.0, v3
    v_mul_f32 v5, v5, v4
    v_cos_f32 v196, v4
    v_sin_f32 v197, v4
    v_fmamk_f32 v6, v4, 0x00000000, v5
    v_cos_f32 v200, v6
    v_sin_f32 v201, v6
    v_fmamk_f32 v7, v4, 0x41800000, v5
    v_cos_f32 v208, v7
    v_sin_f32 v209, v7
    v_fmamk_f32 v6, v4, 0x42000000, v5
    v_cos_f32 v216, v6
    v_sin_f32 v217, v6
    v_fmamk_f32 v7, v4, 0x42400000, v5
    v_cos_f32 v224, v7
    v_sin_f32 v225, v7
    v_pk_mul_f32 v[202:203], v[200:201], v[196:197] op_sel_hi:[1,0]
    v_pk_mul_f32 v[210:211], v[208:209], v[196:197] op_sel_hi:[1,0]
    v_pk_mul_f32 v[218:219], v[216:217], v[196:197] op_sel_hi:[1,0]
    v_pk_mul_f32 v[226:227], v[224:225], v[196:197] op_sel_hi:[1,0]
    v_pk_fma_f32 v[202:203], v[200:201], v[196:197], v[202:203] op_sel:[1,1,0] op_sel_hi:[0,1,1] neg_lo:[1,0,0]
    v_pk_fma_f32 v[210:211], v[208:209], v[196:197], v[210:211] op_sel:[1,1,0] op_sel_hi:[0,1,1] neg_lo:[1,0,0]
    v_pk_fma_f32 v[218:219], v[216:217], v[196:197], v[218:219] op_sel:[1,1,0] op_sel_hi:[0,1,1] neg_lo:[1,0,0]
    v_pk_fma_f32 v[226:227], v[224:225], v[196:197], v[226:227] op_sel:[1,1,0] op_sel_hi:[0,1,1] neg_lo:[1,0,0]
    v_pk_mul_f32 v[204:205], v[202:203], v[196:197] op_sel_hi:[1,0]
    v_pk_mul_f32 v[212:213], v[210:211], v[196:197] op_sel_hi:[1,0]
    v_pk_mul_f32 v[220:221], v[218:219], v[196:197] op_sel_hi:[1,0]
    v_pk_mul_f32 v[228:229], v[226:227], v[196:197] op_sel_hi:[1,0]
    v_pk_fma_f32 v[204:205], v[202:203], v[196:197], v[204:205] op_sel:[1,1,0] op_sel_hi:[0,1,1] neg_lo:[1,0,0]
    v_pk_fma_f32 v[212:213], v[210:211], v[196:197], v[212:213] op_sel:[1,1,0] op_sel_hi:[0,1,1] neg_lo:[1,0,0]
    v_pk_fma_f32 v[220:221], v[218:219], v[196:197], v[220:221] op_sel:[1,1,0] op_sel_hi:[0,1,1] neg_lo:[1,0,0]
    v_pk_fma_f32 v[228:229], v[226:227], v[196:197], v[228:229] op_sel:[1,1,0] op_sel_hi:[0,1,1] neg_lo:[1,0,0]
    v_pk_mul_f32 v[206:207], v[204:205], v[196:197] op_sel_hi:[1,0]
    v_pk_mul_f32 v[214:215], v[212:213], v[196:197] op_sel_hi:[1,0]
    v_pk_mul_f32 v[222:223], v[220:221], v[196:197] op_sel_hi:[1,0]
    v_pk_mul_f32 v[230:231], v[228:229], v[196:197] op_sel_hi:[1,0]
    v_pk_fma_f32 v[206:207], v[204:205], v[196:197], v[206:207] op_sel:[1,1,0] op_sel_hi:[0,1,1] neg_lo:[1,0,0]
    v_pk_fma_f32 v[214:215], v[212:213], v[196:197], v[214:215] op_sel:[1,1,0] op_sel_hi:[0,1,1] neg_lo:[1,0,0]
    v_pk_fma_f32 v[222:223], v[220:221], v[196:197], v[222:223] op_sel:[1,1,0] op_sel_hi:[0,1,1] neg_lo:[1,0,0]
    v_pk_fma_f32 v[230:231], v[228:229], v[196:197], v[230:231] op_sel:[1,1,0] op_sel_hi:[0,1,1] neg_lo:[1,0,0]
    v_cvt_pk_bf16_f32 v20, v200, v202
    v_cvt_pk_bf16_f32 v28, v201, v203
    v_cvt_pk_bf16_f32 v21, v204, v206
    v_cvt_pk_bf16_f32 v29, v205, v207
    v_cvt_pk_bf16_f32 v22, v208, v210
    v_cvt_pk_bf16_f32 v30, v209, v211
    v_cvt_pk_bf16_f32 v23, v212, v214
    v_cvt_pk_bf16_f32 v31, v213, v215
    v_cvt_pk_bf16_f32 v24, v216, v218
    v_cvt_pk_bf16_f32 v32, v217, v219
    v_cvt_pk_bf16_f32 v25, v220, v222
    v_cvt_pk_bf16_f32 v33, v221, v223
    v_cvt_pk_bf16_f32 v26, v224, v226
    v_cvt_pk_bf16_f32 v34, v225, v227
    v_cvt_pk_bf16_f32 v27, v228, v230
    v_cvt_pk_bf16_f32 v35, v229, v231
    v_xor_b32 v36, 0x80008000, v28
    v_xor_b32 v37, 0x80008000, v29
    v_xor_b32 v38, 0x80008000, v30
    v_xor_b32 v39, 0x80008000, v31
    v_xor_b32 v40, 0x80008000, v32
    v_xor_b32 v41, 0x80008000, v33
    v_xor_b32 v42, 0x80008000, v34
    v_xor_b32 v43, 0x80008000, v35
    v_mul_f32 v4, 0x3a000000, v2
    v_mul_f32 v3, 0x41000000, v3
    v_mul_f32_e64 v5, v3, v4
    v_fmamk_f32 v6, v4, 0x00000000, v5
    v_cos_f32 v68, v6
    v_sin_f32 v76, v6
    v_fmamk_f32 v7, v4, 0x3f800000, v5
    v_cos_f32 v69, v7
    v_sin_f32 v77, v7
    v_fmamk_f32 v6, v4, 0x40000000, v5
    v_cos_f32 v70, v6
    v_sin_f32 v78, v6
    v_fmamk_f32 v7, v4, 0x40400000, v5
    v_cos_f32 v71, v7
    v_sin_f32 v79, v7
    v_fmamk_f32 v6, v4, 0x40800000, v5
    v_cos_f32 v72, v6
    v_sin_f32 v80, v6
    v_fmamk_f32 v7, v4, 0x40a00000, v5
    v_cos_f32 v73, v7
    v_sin_f32 v81, v7
    v_fmamk_f32 v6, v4, 0x40c00000, v5
    v_cos_f32 v74, v6
    v_sin_f32 v82, v6
    v_fmamk_f32 v7, v4, 0x40e00000, v5
    v_cos_f32 v75, v7
    v_sin_f32 v83, v7
    v_bfe_u32 v2, v1, 2, 2
    v_and_b32 v4, 3, v1
    v_lshl_add_u32 v2, v2, 3, v4
    v_cvt_f32_u32 v2, v2
    v_mul_f32 v4, 0x3d000000, v2
    v_add_f32 v8, 0x3e000000, v4
    v_mul_f32 v5, v3, v4
    v_mul_f32 v9, v3, v8
    v_cos_f32 v196, v4
    v_sin_f32 v197, v4
    v_cos_f32 v198, v8
    v_sin_f32 v199, v8
    v_fmamk_f32 v6, v4, 0x00000000, v5
    v_cos_f32 v200, v6
    v_sin_f32 v201, v6
    v_fmamk_f32 v7, v4, 0x40800000, v5
    v_cos_f32 v208, v7
    v_sin_f32 v209, v7
    v_fmamk_f32 v6, v8, 0x00000000, v9
    v_cos_f32 v216, v6
    v_sin_f32 v217, v6
    v_fmamk_f32 v7, v8, 0x40800000, v9
    v_cos_f32 v224, v7
    v_sin_f32 v225, v7
    v_pk_mul_f32 v[202:203], v[200:201], v[196:197] op_sel_hi:[1,0]
    v_pk_mul_f32 v[210:211], v[208:209], v[196:197] op_sel_hi:[1,0]
    v_pk_mul_f32 v[218:219], v[216:217], v[198:199] op_sel_hi:[1,0]
    v_pk_mul_f32 v[226:227], v[224:225], v[198:199] op_sel_hi:[1,0]
    v_pk_fma_f32 v[202:203], v[200:201], v[196:197], v[202:203] op_sel:[1,1,0] op_sel_hi:[0,1,1] neg_lo:[1,0,0]
    v_pk_fma_f32 v[210:211], v[208:209], v[196:197], v[210:211] op_sel:[1,1,0] op_sel_hi:[0,1,1] neg_lo:[1,0,0]
    v_pk_fma_f32 v[218:219], v[216:217], v[198:199], v[218:219] op_sel:[1,1,0] op_sel_hi:[0,1,1] neg_lo:[1,0,0]
    v_pk_fma_f32 v[226:227], v[224:225], v[198:199], v[226:227] op_sel:[1,1,0] op_sel_hi:[0,1,1] neg_lo:[1,0,0]
    v_pk_mul_f32 v[204:205], v[202:203], v[196:197] op_sel_hi:[1,0]
    v_pk_mul_f32 v[212:213], v[210:211], v[196:197] op_sel_hi:[1,0]
    v_pk_mul_f32 v[220:221], v[218:219], v[198:199] op_sel_hi:[1,0]
    v_pk_mul_f32 v[228:229], v[226:227], v[198:199] op_sel_hi:[1,0]
    v_pk_fma_f32 v[204:205], v[202:203], v[196:197], v[204:205] op_sel:[1,1,0] op_sel_hi:[0,1,1] neg_lo:[1,0,0]
    v_pk_fma_f32 v[212:213], v[210:211], v[196:197], v[212:213] op_sel:[1,1,0] op_sel_hi:[0,1,1] neg_lo:[1,0,0]
    v_pk_fma_f32 v[220:221], v[218:219], v[198:199], v[220:221] op_sel:[1,1,0] op_sel_hi:[0,1,1] neg_lo:[1,0,0]
    v_pk_fma_f32 v[228:229], v[226:227], v[198:199], v[228:229] op_sel:[1,1,0] op_sel_hi:[0,1,1] neg_lo:[1,0,0]
    v_pk_mul_f32 v[206:207], v[204:205], v[196:197] op_sel_hi:[1,0]
    v_pk_mul_f32 v[214:215], v[212:213], v[196:197] op_sel_hi:[1,0]
    v_pk_mul_f32 v[222:223], v[220:221], v[198:199] op_sel_hi:[1,0]
    v_pk_mul_f32 v[230:231], v[228:229], v[198:199] op_sel_hi:[1,0]
    v_pk_fma_f32 v[206:207], v[204:205], v[196:197], v[206:207] op_sel:[1,1,0] op_sel_hi:[0,1,1] neg_lo:[1,0,0]
    v_pk_fma_f32 v[214:215], v[212:213], v[196:197], v[214:215] op_sel:[1,1,0] op_sel_hi:[0,1,1] neg_lo:[1,0,0]
    v_pk_fma_f32 v[222:223], v[220:221], v[198:199], v[222:223] op_sel:[1,1,0] op_sel_hi:[0,1,1] neg_lo:[1,0,0]
    v_pk_fma_f32 v[230:231], v[228:229], v[198:199], v[230:231] op_sel:[1,1,0] op_sel_hi:[0,1,1] neg_lo:[1,0,0]
    v_cvt_pk_bf16_f32 v44, v200, v202
    v_cvt_pk_bf16_f32 v52, v201, v203
    v_cvt_pk_bf16_f32 v45, v204, v206
    v_cvt_pk_bf16_f32 v53, v205, v207
    v_cvt_pk_bf16_f32 v46, v208, v210
    v_cvt_pk_bf16_f32 v54, v209, v211
    v_cvt_pk_bf16_f32 v47, v212, v214
    v_cvt_pk_bf16_f32 v55, v213, v215
    v_cvt_pk_bf16_f32 v48, v216, v218
    v_cvt_pk_bf16_f32 v56, v217, v219
    v_cvt_pk_bf16_f32 v49, v220, v222
    v_cvt_pk_bf16_f32 v57, v221, v223
    v_cvt_pk_bf16_f32 v50, v224, v226
    v_cvt_pk_bf16_f32 v58, v225, v227
    v_cvt_pk_bf16_f32 v51, v228, v230
    v_cvt_pk_bf16_f32 v59, v229, v231
    v_xor_b32 v60, 0x80008000, v52
    v_xor_b32 v61, 0x80008000, v53
    v_xor_b32 v62, 0x80008000, v54
    v_xor_b32 v63, 0x80008000, v55
    v_xor_b32 v64, 0x80008000, v56
    v_xor_b32 v65, 0x80008000, v57
    v_xor_b32 v66, 0x80008000, v58
    v_xor_b32 v67, 0x80008000, v59
    v_bfe_u32 v2, v1, 1, 1
    v_bfe_u32 v3, v1, 3, 1
    v_lshl_or_b32 v2, v3, 1, v2
    v_lshrrev_b32 v3, 4, v1
    v_xor_b32 v2, v2, v3
    v_lshlrev_b32_e64 v2, 4, v2
    v_bfe_u32 v3, v1, 2, 1
    v_lshl_or_b32 v2, v3, 3, v2
    v_and_b32 v3, 15, v1
    v_lshl_add_u32 v2, v3, 6, v2
    s_lshl_b32 s32, s28, 10
    s_add_u32 s32, s32, 81920
    v_add_u32 v16, s32, v2
    v_xor_b32 v17, 8, v16
    v_bfe_u32 v2, v1, 3, 1
    v_bfe_u32 v3, v1, 5, 1
    v_lshl_or_b32 v2, v3, 1, v2
    v_and_b32_e64 v3, 3, v1
    v_xor_b32 v2, v2, v3
    v_lshlrev_b32 v2, 4, v2
    v_bfe_u32 v3, v1, 4, 1
    v_lshl_or_b32 v2, v3, 3, v2
    v_lshrrev_b32_e64 v3, 2, v1
    v_lshl_add_u32 v2, v3, 6, v2
    v_add_u32 v14, 81920, v2
    v_xor_b32 v15, 8, v14
    v_bfe_u32 v2, v1, 3, 1
    s_lshl_b32 s32, s28, 1
    v_add_u32 v2, s32, v2
    v_lshrrev_b32 v3, 4, v1
    v_lshl_add_u32 v2, v2, 2, v3
    v_and_b32 v4, 7, v1
    v_lshlrev_b32 v4, 4, v4
    v_lshl_add_u32 v147, v2, 7, v4
    s_mov_b32 s32, 81920
    v_mad_u32_u24 v13, v2, s32, v4
    s_lshr_b32 s33, s2, 3
    s_lshl_b32 s33, s33, 12
    s_and_b32 s34, s2, 7
    s_lshl_b32 s34, s34, 8
    s_add_u32 s33, s33, s34
    s_mov_b32 s34, 2621440
    s_add_u32 s35, s34, 4096
    s_lshl_b32 s36, s2, 14
    s_lshl_b32 s37, s28, 11
    s_add_u32 s36, s36, s37
    s_add_u32 s36, s36, 7340032
    s_add_u32 s37, s36, 8192
    s_and_b32 s32, s2, 0xe0
    s_lshl_b32 s38, s28, 1
    s_add_u32 s32, s32, s38
    s_lshl_b32 s32, s32, 7
    s_bfe_u32 s38, s2, 0x20003
    s_lshl_b32 s38, s38, 3
    s_add_u32 s32, s32, s38
    s_add_u32 s32, s32, 19136512
    v_and_b32 v6, 3, v1
    v_lshl_add_u32 v6, v6, 10, s32
    v_bfe_u32 v7, v1, 2, 1
    v_lshl_add_u32 v149, v7, 7, v6
    v_cmp_gt_u32 vcc, 8, v1
    s_nop 0
    s_nop 0
    v_cndmask_b32 v149, v143, v149, vcc
    v_cmp_gt_u32 vcc, 16, v1
    s_nop 0
    s_nop 0
    v_cndmask_b32 v149, v146, v149, vcc
    s_lshr_b32 s32, s28, 1
    s_lshl_b32 s32, s32, 3
    s_add_u32 s32, s32, s30
    s_lshl_b32 s32, s32, 7
    s_add_u32 s32, s32, 19156992
    v_min_u32_e64 v18, 19, v1
    v_and_b32 v7, 3, v18
    v_lshrrev_b32 v18, 2, v18
    v_lshl_add_u32 v18, v18, 11, s32
    v_lshl_add_u32 v18, v7, 3, v18
    v_lshlrev_b32 v10, 4, v1
    v_add_u32 v11, 20480, v10
    v_add_u32 v12, 40960, v10
    s_mul_i32 s44, s30, 12
    s_mul_i32 s32, s28, 3
    s_add_u32 s44, s44, s32
    s_mul_i32 s44, s44, 20480
    s_add_u32 s44, s44, 3145728
    v_bfe_u32 v2, v1, 2, 2
    v_and_b32_e64 v3, 3, v1
    v_lshl_add_u32 v2, v2, 3, v3
    s_mul_i32 s32, s30, 80
    v_add_u32 v2, s32, v2
    v_and_b32 v3, 15, v1
    v_add_u32 v3, s32, v3
    s_movk_i32 s9, 320
    v_add_u32 v4, 0, v2
    v_subrev_u32 v5, 640, v4
    v_cmp_le_u32 vcc, s9, v4
    s_nop 0
    s_nop 0
    v_cndmask_b32 v4, v4, v5, vcc
    v_cvt_f32_i32 v4, v4
    v_mul_f32 v0, 0x3acccccd, v4
    v_add_u32 v4, 4, v2
    v_subrev_u32 v5, 640, v4
    v_cmp_le_u32 vcc, s9, v4
    s_nop 0
    s_nop 0
    v_cndmask_b32 v4, v4, v5, vcc
    v_cvt_f32_i32 v4, v4
    v_mul_f32 v252, 0x3acccccd, v4
    v_add_u32 v4, 32, v2
    v_subrev_u32 v5, 640, v4
    v_cmp_le_u32 vcc, s9, v4
    s_nop 0
    s_nop 0
    v_cndmask_b32 v4, v4, v5, vcc
    v_cvt_f32_i32 v4, v4
    v_mul_f32 v253, 0x3acccccd, v4
    v_add_u32 v4, 36, v2
    v_subrev_u32 v5, 640, v4
    v_cmp_le_u32 vcc, s9, v4
    s_nop 0
    s_nop 0
    v_cndmask_b32 v4, v4, v5, vcc
    v_cvt_f32_i32 v4, v4
    v_mul_f32 v254, 0x3acccccd, v4
    v_add_u32 v4, 64, v3
    v_subrev_u32 v5, 640, v4
    v_cmp_le_u32 vcc, s9, v4
    s_nop 0
    s_nop 0
    v_cndmask_b32 v4, v4, v5, vcc
    v_cvt_f32_i32 v4, v4
    v_mul_f32 v255, 0x3acccccd, v4
    v_lshrrev_b32 v2, 4, v1
    s_cmp_eq_u32 s28, 3
    s_cselect_b32 s9, 3, 4
    v_cmp_eq_u32 s[48:49], s9, v2
    s_mul_i32 s31, s28, 5
    s_mul_i32 s32, s28, 10240
    s_add_u32 s32, s32, 114688
    v_add_u32 v19, s32, v10
    s_lshl_b32 s38, s28, 14
    s_add_u32 s38, s38, 2686976
    buffer_load_dwordx2 v[150:151], v149, s[20:23], 0 offen sc1
    v_mul_f32_e64 v4, 4.0, v0
    v_cos_f32 v196, v4
    v_sin_f32_e64 v197, -v4
    v_mul_f32 v5, 4.0, v252
    v_cos_f32 v198, v5
    v_sin_f32_e64 v199, -v5
    v_mul_f32 v4, 4.0, v253
    v_cos_f32 v200, v4
    v_sin_f32_e64 v201, -v4
    v_mul_f32 v5, 4.0, v254
    v_cos_f32 v202, v5
    v_sin_f32_e64 v203, -v5
    v_mul_f32 v4, 4.0, v255
    v_cos_f32 v204, v4
    v_sin_f32_e64 v205, -v4
    s_add_u32 s9, s31, 0
    s_lshr_b32 s51, s9, 2
    s_lshl_b32 s51, s51, 6
    s_and_b32 s9, s9, 3
    s_add_u32 s9, s9, s51
    s_add_u32 s9, s9, 1
    v_and_b32 v3, 48, v1
    v_add_u32 v3, s9, v3
    v_cvt_f32_u32 v3, v3
    v_mul_f32 v4, v3, v0
    v_cos_f32 v206, v4
    v_sin_f32_e64 v207, -v4
    v_mul_f32 v5, v3, v252
    v_cos_f32 v214, v5
    v_sin_f32_e64 v215, -v5
    v_mul_f32 v4, v3, v253
    v_cos_f32 v222, v4
    v_sin_f32_e64 v223, -v4
    v_mul_f32 v5, v3, v254
    v_cos_f32 v230, v5
    v_sin_f32_e64 v231, -v5
    v_mul_f32 v4, v3, v255
    v_cos_f32 v238, v4
    v_sin_f32_e64 v239, -v4
    s_mov_b32 s8, 0x3b4ccccd
    v_pk_mul_f32 v[206:207], v[206:207], s[8:9] op_sel_hi:[1,0]
    v_pk_mul_f32 v[214:215], v[214:215], s[8:9] op_sel_hi:[1,0]
    v_pk_mul_f32 v[222:223], v[222:223], s[8:9] op_sel_hi:[1,0]
    v_pk_mul_f32 v[230:231], v[230:231], s[8:9] op_sel_hi:[1,0]
    v_pk_mul_f32 v[238:239], v[238:239], s[8:9] op_sel_hi:[1,0]
    v_pk_mul_f32 v[208:209], v[206:207], v[196:197] op_sel_hi:[1,0]
    v_pk_mul_f32 v[216:217], v[214:215], v[198:199] op_sel_hi:[1,0]
    v_pk_mul_f32 v[224:225], v[222:223], v[200:201] op_sel_hi:[1,0]
    v_pk_mul_f32 v[232:233], v[230:231], v[202:203] op_sel_hi:[1,0]
    v_pk_mul_f32 v[240:241], v[238:239], v[204:205] op_sel_hi:[1,0]
    v_pk_fma_f32 v[208:209], v[206:207], v[196:197], v[208:209] op_sel:[1,1,0] op_sel_hi:[0,1,1] neg_lo:[1,0,0]
    v_pk_fma_f32 v[216:217], v[214:215], v[198:199], v[216:217] op_sel:[1,1,0] op_sel_hi:[0,1,1] neg_lo:[1,0,0]
    v_pk_fma_f32 v[224:225], v[222:223], v[200:201], v[224:225] op_sel:[1,1,0] op_sel_hi:[0,1,1] neg_lo:[1,0,0]
    v_pk_fma_f32 v[232:233], v[230:231], v[202:203], v[232:233] op_sel:[1,1,0] op_sel_hi:[0,1,1] neg_lo:[1,0,0]
    v_pk_fma_f32 v[240:241], v[238:239], v[204:205], v[240:241] op_sel:[1,1,0] op_sel_hi:[0,1,1] neg_lo:[1,0,0]
    v_pk_mul_f32 v[210:211], v[208:209], v[196:197] op_sel_hi:[1,0]
    v_pk_mul_f32 v[218:219], v[216:217], v[198:199] op_sel_hi:[1,0]
    v_pk_mul_f32 v[226:227], v[224:225], v[200:201] op_sel_hi:[1,0]
    v_pk_mul_f32 v[234:235], v[232:233], v[202:203] op_sel_hi:[1,0]
    v_pk_mul_f32 v[242:243], v[240:241], v[204:205] op_sel_hi:[1,0]
    v_pk_fma_f32 v[210:211], v[208:209], v[196:197], v[210:211] op_sel:[1,1,0] op_sel_hi:[0,1,1] neg_lo:[1,0,0]
    v_pk_fma_f32 v[218:219], v[216:217], v[198:199], v[218:219] op_sel:[1,1,0] op_sel_hi:[0,1,1] neg_lo:[1,0,0]
    v_pk_fma_f32 v[226:227], v[224:225], v[200:201], v[226:227] op_sel:[1,1,0] op_sel_hi:[0,1,1] neg_lo:[1,0,0]
    v_pk_fma_f32 v[234:235], v[232:233], v[202:203], v[234:235] op_sel:[1,1,0] op_sel_hi:[0,1,1] neg_lo:[1,0,0]
    v_pk_fma_f32 v[242:243], v[240:241], v[204:205], v[242:243] op_sel:[1,1,0] op_sel_hi:[0,1,1] neg_lo:[1,0,0]
    v_pk_mul_f32 v[212:213], v[210:211], v[196:197] op_sel_hi:[1,0]
    v_pk_mul_f32 v[220:221], v[218:219], v[198:199] op_sel_hi:[1,0]
    v_pk_mul_f32 v[228:229], v[226:227], v[200:201] op_sel_hi:[1,0]
    v_pk_mul_f32 v[236:237], v[234:235], v[202:203] op_sel_hi:[1,0]
    v_pk_mul_f32 v[244:245], v[242:243], v[204:205] op_sel_hi:[1,0]
    v_pk_fma_f32 v[212:213], v[210:211], v[196:197], v[212:213] op_sel:[1,1,0] op_sel_hi:[0,1,1] neg_lo:[1,0,0]
    v_pk_fma_f32 v[220:221], v[218:219], v[198:199], v[220:221] op_sel:[1,1,0] op_sel_hi:[0,1,1] neg_lo:[1,0,0]
    v_pk_fma_f32 v[228:229], v[226:227], v[200:201], v[228:229] op_sel:[1,1,0] op_sel_hi:[0,1,1] neg_lo:[1,0,0]
    v_pk_fma_f32 v[236:237], v[234:235], v[202:203], v[236:237] op_sel:[1,1,0] op_sel_hi:[0,1,1] neg_lo:[1,0,0]
    v_pk_fma_f32 v[244:245], v[242:243], v[204:205], v[244:245] op_sel:[1,1,0] op_sel_hi:[0,1,1] neg_lo:[1,0,0]
    v_cvt_pk_bf16_f32 v152, v206, v208
    v_cvt_pk_bf16_f32 v154, v207, v209
    v_cvt_pk_bf16_f32 v153, v210, v212
    v_cvt_pk_bf16_f32 v155, v211, v213
    ds_write_b128 v19, v[152:155] offset:0
    v_cvt_pk_bf16_f32 v156, v214, v216
    v_cvt_pk_bf16_f32 v158, v215, v217
    v_cvt_pk_bf16_f32 v157, v218, v220
    v_cvt_pk_bf16_f32 v159, v219, v221
    ds_write_b128 v19, v[156:159] offset:1024
    v_cvt_pk_bf16_f32 v160, v222, v224
    v_cvt_pk_bf16_f32 v162, v223, v225
    v_cvt_pk_bf16_f32 v161, v226, v228
    v_cvt_pk_bf16_f32 v163, v227, v229
    ds_write_b128 v19, v[160:163] offset:2048
    v_cvt_pk_bf16_f32 v164, v230, v232
    v_cvt_pk_bf16_f32 v166, v231, v233
    v_cvt_pk_bf16_f32 v165, v234, v236
    v_cvt_pk_bf16_f32 v167, v235, v237
    ds_write_b128 v19, v[164:167] offset:3072
    v_cvt_pk_bf16_f32 v168, v238, v240
    v_cvt_pk_bf16_f32 v170, v239, v241
    v_cvt_pk_bf16_f32 v169, v242, v244
    v_cvt_pk_bf16_f32 v171, v243, v245
    ds_write_b128 v19, v[168:171] offset:4096
    s_waitcnt vmcnt(0)
    v_cmp_ne_u64 vcc, s[10:11], v[150:151]
    s_cbranch_vccnz kf_rt_f1
kf_ok_f1:
    buffer_load_dwordx4 v[148:151], v13, s[20:23], s33 offen offset:0 sc1
    buffer_load_dwordx4 v[188:191], v147, s[20:23], s34 offen sc1
    buffer_load_dwordx4 v[192:195], v147, s[20:23], s35 offen sc1
    buffer_load_dwordx4 v[152:155], v13, s[20:23], s33 offen offset:2048 sc1
    buffer_load_dwordx4 v[156:159], v13, s[20:23], s33 offen offset:128 sc1
    buffer_load_dwordx4 v[160:163], v13, s[20:23], s33 offen offset:2176 sc1
    s_and_b32 s32, s29, 3
    s_lshl_b32 s32, s32, 3
    s_lshr_b32 s38, s29, 2
    s_add_u32 s32, s32, s38
    s_lshl_b32 s32, s32, 7
    s_add_u32 s32, s32, 19136512
    s_lshl_b32 s38, s38, 7
    s_add_u32 s38, s38, 19167232
    v_lshrrev_b32 v2, 2, v1
    v_lshl_add_u32 v2, v2, 12, s32
    v_and_b32 v3, 3, v1
    v_lshl_add_u32 v2, v3, 3, v2
    v_and_b32 v3, 1, v1
    v_lshl_add_u32 v3, v3, 10, s38
    v_cmp_gt_u32 vcc, 20, v1
    s_nop 0
    s_nop 0
    v_cndmask_b32 v2, v3, v2, vcc
    buffer_load_dwordx2 v[6:7], v2, s[20:23], 0 offen sc1
    buffer_load_dwordx4 v[92:95], v10, s[20:23], s36 offen offset:0 sc1
    buffer_load_dwordx4 v[96:99], v10, s[20:23], s36 offen offset:1024 sc1
    buffer_load_dwordx4 v[108:111], v10, s[20:23], s37 offen offset:0 sc1
    buffer_load_dwordx4 v[112:115], v10, s[20:23], s37 offen offset:1024 sc1
    s_add_u32 s9, s31, 1
    s_lshr_b32 s51, s9, 2
    s_lshl_b32 s51, s51, 6
    s_and_b32 s9, s9, 3
    s_add_u32 s9, s9, s51
    s_add_u32 s9, s9, 1
    v_and_b32 v3, 48, v1
    v_add_u32 v3, s9, v3
    v_cvt_f32_u32 v3, v3
    v_mul_f32 v4, v3, v0
    v_cos_f32 v206, v4
    v_sin_f32_e64 v207, -v4
    v_mul_f32 v5, v3, v252
    v_cos_f32 v214, v5
    v_sin_f32_e64 v215, -v5
    v_mul_f32 v4, v3, v253
    v_cos_f32 v222, v4
    v_sin_f32_e64 v223, -v4
    v_mul_f32 v5, v3, v254
    v_cos_f32 v230, v5
    v_sin_f32_e64 v231, -v5
    v_mul_f32 v4, v3, v255
    v_cos_f32_e64 v238, v4
    v_sin_f32_e64 v239, -v4
    s_mov_b32 s8, 0x3b4ccccd
    v_pk_mul_f32 v[206:207], v[206:207], s[8:9] op_sel_hi:[1,0]
    v_pk_mul_f32 v[214:215], v[214:215], s[8:9] op_sel_hi:[1,0]
    v_pk_mul_f32 v[222:223], v[222:223], s[8:9] op_sel_hi:[1,0]
    v_pk_mul_f32 v[230:231], v[230:231], s[8:9] op_sel_hi:[1,0]
    v_pk_mul_f32 v[238:239], v[238:239], s[8:9] op_sel_hi:[1,0]
    v_pk_mul_f32 v[208:209], v[206:207], v[196:197] op_sel_hi:[1,0]
    v_pk_mul_f32 v[216:217], v[214:215], v[198:199] op_sel_hi:[1,0]
    v_pk_mul_f32 v[224:225], v[222:223], v[200:201] op_sel_hi:[1,0]
    v_pk_mul_f32 v[232:233], v[230:231], v[202:203] op_sel_hi:[1,0]
    v_pk_mul_f32 v[240:241], v[238:239], v[204:205] op_sel_hi:[1,0]
    v_pk_fma_f32 v[208:209], v[206:207], v[196:197], v[208:209] op_sel:[1,1,0] op_sel_hi:[0,1,1] neg_lo:[1,0,0]
    v_pk_fma_f32 v[216:217], v[214:215], v[198:199], v[216:217] op_sel:[1,1,0] op_sel_hi:[0,1,1] neg_lo:[1,0,0]
    v_pk_fma_f32 v[224:225], v[222:223], v[200:201], v[224:225] op_sel:[1,1,0] op_sel_hi:[0,1,1] neg_lo:[1,0,0]
    v_pk_fma_f32 v[232:233], v[230:231], v[202:203], v[232:233] op_sel:[1,1,0] op_sel_hi:[0,1,1] neg_lo:[1,0,0]
    v_pk_fma_f32 v[240:241], v[238:239], v[204:205], v[240:241] op_sel:[1,1,0] op_sel_hi:[0,1,1] neg_lo:[1,0,0]
    v_pk_mul_f32 v[210:211], v[208:209], v[196:197] op_sel_hi:[1,0]
    v_pk_mul_f32 v[218:219], v[216:217], v[198:199] op_sel_hi:[1,0]
    v_pk_mul_f32 v[226:227], v[224:225], v[200:201] op_sel_hi:[1,0]
    v_pk_mul_f32 v[234:235], v[232:233], v[202:203] op_sel_hi:[1,0]
    v_pk_mul_f32 v[242:243], v[240:241], v[204:205] op_sel_hi:[1,0]
    v_pk_fma_f32 v[210:211], v[208:209], v[196:197], v[210:211] op_sel:[1,1,0] op_sel_hi:[0,1,1] neg_lo:[1,0,0]
    v_pk_fma_f32 v[218:219], v[216:217], v[198:199], v[218:219] op_sel:[1,1,0] op_sel_hi:[0,1,1] neg_lo:[1,0,0]
    v_pk_fma_f32 v[226:227], v[224:225], v[200:201], v[226:227] op_sel:[1,1,0] op_sel_hi:[0,1,1] neg_lo:[1,0,0]
    v_pk_fma_f32 v[234:235], v[232:233], v[202:203], v[234:235] op_sel:[1,1,0] op_sel_hi:[0,1,1] neg_lo:[1,0,0]
    v_pk_fma_f32 v[242:243], v[240:241], v[204:205], v[242:243] op_sel:[1,1,0] op_sel_hi:[0,1,1] neg_lo:[1,0,0]
    v_pk_mul_f32 v[212:213], v[210:211], v[196:197] op_sel_hi:[1,0]
    v_pk_mul_f32 v[220:221], v[218:219], v[198:199] op_sel_hi:[1,0]
    v_pk_mul_f32 v[228:229], v[226:227], v[200:201] op_sel_hi:[1,0]
    v_pk_mul_f32 v[236:237], v[234:235], v[202:203] op_sel_hi:[1,0]
    v_pk_mul_f32 v[244:245], v[242:243], v[204:205] op_sel_hi:[1,0]
    v_pk_fma_f32 v[212:213], v[210:211], v[196:197], v[212:213] op_sel:[1,1,0] op_sel_hi:[0,1,1] neg_lo:[1,0,0]
    v_pk_fma_f32 v[220:221], v[218:219], v[198:199], v[220:221] op_sel:[1,1,0] op_sel_hi:[0,1,1] neg_lo:[1,0,0]
    v_pk_fma_f32 v[228:229], v[226:227], v[200:201], v[228:229] op_sel:[1,1,0] op_sel_hi:[0,1,1] neg_lo:[1,0,0]
    v_pk_fma_f32 v[236:237], v[234:235], v[202:203], v[236:237] op_sel:[1,1,0] op_sel_hi:[0,1,1] neg_lo:[1,0,0]
    v_pk_fma_f32 v[244:245], v[242:243], v[204:205], v[244:245] op_sel:[1,1,0] op_sel_hi:[0,1,1] neg_lo:[1,0,0]
    v_cvt_pk_bf16_f32 v164, v206, v208
    v_cvt_pk_bf16_f32 v166, v207, v209
    v_cvt_pk_bf16_f32 v165, v210, v212
    v_cvt_pk_bf16_f32 v167, v211, v213
    ds_write_b128 v19, v[164:167] offset:5120
    v_cvt_pk_bf16_f32 v168, v214, v216
    v_cvt_pk_bf16_f32 v170, v215, v217
    v_cvt_pk_bf16_f32 v169, v218, v220
    v_cvt_pk_bf16_f32 v171, v219, v221
    ds_write_b128 v19, v[168:171] offset:6144
    v_cvt_pk_bf16_f32 v172, v222, v224
    v_cvt_pk_bf16_f32 v174, v223, v225
    v_cvt_pk_bf16_f32 v173, v226, v228
    v_cvt_pk_bf16_f32 v175, v227, v229
    ds_write_b128 v19, v[172:175] offset:7168
    v_cvt_pk_bf16_f32 v176, v230, v232
    v_cvt_pk_bf16_f32 v178, v231, v233
    v_cvt_pk_bf16_f32 v177, v234, v236
    v_cvt_pk_bf16_f32 v179, v235, v237
    ds_write_b128 v19, v[176:179] offset:8192
    v_cvt_pk_bf16_f32 v180, v238, v240
    v_cvt_pk_bf16_f32 v182, v239, v241
    v_cvt_pk_bf16_f32 v181, v242, v244
    v_cvt_pk_bf16_f32 v183, v243, v245
    ds_write_b128 v19, v[180:183] offset:9216
    s_waitcnt vmcnt(8)
    v_lshlrev_b32 v116, 16, v148
    v_and_b32 v117, 0xffff0000, v148
    v_pk_mul_f32 v[244:245], v[116:117], v[188:189]
    v_lshlrev_b32_e64 v118, 16, v149
    v_and_b32 v119, 0xffff0000, v149
    v_pk_mul_f32 v[246:247], v[118:119], v[190:191]
    v_lshlrev_b32_e64 v120, 16, v150
    v_and_b32 v121, 0xffff0000, v150
    v_pk_mul_f32 v[248:249], v[120:121], v[192:193]
    v_lshlrev_b32_e64 v122, 16, v151
    v_and_b32 v123, 0xffff0000, v151
    v_pk_mul_f32 v[250:251], v[122:123], v[194:195]
    v_cvt_pk_bf16_f32 v172, v244, v245
    v_cvt_pk_bf16_f32 v173, v246, v247
    v_cvt_pk_bf16_f32 v174, v248, v249
    v_cvt_pk_bf16_f32 v175, v250, v251
    ds_write_b64 v16, v[172:173] offset:0
    ds_write_b64 v17, v[174:175] offset:0
    s_waitcnt vmcnt(7)
    v_lshlrev_b32 v124, 16, v152
    v_and_b32 v125, 0xffff0000, v152
    v_pk_mul_f32 v[244:245], v[124:125], v[188:189]
    v_lshlrev_b32_e64 v126, 16, v153
    v_and_b32 v127, 0xffff0000, v153
    v_pk_mul_f32 v[246:247], v[126:127], v[190:191]
    v_lshlrev_b32_e64 v128, 16, v154
    v_and_b32 v129, 0xffff0000, v154
    v_pk_mul_f32 v[248:249], v[128:129], v[192:193]
    v_lshlrev_b32_e64 v130, 16, v155
    v_and_b32 v131, 0xffff0000, v155
    v_pk_mul_f32 v[250:251], v[130:131], v[194:195]
    v_cvt_pk_bf16_f32 v176, v244, v245
    v_cvt_pk_bf16_f32 v177, v246, v247
    v_cvt_pk_bf16_f32 v178, v248, v249
    v_cvt_pk_bf16_f32 v179, v250, v251
    ds_write_b64 v16, v[176:177] offset:4096
    ds_write_b64 v17, v[178:179] offset:4096
    s_waitcnt vmcnt(6)
    v_lshlrev_b32 v132, 16, v156
    v_and_b32 v133, 0xffff0000, v156
    v_pk_mul_f32 v[244:245], v[132:133], v[188:189]
    v_lshlrev_b32_e64 v134, 16, v157
    v_and_b32 v135, 0xffff0000, v157
    v_pk_mul_f32 v[246:247], v[134:135], v[190:191]
    v_lshlrev_b32_e64 v136, 16, v158
    v_and_b32 v137, 0xffff0000, v158
    v_pk_mul_f32 v[248:249], v[136:137], v[192:193]
    v_lshlrev_b32_e64 v138, 16, v159
    v_and_b32 v139, 0xffff0000, v159
    v_pk_mul_f32 v[250:251], v[138:139], v[194:195]
    v_cvt_pk_bf16_f32 v180, v244, v245
    v_cvt_pk_bf16_f32 v181, v246, v247
    v_cvt_pk_bf16_f32 v182, v248, v249
    v_cvt_pk_bf16_f32 v183, v250, v251
    ds_write_b64 v16, v[180:181] offset:8192
    ds_write_b64 v17, v[182:183] offset:8192
    s_waitcnt vmcnt(5)
    v_lshlrev_b32 v140, 16, v160
    v_and_b32 v141, 0xffff0000, v160
    v_pk_mul_f32 v[244:245], v[140:141], v[188:189]
    v_lshlrev_b32_e64 v142, 16, v161
    v_and_b32 v143, 0xffff0000, v161
    v_pk_mul_f32 v[246:247], v[142:143], v[190:191]
    v_lshlrev_b32_e64 v144, 16, v162
    v_and_b32 v145, 0xffff0000, v162
    v_pk_mul_f32 v[248:249], v[144:145], v[192:193]
    v_lshlrev_b32_e64 v146, 16, v163
    v_and_b32 v147, 0xffff0000, v163
    v_pk_mul_f32 v[250:251], v[146:147], v[194:195]
    v_cvt_pk_bf16_f32 v184, v244, v245
    v_cvt_pk_bf16_f32 v185, v246, v247
    v_cvt_pk_bf16_f32 v186, v248, v249
    v_cvt_pk_bf16_f32 v187, v250, v251
    ds_write_b64 v16, v[184:185] offset:12288
    ds_write_b64 v17, v[186:187] offset:12288
    s_waitcnt lgkmcnt(0)
    s_barrier
    ds_read_b64_tr_b16 v[148:149], v14 offset:0
    ds_read_b64_tr_b16 v[150:151], v14 offset:1024
    ds_read_b64_tr_b16 v[156:157], v15 offset:0
    ds_read_b64_tr_b16 v[158:159], v15 offset:1024
    ds_read_b64_tr_b16 v[164:165], v14 offset:4096
    ds_read_b64_tr_b16 v[166:167], v14 offset:5120
    ds_read_b64_tr_b16 v[172:173], v15 offset:4096
    ds_read_b64_tr_b16 v[174:175], v15 offset:5120
    ds_read_b64_tr_b16 v[152:153], v14 offset:2048
    ds_read_b64_tr_b16 v[154:155], v14 offset:3072
    ds_read_b64_tr_b16 v[160:161], v15 offset:2048
    ds_read_b64_tr_b16 v[162:163], v15 offset:3072
    buffer_load_dwordx2 v[8:9], v18, s[20:23], 0 offen sc1
    s_waitcnt lgkmcnt(4)
    v_mfma_f32_16x16x32_bf16 v[212:215], v[148:151], v[20:23], 0
    ds_read_b64_tr_b16 v[168:169], v14 offset:6144
    v_mfma_f32_16x16x32_bf16 v[216:219], v[156:159], v[20:23], 0
    ds_read_b64_tr_b16 v[170:171], v14 offset:7168
    v_mfma_f32_16x16x32_bf16 v[220:223], v[164:167], v[20:23], 0
    ds_read_b64_tr_b16 v[176:177], v15 offset:6144
    v_mfma_f32_16x16x32_bf16 v[224:227], v[172:175], v[20:23], 0
    ds_read_b64_tr_b16 v[178:179], v15 offset:7168
    v_mfma_f32_16x16x32_bf16 v[212:215], v[164:167], v[28:31], v[212:215]
    ds_read_b64_tr_b16 v[180:181], v14 offset:8192
    v_mfma_f32_16x16x32_bf16 v[216:219], v[172:175], v[28:31], v[216:219]
    ds_read_b64_tr_b16 v[182:183], v14 offset:9216
    v_mfma_f32_16x16x32_bf16 v[220:223], v[148:151], v[36:39], v[220:223]
    ds_read_b64_tr_b16 v[188:189], v15 offset:8192
    v_mfma_f32_16x16x32_bf16 v[224:227], v[156:159], v[36:39], v[224:227]
    ds_read_b64_tr_b16 v[190:191], v15 offset:9216
    s_waitcnt lgkmcnt(4)
    s_waitcnt vmcnt(3)
    v_mfma_f32_16x16x32_bf16 v[212:215], v[152:155], v[24:27], v[212:215]
    ds_read_b64_tr_b16 v[196:197], v14 offset:12288
    v_lshlrev_b32 v84, 16, v92
    v_and_b32 v85, 0xffff0000, v92
    v_mfma_f32_16x16x32_bf16 v[216:219], v[160:163], v[24:27], v[216:219]
    ds_read_b64_tr_b16 v[198:199], v14 offset:13312
    v_lshlrev_b32_e64 v86, 16, v93
    v_and_b32 v87, 0xffff0000, v93
    v_mfma_f32_16x16x32_bf16 v[220:223], v[168:171], v[24:27], v[220:223]
    ds_read_b64_tr_b16 v[204:205], v15 offset:12288
    v_lshlrev_b32_e64 v92, 16, v94
    v_and_b32 v93, 0xffff0000, v94
    v_mfma_f32_16x16x32_bf16 v[224:227], v[176:179], v[24:27], v[224:227]
    ds_read_b64_tr_b16 v[206:207], v15 offset:13312
    v_lshlrev_b32_e64 v94, 16, v95
    v_and_b32 v95, 0xffff0000, v95
    v_mfma_f32_16x16x32_bf16 v[212:215], v[168:171], v[32:35], v[212:215]
    ds_read_b64_tr_b16 v[184:185], v14 offset:10240
    v_lshlrev_b32_e64 v88, 16, v96
    v_and_b32 v89, 0xffff0000, v96
    v_mfma_f32_16x16x32_bf16 v[216:219], v[176:179], v[32:35], v[216:219]
    ds_read_b64_tr_b16 v[186:187], v14 offset:11264
    v_lshlrev_b32_e64 v90, 16, v97
    v_and_b32 v91, 0xffff0000, v97
    v_mfma_f32_16x16x32_bf16 v[220:223], v[152:155], v[40:43], v[220:223]
    ds_read_b64_tr_b16 v[192:193], v15 offset:10240
    v_lshlrev_b32_e64 v96, 16, v98
    v_and_b32 v97, 0xffff0000, v98
    v_mfma_f32_16x16x32_bf16 v[224:227], v[160:163], v[40:43], v[224:227]
    ds_read_b64_tr_b16 v[194:195], v15 offset:11264
    v_lshlrev_b32 v98, 16, v99
    v_and_b32 v99, 0xffff0000, v99
    s_waitcnt lgkmcnt(4)
    ds_read_b64_tr_b16 v[200:201], v14 offset:14336
    ds_read_b64_tr_b16 v[202:203], v14 offset:15360
    ds_read_b64_tr_b16 v[208:209], v15 offset:14336
    ds_read_b64_tr_b16 v[210:211], v15 offset:15360
    s_waitcnt vmcnt(0)
    v_cmp_ne_u64 vcc, s[10:11], v[8:9]
    s_cbranch_vccnz kf_rt_wf
kf_ok_wf:
    v_cmp_ne_u64 vcc, s[10:11], v[6:7]
    s_cbranch_vccnz kf_rt_tf
kf_ok_tf:
    v_mfma_f32_16x16x32_bf16 v[228:231], v[180:183], v[20:23], 0
    v_lshlrev_b32 v100, 16, v108
    v_and_b32 v101, 0xffff0000, v108
    v_mfma_f32_16x16x32_bf16 v[232:235], v[188:191], v[20:23], 0
    v_lshlrev_b32_e64 v102, 16, v109
    v_and_b32 v103, 0xffff0000, v109
    v_mfma_f32_16x16x32_bf16 v[236:239], v[196:199], v[20:23], 0
    s_add_u32 s45, s44, 0
    buffer_load_dwordx4 a[0:3], v10, s[20:23], s45 offen offset:0 sc1
    v_lshlrev_b32 v108, 16, v110
    v_and_b32 v109, 0xffff0000, v110
    v_mfma_f32_16x16x32_bf16 v[240:243], v[204:207], v[20:23], 0
    v_lshlrev_b32_e64 v110, 16, v111
    v_and_b32 v111, 0xffff0000, v111
    v_mfma_f32_16x16x32_bf16 v[228:231], v[196:199], v[28:31], v[228:231]
    v_lshlrev_b32_e64 v104, 16, v112
    v_and_b32 v105, 0xffff0000, v112
    v_mfma_f32_16x16x32_bf16 v[232:235], v[204:207], v[28:31], v[232:235]
    v_lshlrev_b32_e64 v106, 16, v113
    v_and_b32 v107, 0xffff0000, v113
    buffer_load_dwordx4 a[4:7], v11, s[20:23], s45 offen offset:0 sc1
    v_mfma_f32_16x16x32_bf16 v[236:239], v[180:183], v[36:39], v[236:239]
    v_lshlrev_b32_e64 v112, 16, v114
    v_and_b32 v113, 0xffff0000, v114
    v_mfma_f32_16x16x32_bf16 v[240:243], v[188:191], v[36:39], v[240:243]
    v_lshlrev_b32 v114, 16, v115
    v_and_b32 v115, 0xffff0000, v115
    s_waitcnt lgkmcnt(0)
    v_mfma_f32_16x16x32_bf16 v[228:231], v[184:187], v[24:27], v[228:231]
    v_mul_f32 v244, v212, v68
    v_mul_f32 v246, v220, v68
    v_mfma_f32_16x16x32_bf16 v[232:235], v[192:195], v[24:27], v[232:235]
    buffer_load_dwordx4 a[8:11], v12, s[20:23], s45 offen offset:0 sc1
    v_mul_f32 v245, v213, v69
    v_mul_f32 v247, v221, v69
    v_mfma_f32_16x16x32_bf16 v[236:239], v[200:203], v[24:27], v[236:239]
    v_fmac_f32_e64 v244, v220, v76
    v_fma_f32 v246, -v212, v76, v246
    v_mfma_f32_16x16x32_bf16 v[240:243], v[208:211], v[24:27], v[240:243]
    v_fmac_f32_e64 v245, v221, v77
    v_fma_f32 v247, -v213, v77, v247
    v_mfma_f32_16x16x32_bf16 v[228:231], v[200:203], v[32:35], v[228:231]
    v_cvt_pk_bf16_f32 v148, v244, v245
    v_cvt_pk_bf16_f32 v152, v246, v247
    buffer_load_dwordx4 a[12:15], v10, s[20:23], s45 offen offset:1024 sc1
    v_mfma_f32_16x16x32_bf16 v[232:235], v[208:211], v[32:35], v[232:235]
    v_mul_f32 v248, v214, v70
    v_mul_f32 v250, v222, v70
    v_mfma_f32_16x16x32_bf16 v[236:239], v[184:187], v[40:43], v[236:239]
    v_mul_f32 v249, v215, v71
    v_mul_f32 v251, v223, v71
    v_mfma_f32_16x16x32_bf16 v[240:243], v[192:195], v[40:43], v[240:243]
    v_fmac_f32 v248, v222, v78
    v_fma_f32 v250, -v214, v78, v250
    v_fmac_f32 v249, v223, v79
    v_fma_f32 v251, -v215, v79, v251
    buffer_load_dwordx4 a[16:19], v11, s[20:23], s45 offen offset:1024 sc1
    v_cvt_pk_bf16_f32 v149, v248, v249
    v_cvt_pk_bf16_f32 v153, v250, v251
    v_pk_mul_f32 v[244:245], v[216:217], v[72:73]
    v_pk_mul_f32 v[246:247], v[224:225], v[72:73]
    v_pk_fma_f32 v[244:245], v[224:225], v[80:81], v[244:245]
    v_pk_fma_f32 v[246:247], v[216:217], v[80:81], v[246:247] neg_lo:[1,0,0] neg_hi:[1,0,0]
    v_cvt_pk_bf16_f32 v150, v244, v245
    v_cvt_pk_bf16_f32 v154, v246, v247
    v_pk_mul_f32 v[248:249], v[218:219], v[74:75]
    v_pk_mul_f32 v[250:251], v[226:227], v[74:75]
    v_pk_fma_f32 v[248:249], v[226:227], v[82:83], v[248:249]
    v_pk_fma_f32 v[250:251], v[218:219], v[82:83], v[250:251] neg_lo:[1,0,0] neg_hi:[1,0,0]
    v_cvt_pk_bf16_f32 v151, v248, v249
    v_cvt_pk_bf16_f32 v155, v250, v251
    buffer_load_dwordx4 a[20:23], v12, s[20:23], s45 offen offset:1024 sc1
    v_mfma_f32_16x16x32_bf16 v[212:215], v[44:47], v[148:151], 0
    v_mul_f32 v244, v228, v68
    v_mul_f32 v246, v236, v68
    v_mfma_f32_16x16x32_bf16 v[216:219], v[48:51], v[148:151], 0
    v_mul_f32 v245, v229, v69
    v_mul_f32 v247, v237, v69
    v_mfma_f32_16x16x32_bf16 v[220:223], v[44:47], v[152:155], 0
    v_fmac_f32_e64 v244, v236, v76
    v_fma_f32 v246, -v228, v76, v246
    v_mfma_f32_16x16x32_bf16 v[224:227], v[48:51], v[152:155], 0
    buffer_load_dwordx4 a[24:27], v10, s[20:23], s45 offen offset:2048 sc1
    v_fmac_f32_e64 v245, v237, v77
    v_fma_f32 v247, -v229, v77, v247
    v_mfma_f32_16x16x32_bf16 v[212:215], v[52:55], v[152:155], v[212:215]
    v_cvt_pk_bf16_f32 v180, v244, v245
    v_cvt_pk_bf16_f32 v184, v246, v247
    v_mfma_f32_16x16x32_bf16 v[216:219], v[56:59], v[152:155], v[216:219]
    v_mul_f32 v248, v230, v70
    v_mul_f32 v250, v238, v70
    v_mfma_f32_16x16x32_bf16 v[220:223], v[60:63], v[148:151], v[220:223]
    v_mul_f32 v249, v231, v71
    v_mul_f32 v251, v239, v71
    buffer_load_dwordx4 a[28:31], v11, s[20:23], s45 offen offset:2048 sc1
    v_mfma_f32_16x16x32_bf16 v[224:227], v[64:67], v[148:151], v[224:227]
    v_fmac_f32 v248, v238, v78
    v_fma_f32 v250, -v230, v78, v250
    v_fmac_f32 v249, v239, v79
    v_fma_f32 v251, -v231, v79, v251
    v_cvt_pk_bf16_f32 v181, v248, v249
    v_cvt_pk_bf16_f32 v185, v250, v251
    v_pk_mul_f32 v[244:245], v[232:233], v[72:73]
    v_pk_mul_f32 v[246:247], v[240:241], v[72:73]
    v_pk_fma_f32 v[244:245], v[240:241], v[80:81], v[244:245]
    v_pk_fma_f32 v[246:247], v[232:233], v[80:81], v[246:247] neg_lo:[1,0,0] neg_hi:[1,0,0]
    v_cvt_pk_bf16_f32 v182, v244, v245
    v_cvt_pk_bf16_f32 v186, v246, v247
    buffer_load_dwordx4 a[32:35], v12, s[20:23], s45 offen offset:2048 sc1
    v_pk_mul_f32 v[248:249], v[234:235], v[74:75]
    v_pk_mul_f32 v[250:251], v[242:243], v[74:75]
    v_pk_fma_f32 v[248:249], v[242:243], v[82:83], v[248:249]
    v_pk_fma_f32 v[250:251], v[234:235], v[82:83], v[250:251] neg_lo:[1,0,0] neg_hi:[1,0,0]
    v_cvt_pk_bf16_f32 v183, v248, v249
    v_cvt_pk_bf16_f32 v187, v250, v251
    s_nop 0
    v_mfma_f32_16x16x32_bf16 v[228:231], v[44:47], v[180:183], 0
    v_mul_f32 v244, v212, v84
    v_mul_f32 v246, v220, v84
    v_mfma_f32_16x16x32_bf16 v[232:235], v[48:51], v[180:183], 0
    v_mul_f32 v245, v213, v85
    v_mul_f32_e64 v247, v221, v85
    buffer_load_dwordx4 a[36:39], v10, s[20:23], s45 offen offset:3072 sc1
    v_mfma_f32_16x16x32_bf16 v[236:239], v[44:47], v[184:187], 0
    v_fma_f32 v244, -v220, v92, v244
    v_fmac_f32_e64 v246, v212, v92
    v_mfma_f32_16x16x32_bf16 v[240:243], v[48:51], v[184:187], 0
    v_fma_f32 v245, -v221, v93, v245
    v_fmac_f32_e64 v247, v213, v93
    v_mfma_f32_16x16x32_bf16 v[228:231], v[52:55], v[184:187], v[228:231]
    v_cvt_pk_bf16_f32 v148, v244, v245
    v_cvt_pk_bf16_f32 v152, v246, v247
    v_mfma_f32_16x16x32_bf16 v[232:235], v[56:59], v[184:187], v[232:235]
    buffer_load_dwordx4 a[40:43], v11, s[20:23], s45 offen offset:3072 sc1
    v_mul_f32 v248, v214, v86
    v_mul_f32 v250, v222, v86
    v_mfma_f32_16x16x32_bf16 v[236:239], v[60:63], v[180:183], v[236:239]
    v_mul_f32 v249, v215, v87
    v_mul_f32 v251, v223, v87
    v_mfma_f32_16x16x32_bf16 v[240:243], v[64:67], v[180:183], v[240:243]
    v_fma_f32 v248, -v222, v94, v248
    v_fmac_f32 v250, v214, v94
    v_fma_f32 v249, -v223, v95, v249
    v_fmac_f32 v251, v215, v95
    v_cvt_pk_bf16_f32 v149, v248, v249
    v_cvt_pk_bf16_f32 v153, v250, v251
    buffer_load_dwordx4 a[44:47], v12, s[20:23], s45 offen offset:3072 sc1
    v_pk_mul_f32 v[244:245], v[216:217], v[88:89]
    v_pk_mul_f32 v[246:247], v[224:225], v[88:89]
    v_pk_fma_f32 v[244:245], v[224:225], v[96:97], v[244:245] neg_lo:[1,0,0] neg_hi:[1,0,0]
    v_pk_fma_f32 v[246:247], v[216:217], v[96:97], v[246:247]
    v_cvt_pk_bf16_f32 v150, v244, v245
    v_cvt_pk_bf16_f32 v154, v246, v247
    v_pk_mul_f32 v[248:249], v[218:219], v[90:91]
    v_pk_mul_f32 v[250:251], v[226:227], v[90:91]
    v_pk_fma_f32 v[248:249], v[226:227], v[98:99], v[248:249] neg_lo:[1,0,0] neg_hi:[1,0,0]
    v_pk_fma_f32 v[250:251], v[218:219], v[98:99], v[250:251]
    v_cvt_pk_bf16_f32 v151, v248, v249
    v_cvt_pk_bf16_f32 v155, v250, v251
    s_nop 0
    v_mfma_f32_16x16x32_bf16 v[212:215], v[44:47], v[148:151], 0
    s_add_u32 s45, s44, 4096
    buffer_load_dwordx4 a[48:51], v10, s[20:23], s45 offen offset:0 sc1
    v_mul_f32 v244, v228, v100
    v_mul_f32_e64 v246, v236, v100
    v_mfma_f32_16x16x32_bf16 v[216:219], v[48:51], v[148:151], 0
    v_mul_f32 v245, v229, v101
    v_mul_f32 v247, v237, v101
    v_mfma_f32_16x16x32_bf16 v[220:223], v[44:47], v[152:155], 0
    v_fma_f32 v244, -v236, v108, v244
    v_fmac_f32_e64 v246, v228, v108
    v_mfma_f32_16x16x32_bf16 v[224:227], v[48:51], v[152:155], 0
    v_fma_f32 v245, -v237, v109, v245
    v_fmac_f32_e64 v247, v229, v109
    buffer_load_dwordx4 a[52:55], v11, s[20:23], s45 offen offset:0 sc1
    v_mfma_f32_16x16x32_bf16 v[212:215], v[60:63], v[152:155], v[212:215]
    v_cvt_pk_bf16_f32 v180, v244, v245
    v_cvt_pk_bf16_f32 v184, v246, v247
    v_mfma_f32_16x16x32_bf16 v[216:219], v[64:67], v[152:155], v[216:219]
    v_mul_f32 v248, v230, v102
    v_mul_f32 v250, v238, v102
    v_mfma_f32_16x16x32_bf16 v[220:223], v[52:55], v[148:151], v[220:223]
    v_mul_f32 v249, v231, v103
    v_mul_f32 v251, v239, v103
    v_mfma_f32_16x16x32_bf16 v[224:227], v[56:59], v[148:151], v[224:227]
    buffer_load_dwordx4 a[56:59], v12, s[20:23], s45 offen offset:0 sc1
    v_fma_f32 v248, -v238, v110, v248
    v_fmac_f32 v250, v230, v110
    v_fma_f32 v249, -v239, v111, v249
    v_fmac_f32 v251, v231, v111
    v_cvt_pk_bf16_f32 v181, v248, v249
    v_cvt_pk_bf16_f32 v185, v250, v251
    v_pk_mul_f32 v[244:245], v[232:233], v[104:105]
    v_pk_mul_f32 v[246:247], v[240:241], v[104:105]
    v_pk_fma_f32 v[244:245], v[240:241], v[112:113], v[244:245] neg_lo:[1,0,0] neg_hi:[1,0,0]
    v_pk_fma_f32 v[246:247], v[232:233], v[112:113], v[246:247]
    v_cvt_pk_bf16_f32 v182, v244, v245
    v_cvt_pk_bf16_f32 v186, v246, v247
    v_pk_mul_f32 v[248:249], v[234:235], v[106:107]
    v_pk_mul_f32 v[250:251], v[242:243], v[106:107]
    buffer_load_dwordx4 a[60:63], v10, s[20:23], s45 offen offset:1024 sc1
    v_pk_fma_f32 v[248:249], v[242:243], v[114:115], v[248:249] neg_lo:[1,0,0] neg_hi:[1,0,0]
    v_pk_fma_f32 v[250:251], v[234:235], v[114:115], v[250:251]
    v_cvt_pk_bf16_f32 v183, v248, v249
    v_cvt_pk_bf16_f32 v187, v250, v251
    s_nop 0
    v_mfma_f32_16x16x32_bf16 v[228:231], v[44:47], v[180:183], 0
    v_mul_f32 v244, v212, v68
    v_mul_f32 v246, v220, v68
    v_mfma_f32_16x16x32_bf16 v[232:235], v[48:51], v[180:183], 0
    v_mul_f32 v245, v213, v69
    v_mul_f32_e64 v247, v221, v69
    v_mfma_f32_16x16x32_bf16 v[236:239], v[44:47], v[184:187], 0
    buffer_load_dwordx4 a[64:67], v11, s[20:23], s45 offen offset:1024 sc1
    v_fma_f32 v244, -v220, v76, v244
    v_fmac_f32_e64 v246, v212, v76
    v_mfma_f32_16x16x32_bf16 v[240:243], v[48:51], v[184:187], 0
    v_fma_f32 v245, -v221, v77, v245
    v_fmac_f32_e64 v247, v213, v77
    v_mfma_f32_16x16x32_bf16 v[228:231], v[60:63], v[184:187], v[228:231]
    v_cvt_pk_bf16_f32 v148, v244, v245
    v_cvt_pk_bf16_f32 v152, v246, v247
    v_mfma_f32_16x16x32_bf16 v[232:235], v[64:67], v[184:187], v[232:235]
    v_mul_f32 v248, v214, v70
    v_mul_f32 v250, v222, v70
    buffer_load_dwordx4 a[68:71], v12, s[20:23], s45 offen offset:1024 sc1
    v_mfma_f32_16x16x32_bf16 v[236:239], v[52:55], v[180:183], v[236:239]
    v_mul_f32 v249, v215, v71
    v_mul_f32 v251, v223, v71
    v_mfma_f32_16x16x32_bf16 v[240:243], v[56:59], v[180:183], v[240:243]
    v_fma_f32 v248, -v222, v78, v248
    v_fmac_f32 v250, v214, v78
    v_fma_f32 v249, -v223, v79, v249
    v_fmac_f32 v251, v215, v79
    v_cvt_pk_bf16_f32 v149, v248, v249
    v_cvt_pk_bf16_f32 v153, v250, v251
    v_pk_mul_f32 v[244:245], v[216:217], v[72:73]
    v_pk_mul_f32 v[246:247], v[224:225], v[72:73]
    buffer_load_dwordx4 a[72:75], v10, s[20:23], s45 offen offset:2048 sc1
    v_pk_fma_f32 v[244:245], v[224:225], v[80:81], v[244:245] neg_lo:[1,0,0] neg_hi:[1,0,0]
    v_pk_fma_f32 v[246:247], v[216:217], v[80:81], v[246:247]
    v_cvt_pk_bf16_f32 v150, v244, v245
    v_cvt_pk_bf16_f32 v154, v246, v247
    v_pk_mul_f32 v[248:249], v[218:219], v[74:75]
    v_pk_mul_f32 v[250:251], v[226:227], v[74:75]
    v_pk_fma_f32 v[248:249], v[226:227], v[82:83], v[248:249] neg_lo:[1,0,0] neg_hi:[1,0,0]
    v_pk_fma_f32 v[250:251], v[218:219], v[82:83], v[250:251]
    v_cvt_pk_bf16_f32 v151, v248, v249
    v_cvt_pk_bf16_f32 v155, v250, v251
    ds_write_b64 v16, v[148:149] offset:16384
    ds_write_b64 v17, v[150:151] offset:16384
    ds_write_b64 v16, v[152:153] offset:20480
    ds_write_b64 v17, v[154:155] offset:20480
    buffer_load_dwordx4 a[76:79], v11, s[20:23], s45 offen offset:2048 sc1
    s_waitcnt lgkmcnt(0)
    s_barrier
    s_cmp_eq_u32 s2, 159
    s_cselect_b32 s32, 0, -1
    ds_read_b64_tr_b16 v[148:149], v14 offset:16384
    ds_read_b64_tr_b16 v[150:151], v14 offset:17408
    ds_read_b64_tr_b16 v[156:157], v15 offset:16384
    ds_read_b64_tr_b16 v[158:159], v15 offset:17408
    ds_read_b64_tr_b16 v[164:165], v14 offset:20480
    ds_read_b64_tr_b16 v[166:167], v14 offset:21504
    ds_read_b64_tr_b16 v[172:173], v15 offset:20480
    ds_read_b64_tr_b16 v[174:175], v15 offset:21504
    v_mul_f32 v244, v228, v68
    ds_read_b64_tr_b16 v[152:153], v14 offset:18432
    v_mul_f32_e64 v246, v236, v68
    v_mul_f32 v245, v229, v69
    ds_read_b64_tr_b16 v[154:155], v14 offset:19456
    v_mul_f32 v247, v237, v69
    v_fma_f32 v244, -v236, v76, v244
    ds_read_b64_tr_b16 v[160:161], v15 offset:18432
    v_fmac_f32_e64 v246, v228, v76
    v_fma_f32 v245, -v237, v77, v245
    ds_read_b64_tr_b16 v[162:163], v15 offset:19456
    v_fmac_f32_e64 v247, v229, v77
    v_cvt_pk_bf16_f32 v180, v244, v245
    ds_read_b64_tr_b16 v[168:169], v14 offset:22528
    v_cvt_pk_bf16_f32 v184, v246, v247
    v_mul_f32 v248, v230, v70
    ds_read_b64_tr_b16 v[170:171], v14 offset:23552
    v_mul_f32 v250, v238, v70
    v_mul_f32 v249, v231, v71
    ds_read_b64_tr_b16 v[176:177], v15 offset:22528
    v_mul_f32 v251, v239, v71
    v_fma_f32 v248, -v238, v78, v248
    ds_read_b64_tr_b16 v[178:179], v15 offset:23552
    v_fmac_f32 v250, v230, v78
    s_waitcnt lgkmcnt(8)
    v_mfma_f32_16x16x32_bf16 v[116:119], v[148:151], v[20:23], v[116:119]
    v_fma_f32 v249, -v239, v79, v249
    v_fmac_f32_e64 v251, v231, v79
    v_mfma_f32_16x16x32_bf16 v[120:123], v[156:159], v[20:23], v[120:123]
    v_cvt_pk_bf16_f32 v181, v248, v249
    v_cvt_pk_bf16_f32 v185, v250, v251
    v_mfma_f32_16x16x32_bf16 v[124:127], v[164:167], v[20:23], v[124:127]
    v_mul_f32 v244, v232, v72
    v_mul_f32 v246, v240, v72
    v_mfma_f32_16x16x32_bf16 v[128:131], v[172:175], v[20:23], v[128:131]
    v_mul_f32 v245, v233, v73
    v_mul_f32 v247, v241, v73
    v_mfma_f32_16x16x32_bf16 v[116:119], v[164:167], v[36:39], v[116:119]
    v_fma_f32 v244, -v240, v80, v244
    v_fmac_f32_e64 v246, v232, v80
    v_mfma_f32_16x16x32_bf16 v[120:123], v[172:175], v[36:39], v[120:123]
    v_fma_f32 v245, -v241, v81, v245
    v_fmac_f32_e64 v247, v233, v81
    v_mfma_f32_16x16x32_bf16 v[124:127], v[148:151], v[28:31], v[124:127]
    v_cvt_pk_bf16_f32 v182, v244, v245
    v_cvt_pk_bf16_f32 v186, v246, v247
    v_mfma_f32_16x16x32_bf16 v[128:131], v[156:159], v[28:31], v[128:131]
    v_mul_f32_e64 v248, v234, v74
    v_mul_f32 v250, v242, v74
    s_waitcnt lgkmcnt(0)
    v_mfma_f32_16x16x32_bf16 v[116:119], v[152:155], v[24:27], v[116:119]
    v_mul_f32 v249, v235, v75
    v_mul_f32 v251, v243, v75
    v_mfma_f32_16x16x32_bf16 v[120:123], v[160:163], v[24:27], v[120:123]
    v_fma_f32 v248, -v242, v82, v248
    v_fmac_f32_e64 v250, v234, v82
    v_mfma_f32_16x16x32_bf16 v[124:127], v[168:171], v[24:27], v[124:127]
    v_fma_f32 v249, -v243, v83, v249
    v_fmac_f32_e64 v251, v235, v83
    v_mfma_f32_16x16x32_bf16 v[128:131], v[176:179], v[24:27], v[128:131]
    v_cvt_pk_bf16_f32 v183, v248, v249
    v_cvt_pk_bf16_f32 v187, v250, v251
    v_mfma_f32_16x16x32_bf16 v[116:119], v[168:171], v[40:43], v[116:119]
    ds_write_b64 v16, v[180:181] offset:24576
    ds_write_b64 v17, v[182:183] offset:24576
    v_mfma_f32_16x16x32_bf16 v[120:123], v[176:179], v[40:43], v[120:123]
    ds_write_b64 v16, v[184:185] offset:28672
    ds_write_b64 v17, v[186:187] offset:28672
    v_mfma_f32_16x16x32_bf16 v[124:127], v[152:155], v[32:35], v[124:127]
    v_mfma_f32_16x16x32_bf16 v[128:131], v[160:163], v[32:35], v[128:131]
    s_waitcnt lgkmcnt(0)
    s_barrier
    ds_read_b64_tr_b16 v[180:181], v14 offset:24576
    ds_read_b64_tr_b16 v[182:183], v14 offset:25600
    ds_read_b64_tr_b16 v[188:189], v15 offset:24576
    ds_read_b64_tr_b16 v[190:191], v15 offset:25600
    ds_read_b64_tr_b16 v[196:197], v14 offset:28672
    ds_read_b64_tr_b16 v[198:199], v14 offset:29696
    ds_read_b64_tr_b16 v[204:205], v15 offset:28672
    ds_read_b64_tr_b16 v[206:207], v15 offset:29696
    v_cvt_pk_bf16_f32 v212, v116, v117
    ds_read_b64_tr_b16 v[184:185], v14 offset:26624
    v_cvt_pk_bf16_f32 v213, v118, v119
    ds_read_b64_tr_b16 v[186:187], v14 offset:27648
    v_cvt_pk_bf16_f32 v214, v120, v121
    ds_read_b64_tr_b16 v[192:193], v15 offset:26624
    v_cvt_pk_bf16_f32 v215, v122, v123
    ds_read_b64_tr_b16 v[194:195], v15 offset:27648
    v_or_b32_e64 v212, 1, v212
    ds_read_b64_tr_b16 v[200:201], v14 offset:30720
    buffer_store_dwordx4 v[212:215], v13, s[20:23], s33 offen offset:0 sc1
    ds_read_b64_tr_b16 v[202:203], v14 offset:31744
    v_cvt_pk_bf16_f32 v220, v124, v125
    ds_read_b64_tr_b16 v[208:209], v15 offset:30720
    v_cvt_pk_bf16_f32 v221, v126, v127
    ds_read_b64_tr_b16 v[210:211], v15 offset:31744
    v_cvt_pk_bf16_f32 v222, v128, v129
    v_cvt_pk_bf16_f32 v223, v130, v131
    v_or_b32 v220, 1, v220
    buffer_store_dwordx4 v[220:223], v13, s[20:23], s33 offen offset:2048 sc1
    s_waitcnt lgkmcnt(8)
    v_mfma_f32_16x16x32_bf16 v[132:135], v[180:183], v[20:23], v[132:135]
    v_mfma_f32_16x16x32_bf16 v[136:139], v[188:191], v[20:23], v[136:139]
    v_mfma_f32_16x16x32_bf16 v[140:143], v[196:199], v[20:23], v[140:143]
    v_mfma_f32_16x16x32_bf16 v[144:147], v[204:207], v[20:23], v[144:147]
    v_mfma_f32_16x16x32_bf16 v[132:135], v[196:199], v[36:39], v[132:135]
    v_mfma_f32_16x16x32_bf16 v[136:139], v[204:207], v[36:39], v[136:139]
    v_mfma_f32_16x16x32_bf16 v[140:143], v[180:183], v[28:31], v[140:143]
    v_mfma_f32_16x16x32_bf16 v[144:147], v[188:191], v[28:31], v[144:147]
    s_waitcnt lgkmcnt(0)
    v_mfma_f32_16x16x32_bf16 v[132:135], v[184:187], v[24:27], v[132:135]
    v_mfma_f32_16x16x32_bf16 v[136:139], v[192:195], v[24:27], v[136:139]
    v_mfma_f32_16x16x32_bf16 v[140:143], v[200:203], v[24:27], v[140:143]
    v_mfma_f32_16x16x32_bf16 v[144:147], v[208:211], v[24:27], v[144:147]
    v_mfma_f32_16x16x32_bf16 v[132:135], v[200:203], v[40:43], v[132:135]
    v_mfma_f32_16x16x32_bf16 v[136:139], v[208:211], v[40:43], v[136:139]
    v_mfma_f32_16x16x32_bf16 v[140:143], v[184:187], v[32:35], v[140:143]
    v_mfma_f32_16x16x32_bf16 v[144:147], v[192:195], v[32:35], v[144:147]
    s_nop 4
    v_cvt_pk_bf16_f32 v228, v132, v133
    v_cvt_pk_bf16_f32 v229, v134, v135
    v_cvt_pk_bf16_f32 v230, v136, v137
    v_cvt_pk_bf16_f32 v231, v138, v139
    v_or_b32_e64 v228, 1, v228
    buffer_store_dwordx4 v[228:231], v13, s[20:23], s33 offen offset:128 sc1
    v_cvt_pk_bf16_f32 v236, v140, v141
    v_cvt_pk_bf16_f32 v237, v142, v143
    v_cvt_pk_bf16_f32 v238, v144, v145
    v_cvt_pk_bf16_f32 v239, v146, v147
    v_and_or_b32 v236, v236, s32, 1
    v_and_b32 v237, s32, v237
    v_and_b32 v238, s32, v238
    v_and_b32 v239, s32, v239
    buffer_store_dwordx4 v[236:239], v13, s[20:23], s33 offen offset:2176 sc1
    s_cmp_lg_u32 s28, 0
    s_cbranch_scc1 kxh_f
    s_lshl_b32 s32, s2, 7
    s_add_u32 s32, s32, 19005440
    v_mov_b32 v2, s10
    v_mov_b32 v3, s11
    v_mov_b32_e64 v4, 0
    buffer_store_dwordx2 v[2:3], v4, s[20:23], s32 offen sc1
kxh_f:
    ds_read_b128 v[20:23], v19 offset:0
    ds_read_b128 v[24:27], v19 offset:1024
    ds_read_b128 v[28:31], v19 offset:2048
    ds_read_b128 v[32:35], v19 offset:3072
    ds_read_b128 v[36:39], v19 offset:4096
    ds_read_b128 v[40:43], v19 offset:5120
    ds_read_b128 v[44:47], v19 offset:6144
    ds_read_b128 v[48:51], v19 offset:7168
    ds_read_b128 v[52:55], v19 offset:8192
    ds_read_b128 v[56:59], v19 offset:9216
    v_mul_f32 v4, 4.0, v0
    v_cos_f32 v196, v4
    v_sin_f32_e64 v197, -v4
    v_mul_f32 v5, 4.0, v252
    v_cos_f32 v198, v5
    v_sin_f32_e64 v199, -v5
    v_mul_f32 v4, 4.0, v253
    v_cos_f32 v200, v4
    v_sin_f32_e64 v201, -v4
    buffer_load_dwordx4 a[80:83], v12, s[20:23], s45 offen offset:2048 sc1
    v_mul_f32_e64 v5, 4.0, v254
    v_cos_f32 v202, v5
    v_sin_f32_e64 v203, -v5
    v_mul_f32 v4, 4.0, v255
    v_cos_f32 v204, v4
    v_sin_f32_e64 v205, -v4
    s_add_u32 s9, s31, 2
    s_lshr_b32 s51, s9, 2
    s_lshl_b32 s51, s51, 6
    s_and_b32 s9, s9, 3
    buffer_load_dwordx4 a[84:87], v10, s[20:23], s45 offen offset:3072 sc1
    s_add_u32 s9, s9, s51
    s_add_u32 s9, s9, 1
    v_and_b32 v3, 48, v1
    v_add_u32 v3, s9, v3
    v_cvt_f32_u32 v3, v3
    v_mul_f32 v4, v3, v0
    v_cos_f32 v206, v4
    v_sin_f32_e64 v207, -v4
    v_mul_f32 v5, v3, v252
    v_cos_f32 v214, v5
    v_sin_f32_e64 v215, -v5
    buffer_load_dwordx4 a[88:91], v11, s[20:23], s45 offen offset:3072 sc1
    v_mul_f32 v4, v3, v253
    v_cos_f32 v222, v4
    v_sin_f32_e64 v223, -v4
    v_mul_f32 v5, v3, v254
    v_cos_f32 v230, v5
    v_sin_f32_e64 v231, -v5
    v_mul_f32 v4, v3, v255
    v_cos_f32 v238, v4
    v_sin_f32_e64 v239, -v4
    buffer_load_dwordx4 a[92:95], v12, s[20:23], s45 offen offset:3072 sc1
    s_mov_b32 s8, 0x3b4ccccd
    v_pk_mul_f32 v[206:207], v[206:207], s[8:9] op_sel_hi:[1,0]
    v_pk_mul_f32 v[214:215], v[214:215], s[8:9] op_sel_hi:[1,0]
    v_pk_mul_f32 v[222:223], v[222:223], s[8:9] op_sel_hi:[1,0]
    v_pk_mul_f32 v[230:231], v[230:231], s[8:9] op_sel_hi:[1,0]
    v_pk_mul_f32 v[238:239], v[238:239], s[8:9] op_sel_hi:[1,0]
    v_pk_mul_f32 v[208:209], v[206:207], v[196:197] op_sel_hi:[1,0]
    v_pk_mul_f32 v[216:217], v[214:215], v[198:199] op_sel_hi:[1,0]
    v_pk_mul_f32 v[224:225], v[222:223], v[200:201] op_sel_hi:[1,0]
    v_pk_mul_f32 v[232:233], v[230:231], v[202:203] op_sel_hi:[1,0]
    v_pk_mul_f32 v[240:241], v[238:239], v[204:205] op_sel_hi:[1,0]
    v_pk_fma_f32 v[208:209], v[206:207], v[196:197], v[208:209] op_sel:[1,1,0] op_sel_hi:[0,1,1] neg_lo:[1,0,0]
    v_pk_fma_f32 v[216:217], v[214:215], v[198:199], v[216:217] op_sel:[1,1,0] op_sel_hi:[0,1,1] neg_lo:[1,0,0]
    v_pk_fma_f32 v[224:225], v[222:223], v[200:201], v[224:225] op_sel:[1,1,0] op_sel_hi:[0,1,1] neg_lo:[1,0,0]
    s_add_u32 s45, s44, 8192
    buffer_load_dwordx4 a[96:99], v10, s[20:23], s45 offen offset:0 sc1
    v_pk_fma_f32 v[232:233], v[230:231], v[202:203], v[232:233] op_sel:[1,1,0] op_sel_hi:[0,1,1] neg_lo:[1,0,0]
    v_pk_fma_f32 v[240:241], v[238:239], v[204:205], v[240:241] op_sel:[1,1,0] op_sel_hi:[0,1,1] neg_lo:[1,0,0]
    v_pk_mul_f32 v[210:211], v[208:209], v[196:197] op_sel_hi:[1,0]
    v_pk_mul_f32 v[218:219], v[216:217], v[198:199] op_sel_hi:[1,0]
    v_pk_mul_f32 v[226:227], v[224:225], v[200:201] op_sel_hi:[1,0]
    v_pk_mul_f32 v[234:235], v[232:233], v[202:203] op_sel_hi:[1,0]
    v_pk_mul_f32 v[242:243], v[240:241], v[204:205] op_sel_hi:[1,0]
    v_pk_fma_f32 v[210:211], v[208:209], v[196:197], v[210:211] op_sel:[1,1,0] op_sel_hi:[0,1,1] neg_lo:[1,0,0]
    v_pk_fma_f32 v[218:219], v[216:217], v[198:199], v[218:219] op_sel:[1,1,0] op_sel_hi:[0,1,1] neg_lo:[1,0,0]
    v_pk_fma_f32 v[226:227], v[224:225], v[200:201], v[226:227] op_sel:[1,1,0] op_sel_hi:[0,1,1] neg_lo:[1,0,0]
    v_pk_fma_f32 v[234:235], v[232:233], v[202:203], v[234:235] op_sel:[1,1,0] op_sel_hi:[0,1,1] neg_lo:[1,0,0]
    v_pk_fma_f32 v[242:243], v[240:241], v[204:205], v[242:243] op_sel:[1,1,0] op_sel_hi:[0,1,1] neg_lo:[1,0,0]
    v_pk_mul_f32 v[212:213], v[210:211], v[196:197] op_sel_hi:[1,0]
    v_pk_mul_f32 v[220:221], v[218:219], v[198:199] op_sel_hi:[1,0]
    buffer_load_dwordx4 a[100:103], v11, s[20:23], s45 offen offset:0 sc1
    v_pk_mul_f32 v[228:229], v[226:227], v[200:201] op_sel_hi:[1,0]
    v_pk_mul_f32 v[236:237], v[234:235], v[202:203] op_sel_hi:[1,0]
    v_pk_mul_f32 v[244:245], v[242:243], v[204:205] op_sel_hi:[1,0]
    v_pk_fma_f32 v[212:213], v[210:211], v[196:197], v[212:213] op_sel:[1,1,0] op_sel_hi:[0,1,1] neg_lo:[1,0,0]
    v_pk_fma_f32 v[220:221], v[218:219], v[198:199], v[220:221] op_sel:[1,1,0] op_sel_hi:[0,1,1] neg_lo:[1,0,0]
    v_pk_fma_f32 v[228:229], v[226:227], v[200:201], v[228:229] op_sel:[1,1,0] op_sel_hi:[0,1,1] neg_lo:[1,0,0]
    v_pk_fma_f32 v[236:237], v[234:235], v[202:203], v[236:237] op_sel:[1,1,0] op_sel_hi:[0,1,1] neg_lo:[1,0,0]
    v_pk_fma_f32 v[244:245], v[242:243], v[204:205], v[244:245] op_sel:[1,1,0] op_sel_hi:[0,1,1] neg_lo:[1,0,0]
    v_cvt_pk_bf16_f32 v60, v206, v208
    v_cvt_pk_bf16_f32 v62, v207, v209
    v_cvt_pk_bf16_f32 v61, v210, v212
    v_cvt_pk_bf16_f32 v63, v211, v213
    v_cvt_pk_bf16_f32 v64, v214, v216
    v_cvt_pk_bf16_f32 v66, v215, v217
    buffer_load_dwordx4 a[104:107], v12, s[20:23], s45 offen offset:0 sc1
    v_cvt_pk_bf16_f32 v65, v218, v220
    v_cvt_pk_bf16_f32 v67, v219, v221
    v_cvt_pk_bf16_f32 v68, v222, v224
    v_cvt_pk_bf16_f32 v70, v223, v225
    v_cvt_pk_bf16_f32 v69, v226, v228
    v_cvt_pk_bf16_f32 v71, v227, v229
    v_cvt_pk_bf16_f32 v72, v230, v232
    v_cvt_pk_bf16_f32 v74, v231, v233
    v_cvt_pk_bf16_f32 v73, v234, v236
    v_cvt_pk_bf16_f32 v75, v235, v237
    v_cvt_pk_bf16_f32 v76, v238, v240
    v_cvt_pk_bf16_f32 v78, v239, v241
    v_cvt_pk_bf16_f32 v77, v242, v244
    v_cvt_pk_bf16_f32 v79, v243, v245
    buffer_load_dwordx4 a[108:111], v10, s[20:23], s45 offen offset:1024 sc1
    s_add_u32 s9, s31, 3
    s_lshr_b32 s51, s9, 2
    s_lshl_b32 s51, s51, 6
    s_and_b32 s9, s9, 3
    s_add_u32 s9, s9, s51
    s_add_u32 s9, s9, 1
    v_and_b32 v3, 48, v1
    v_add_u32 v3, s9, v3
    v_cvt_f32_u32 v3, v3
    v_mul_f32 v4, v3, v0
    v_cos_f32_e64 v206, v4
    v_sin_f32_e64 v207, -v4
    buffer_load_dwordx4 a[112:115], v11, s[20:23], s45 offen offset:1024 sc1
    v_mul_f32 v5, v3, v252
    v_cos_f32 v214, v5
    v_sin_f32_e64 v215, -v5
    v_mul_f32 v4, v3, v253
    v_cos_f32 v222, v4
    v_sin_f32_e64 v223, -v4
    v_mul_f32 v5, v3, v254
    v_cos_f32 v230, v5
    v_sin_f32_e64 v231, -v5
    buffer_load_dwordx4 a[116:119], v12, s[20:23], s45 offen offset:1024 sc1
    v_mul_f32 v4, v3, v255
    v_cos_f32 v238, v4
    v_sin_f32_e64 v239, -v4
    s_mov_b32 s8, 0x3b4ccccd
    v_pk_mul_f32 v[206:207], v[206:207], s[8:9] op_sel_hi:[1,0]
    v_pk_mul_f32 v[214:215], v[214:215], s[8:9] op_sel_hi:[1,0]
    v_pk_mul_f32 v[222:223], v[222:223], s[8:9] op_sel_hi:[1,0]
    v_pk_mul_f32 v[230:231], v[230:231], s[8:9] op_sel_hi:[1,0]
    v_pk_mul_f32 v[238:239], v[238:239], s[8:9] op_sel_hi:[1,0]
    v_pk_mul_f32 v[208:209], v[206:207], v[196:197] op_sel_hi:[1,0]
    v_pk_mul_f32 v[216:217], v[214:215], v[198:199] op_sel_hi:[1,0]
    v_pk_mul_f32 v[224:225], v[222:223], v[200:201] op_sel_hi:[1,0]
    buffer_load_dwordx4 a[120:123], v10, s[20:23], s45 offen offset:2048 sc1
    v_pk_mul_f32 v[232:233], v[230:231], v[202:203] op_sel_hi:[1,0]
    v_pk_mul_f32 v[240:241], v[238:239], v[204:205] op_sel_hi:[1,0]
    v_pk_fma_f32 v[208:209], v[206:207], v[196:197], v[208:209] op_sel:[1,1,0] op_sel_hi:[0,1,1] neg_lo:[1,0,0]
    v_pk_fma_f32 v[216:217], v[214:215], v[198:199], v[216:217] op_sel:[1,1,0] op_sel_hi:[0,1,1] neg_lo:[1,0,0]
    v_pk_fma_f32 v[224:225], v[222:223], v[200:201], v[224:225] op_sel:[1,1,0] op_sel_hi:[0,1,1] neg_lo:[1,0,0]
    v_pk_fma_f32 v[232:233], v[230:231], v[202:203], v[232:233] op_sel:[1,1,0] op_sel_hi:[0,1,1] neg_lo:[1,0,0]
    v_pk_fma_f32 v[240:241], v[238:239], v[204:205], v[240:241] op_sel:[1,1,0] op_sel_hi:[0,1,1] neg_lo:[1,0,0]
    v_pk_mul_f32 v[210:211], v[208:209], v[196:197] op_sel_hi:[1,0]
    v_pk_mul_f32 v[218:219], v[216:217], v[198:199] op_sel_hi:[1,0]
    v_pk_mul_f32 v[226:227], v[224:225], v[200:201] op_sel_hi:[1,0]
    v_pk_mul_f32 v[234:235], v[232:233], v[202:203] op_sel_hi:[1,0]
    v_pk_mul_f32 v[242:243], v[240:241], v[204:205] op_sel_hi:[1,0]
    v_pk_fma_f32 v[210:211], v[208:209], v[196:197], v[210:211] op_sel:[1,1,0] op_sel_hi:[0,1,1] neg_lo:[1,0,0]
    v_pk_fma_f32 v[218:219], v[216:217], v[198:199], v[218:219] op_sel:[1,1,0] op_sel_hi:[0,1,1] neg_lo:[1,0,0]
    buffer_load_dwordx4 a[124:127], v11, s[20:23], s45 offen offset:2048 sc1
    v_pk_fma_f32 v[226:227], v[224:225], v[200:201], v[226:227] op_sel:[1,1,0] op_sel_hi:[0,1,1] neg_lo:[1,0,0]
    v_pk_fma_f32 v[234:235], v[232:233], v[202:203], v[234:235] op_sel:[1,1,0] op_sel_hi:[0,1,1] neg_lo:[1,0,0]
    v_pk_fma_f32 v[242:243], v[240:241], v[204:205], v[242:243] op_sel:[1,1,0] op_sel_hi:[0,1,1] neg_lo:[1,0,0]
    v_pk_mul_f32 v[212:213], v[210:211], v[196:197] op_sel_hi:[1,0]
    v_pk_mul_f32 v[220:221], v[218:219], v[198:199] op_sel_hi:[1,0]
    v_pk_mul_f32 v[228:229], v[226:227], v[200:201] op_sel_hi:[1,0]
    v_pk_mul_f32 v[236:237], v[234:235], v[202:203] op_sel_hi:[1,0]
    v_pk_mul_f32 v[244:245], v[242:243], v[204:205] op_sel_hi:[1,0]
    v_pk_fma_f32 v[212:213], v[210:211], v[196:197], v[212:213] op_sel:[1,1,0] op_sel_hi:[0,1,1] neg_lo:[1,0,0]
    v_pk_fma_f32 v[220:221], v[218:219], v[198:199], v[220:221] op_sel:[1,1,0] op_sel_hi:[0,1,1] neg_lo:[1,0,0]
    v_pk_fma_f32 v[228:229], v[226:227], v[200:201], v[228:229] op_sel:[1,1,0] op_sel_hi:[0,1,1] neg_lo:[1,0,0]
    v_pk_fma_f32 v[236:237], v[234:235], v[202:203], v[236:237] op_sel:[1,1,0] op_sel_hi:[0,1,1] neg_lo:[1,0,0]
    v_pk_fma_f32 v[244:245], v[242:243], v[204:205], v[244:245] op_sel:[1,1,0] op_sel_hi:[0,1,1] neg_lo:[1,0,0]
    v_cvt_pk_bf16_f32 v80, v206, v208
    buffer_load_dwordx4 a[128:131], v12, s[20:23], s45 offen offset:2048 sc1
    v_cvt_pk_bf16_f32 v82, v207, v209
    v_cvt_pk_bf16_f32 v81, v210, v212
    v_cvt_pk_bf16_f32 v83, v211, v213
    v_cvt_pk_bf16_f32 v84, v214, v216
    v_cvt_pk_bf16_f32 v86, v215, v217
    v_cvt_pk_bf16_f32 v85, v218, v220
    v_cvt_pk_bf16_f32 v87, v219, v221
    v_cvt_pk_bf16_f32 v88, v222, v224
    v_cvt_pk_bf16_f32 v90, v223, v225
    v_cvt_pk_bf16_f32 v89, v226, v228
    v_cvt_pk_bf16_f32 v91, v227, v229
    v_cvt_pk_bf16_f32 v92, v230, v232
    v_cvt_pk_bf16_f32 v94, v231, v233
    v_cvt_pk_bf16_f32 v93, v234, v236
    buffer_load_dwordx4 a[132:135], v10, s[20:23], s45 offen offset:3072 sc1
    v_cvt_pk_bf16_f32 v95, v235, v237
    v_cvt_pk_bf16_f32 v96, v238, v240
    v_cvt_pk_bf16_f32 v98, v239, v241
    v_cvt_pk_bf16_f32 v97, v242, v244
    v_cvt_pk_bf16_f32 v99, v243, v245
kf_join:
    s_add_u32 s45, s44, 8192
    s_mul_i32 s33, s29, 81920
    s_lshl_b32 s39, s28, 12
    s_add_u32 s33, s33, s39
    v_bfe_u32 v2, v1, 1, 2
    v_bfe_u32 v204, v1, 4, 2
    v_xor_b32_e64 v2, v2, v204
    v_lshlrev_b32 v2, 5, v2
    v_and_b32 v13, 1, v1
    v_lshl_or_b32 v2, v13, 4, v2
    v_lshrrev_b32 v13, 3, v1
    v_lshl_add_u32 v13, v13, 7, v2
    v_add_u32 v18, s39, v10
    s_add_u32 s35, s33, 16384
    s_add_u32 s36, s33, 32768
    s_add_u32 s37, s33, 49152
    s_add_u32 s38, s33, 65536
    s_add_u32 m0, s39, 0
    s_nop 0
    buffer_load_dwordx4 v13, s[20:23], s33 offen offset:0 sc1 lds
    s_add_u32 m0, s39, 0
    s_nop 0
    buffer_load_dwordx4 v13, s[20:23], s33 offen offset:1024 sc1 lds
    s_add_u32 m0, s39, 0
    s_nop 0
    buffer_load_dwordx4 v13, s[20:23], s33 offen offset:2048 sc1 lds
    s_add_u32 m0, s39, 0
    s_nop 0
    buffer_load_dwordx4 v13, s[20:23], s33 offen offset:3072 sc1 lds
    s_add_u32 m0, s39, 16384
    s_nop 0
    buffer_load_dwordx4 v13, s[20:23], s35 offen offset:0 sc1 lds
    s_add_u32 m0, s39, 16384
    s_nop 0
    buffer_load_dwordx4 v13, s[20:23], s35 offen offset:1024 sc1 lds
    s_add_u32 m0, s39, 16384
    s_nop 0
    buffer_load_dwordx4 v13, s[20:23], s35 offen offset:2048 sc1 lds
    s_add_u32 m0, s39, 16384
    s_nop 0
    buffer_load_dwordx4 v13, s[20:23], s35 offen offset:3072 sc1 lds
    s_add_u32 m0, s39, 32768
    s_nop 0
    buffer_load_dwordx4 v13, s[20:23], s36 offen offset:0 sc1 lds
    s_add_u32 m0, s39, 32768
    s_nop 0
    buffer_load_dwordx4 v13, s[20:23], s36 offen offset:1024 sc1 lds
    s_add_u32 m0, s39, 32768
    s_nop 0
    buffer_load_dwordx4 v13, s[20:23], s36 offen offset:2048 sc1 lds
    s_add_u32 m0, s39, 32768
    s_nop 0
    buffer_load_dwordx4 v13, s[20:23], s36 offen offset:3072 sc1 lds
    v_add_u32 v19, 0x10000, v18
    v_lshrrev_b32 v2, 2, v1
    v_bfe_u32 v204, v2, 1, 2
    v_and_b32 v205, 3, v1
    v_lshlrev_b32 v205, 3, v205
    v_lshl_add_u32 v205, v2, 7, v205
    v_xor_b32 v2, 0, v204
    v_lshl_add_u32 v14, v2, 5, v205
    v_xor_b32 v2, 1, v204
    v_lshl_add_u32 v15, v2, 5, v205
    v_xor_b32 v2, 2, v204
    v_lshl_add_u32 v16, v2, 5, v205
    v_xor_b32 v2, 3, v204
    v_lshl_add_u32 v17, v2, 5, v205
    v_xor_b32 v2, s28, v204
    v_lshl_add_u32 v112, v2, 5, v205
    s_mov_b32 s40, s28
    s_cmp_ge_u32 0, s28
    s_addc_u32 s41, 0, 0
    s_cmp_ge_u32 1, s28
    s_addc_u32 s42, 1, 0
    s_cmp_ge_u32 2, s28
    s_addc_u32 s43, 2, 0
    s_mul_i32 s32, s28, 20480
    v_add_u32 v205, s32, v205
    v_xor_b32 v2, s40, v204
    v_lshl_add_u32 v113, v2, 5, v205
    v_xor_b32 v2, s41, v204
    v_lshl_add_u32 v114, v2, 5, v205
    v_xor_b32 v2, s42, v204
    v_lshl_add_u32 v115, v2, 5, v205
    v_xor_b32 v2, s43, v204
    v_lshl_add_u32 v116, v2, 5, v205
    s_mul_i32 s12, s30, 48
    s_mul_i32 s32, s28, 12
    s_add_u32 s12, s12, s32
    s_mul_i32 s12, s12, 5120
    s_add_u32 s12, s12, 5242880
    s_waitcnt vmcnt(8)
    ds_read_b32 v204, v18 offset:0
    ds_read_b32 v205, v18 offset:1024
    ds_read_b32 v206, v18 offset:2048
    ds_read_b32 v207, v18 offset:3072
    s_waitcnt lgkmcnt(0)
    v_bitop3_b32 v2, v204, v205, v206 bitop3:0x80
    v_bitop3_b32 v2, v2, v207, 1 bitop3:0x80
    v_cmp_eq_u32 vcc, 0, v2
    s_cbranch_vccnz kf_rt_h0
kf_ok_h0:
    s_barrier
    ds_read_b64_tr_b16 v[100:101], v112 offset:0
    ds_read_b64_tr_b16 v[102:103], v112 offset:2048
    ds_read_b64_tr_b16 v[172:173], v14 offset:0
    ds_read_b64_tr_b16 v[174:175], v14 offset:2048
    ds_read_b64_tr_b16 v[176:177], v15 offset:0
    ds_read_b64_tr_b16 v[178:179], v15 offset:2048
    ds_read_b64_tr_b16 v[180:181], v16 offset:0
    ds_read_b64_tr_b16 v[182:183], v16 offset:2048
    ds_read_b64_tr_b16 v[184:185], v17 offset:0
    ds_read_b64_tr_b16 v[186:187], v17 offset:2048
    ds_read_b64_tr_b16 v[104:105], v112 offset:4096
    ds_read_b64_tr_b16 v[106:107], v112 offset:6144
    ds_read_b64_tr_b16 v[188:189], v14 offset:4096
    ds_read_b64_tr_b16 v[190:191], v14 offset:6144
    ds_read_b64_tr_b16 v[192:193], v15 offset:4096
    s_waitcnt lgkmcnt(5)
    ds_read_b64_tr_b16 v[194:195], v15 offset:6144
    ds_read_b64_tr_b16 v[196:197], v16 offset:4096
    ds_read_b64_tr_b16 v[198:199], v16 offset:6144
    ds_read_b64_tr_b16 v[200:201], v17 offset:4096
    ds_read_b64_tr_b16 v[202:203], v17 offset:6144
    s_waitcnt lgkmcnt(10)
    v_mfma_f32_16x16x32_bf16 v[168:171], v[100:103], v[100:103], 0
    ds_read_b64_tr_b16 v[108:109], v112 offset:8192
    v_mfma_f32_16x16x32_bf16 v[120:123], a[0:3], v[172:175], 0
    ds_read_b64_tr_b16 v[110:111], v112 offset:10240
    v_mfma_f32_16x16x32_bf16 v[136:139], a[4:7], v[172:175], 0
    ds_read_b64_tr_b16 v[208:209], v14 offset:8192
    v_mfma_f32_16x16x32_bf16 v[152:155], a[8:11], v[172:175], 0
    ds_read_b64_tr_b16 v[210:211], v14 offset:10240
    v_mfma_f32_16x16x32_bf16 v[124:127], a[0:3], v[176:179], 0
    ds_read_b64_tr_b16 v[212:213], v15 offset:8192
    v_mfma_f32_16x16x32_bf16 v[140:143], a[4:7], v[176:179], 0
    ds_read_b64_tr_b16 v[214:215], v15 offset:10240
    v_mfma_f32_16x16x32_bf16 v[156:159], a[8:11], v[176:179], 0
    ds_read_b64_tr_b16 v[216:217], v16 offset:8192
    v_mfma_f32_16x16x32_bf16 v[128:131], a[0:3], v[180:183], 0
    ds_read_b64_tr_b16 v[218:219], v16 offset:10240
    v_mfma_f32_16x16x32_bf16 v[144:147], a[4:7], v[180:183], 0
    ds_read_b64_tr_b16 v[220:221], v17 offset:8192
    v_mfma_f32_16x16x32_bf16 v[160:163], a[8:11], v[180:183], 0
    ds_read_b64_tr_b16 v[222:223], v17 offset:10240
    v_mfma_f32_16x16x32_bf16 v[132:135], a[0:3], v[184:187], 0
    s_waitcnt vmcnt(4)
    ds_read_b32 v204, v18 offset:16384
    v_mfma_f32_16x16x32_bf16 v[148:151], a[4:7], v[184:187], 0
    ds_read_b32 v205, v18 offset:17408
    v_mfma_f32_16x16x32_bf16 v[164:167], a[8:11], v[184:187], 0
    ds_read_b32 v206, v18 offset:18432
    ds_read_b32 v207, v18 offset:19456
    s_add_u32 m0, s39, 49152
    s_nop 0
    buffer_load_dwordx4 v13, s[20:23], s37 offen offset:0 sc1 lds
    s_add_u32 m0, s39, 49152
    s_nop 0
    buffer_load_dwordx4 v13, s[20:23], s37 offen offset:1024 sc1 lds
    s_add_u32 m0, s39, 49152
    s_nop 0
    buffer_load_dwordx4 v13, s[20:23], s37 offen offset:2048 sc1 lds
    s_add_u32 m0, s39, 49152
    s_nop 0
    buffer_load_dwordx4 v13, s[20:23], s37 offen offset:3072 sc1 lds
    s_waitcnt lgkmcnt(14)
    v_mfma_f32_16x16x32_bf16 v[168:171], v[104:107], v[104:107], v[168:171]
    ds_read_b64_tr_b16 v[100:101], v112 offset:12288
    v_mfma_f32_16x16x32_bf16 v[120:123], a[12:15], v[188:191], v[120:123]
    ds_read_b64_tr_b16 v[102:103], v112 offset:14336
    v_mfma_f32_16x16x32_bf16 v[136:139], a[16:19], v[188:191], v[136:139]
    ds_read_b64_tr_b16 v[172:173], v14 offset:12288
    v_mfma_f32_16x16x32_bf16 v[152:155], a[20:23], v[188:191], v[152:155]
    ds_read_b64_tr_b16 v[174:175], v14 offset:14336
    v_mfma_f32_16x16x32_bf16 v[124:127], a[12:15], v[192:195], v[124:127]
    ds_read_b64_tr_b16 v[176:177], v15 offset:12288
    v_mfma_f32_16x16x32_bf16 v[140:143], a[16:19], v[192:195], v[140:143]
    ds_read_b64_tr_b16 v[178:179], v15 offset:14336
    buffer_load_dwordx4 a[136:139], v11, s[20:23], s45 offen offset:3072 sc1
    v_mfma_f32_16x16x32_bf16 v[156:159], a[20:23], v[192:195], v[156:159]
    ds_read_b64_tr_b16 v[180:181], v16 offset:12288
    v_mfma_f32_16x16x32_bf16 v[128:131], a[12:15], v[196:199], v[128:131]
    ds_read_b64_tr_b16 v[182:183], v16 offset:14336
    v_mfma_f32_16x16x32_bf16 v[144:147], a[16:19], v[196:199], v[144:147]
    ds_read_b64_tr_b16 v[184:185], v17 offset:12288
    buffer_load_dwordx4 a[140:143], v12, s[20:23], s45 offen offset:3072 sc1
    v_mfma_f32_16x16x32_bf16 v[160:163], a[20:23], v[196:199], v[160:163]
    ds_read_b64_tr_b16 v[186:187], v17 offset:14336
    v_mfma_f32_16x16x32_bf16 v[132:135], a[12:15], v[200:203], v[132:135]
    s_waitcnt lgkmcnt(5)
    v_bitop3_b32 v2, v204, v205, v206 bitop3:0x80
    v_mfma_f32_16x16x32_bf16 v[148:151], a[16:19], v[200:203], v[148:151]
    s_add_u32 s45, s44, 12288
    buffer_load_dwordx4 a[144:147], v10, s[20:23], s45 offen offset:0 sc1
    v_mfma_f32_16x16x32_bf16 v[164:167], a[20:23], v[200:203], v[164:167]
    v_bitop3_b32 v2, v2, v207, 1 bitop3:0x80
    v_cmp_eq_u32 vcc, 0, v2
    s_cbranch_vccnz kf_rt_h1
kf_ok_h1:
    s_waitcnt lgkmcnt(10)
    v_mfma_f32_16x16x32_bf16 v[168:171], v[108:111], v[108:111], v[168:171]
    v_mfma_f32_16x16x32_bf16 v[120:123], a[24:27], v[208:211], v[120:123]
    s_barrier
    v_mfma_f32_16x16x32_bf16 v[136:139], a[28:31], v[208:211], v[136:139]
    ds_read_b64_tr_b16 v[104:105], v112 offset:16384
    v_mfma_f32_16x16x32_bf16 v[152:155], a[32:35], v[208:211], v[152:155]
    ds_read_b64_tr_b16 v[106:107], v112 offset:18432
    v_mfma_f32_16x16x32_bf16 v[124:127], a[24:27], v[212:215], v[124:127]
    ds_read_b64_tr_b16 v[188:189], v14 offset:16384
    v_mfma_f32_16x16x32_bf16 v[140:143], a[28:31], v[212:215], v[140:143]
    ds_read_b64_tr_b16 v[190:191], v14 offset:18432
    v_mfma_f32_16x16x32_bf16 v[156:159], a[32:35], v[212:215], v[156:159]
    ds_read_b64_tr_b16 v[192:193], v15 offset:16384
    v_mfma_f32_16x16x32_bf16 v[128:131], a[24:27], v[216:219], v[128:131]
    ds_read_b64_tr_b16 v[194:195], v15 offset:18432
    v_mfma_f32_16x16x32_bf16 v[144:147], a[28:31], v[216:219], v[144:147]
    ds_read_b64_tr_b16 v[196:197], v16 offset:16384
    v_mfma_f32_16x16x32_bf16 v[160:163], a[32:35], v[216:219], v[160:163]
    ds_read_b64_tr_b16 v[198:199], v16 offset:18432
    v_mfma_f32_16x16x32_bf16 v[132:135], a[24:27], v[220:223], v[132:135]
    ds_read_b64_tr_b16 v[200:201], v17 offset:16384
    v_mfma_f32_16x16x32_bf16 v[148:151], a[28:31], v[220:223], v[148:151]
    ds_read_b64_tr_b16 v[202:203], v17 offset:18432
    v_mfma_f32_16x16x32_bf16 v[164:167], a[32:35], v[220:223], v[164:167]
    s_add_u32 m0, s39, 65536
    s_nop 0
    buffer_load_dwordx4 v13, s[20:23], s38 offen offset:0 sc1 lds
    s_add_u32 m0, s39, 65536
    s_nop 0
    buffer_load_dwordx4 v13, s[20:23], s38 offen offset:1024 sc1 lds
    s_add_u32 m0, s39, 65536
    s_nop 0
    buffer_load_dwordx4 v13, s[20:23], s38 offen offset:2048 sc1 lds
    s_add_u32 m0, s39, 65536
    s_nop 0
    buffer_load_dwordx4 v13, s[20:23], s38 offen offset:3072 sc1 lds
    s_waitcnt lgkmcnt(10)
    v_mfma_f32_16x16x32_bf16 v[168:171], v[100:103], v[100:103], v[168:171]
    ds_read_b64_tr_b16 v[108:109], v112 offset:20480
    v_mfma_f32_16x16x32_bf16 v[120:123], a[36:39], v[172:175], v[120:123]
    ds_read_b64_tr_b16 v[110:111], v112 offset:22528
    v_mfma_f32_16x16x32_bf16 v[136:139], a[40:43], v[172:175], v[136:139]
    ds_read_b64_tr_b16 v[208:209], v14 offset:20480
    buffer_load_dwordx4 a[148:151], v11, s[20:23], s45 offen offset:0 sc1
    v_mfma_f32_16x16x32_bf16 v[152:155], a[44:47], v[172:175], v[152:155]
    ds_read_b64_tr_b16 v[210:211], v14 offset:22528
    v_mfma_f32_16x16x32_bf16 v[124:127], a[36:39], v[176:179], v[124:127]
    ds_read_b64_tr_b16 v[212:213], v15 offset:20480
    v_mfma_f32_16x16x32_bf16 v[140:143], a[40:43], v[176:179], v[140:143]
    ds_read_b64_tr_b16 v[214:215], v15 offset:22528
    buffer_load_dwordx4 a[152:155], v12, s[20:23], s45 offen offset:0 sc1
    v_mfma_f32_16x16x32_bf16 v[156:159], a[44:47], v[176:179], v[156:159]
    ds_read_b64_tr_b16 v[216:217], v16 offset:20480
    v_mfma_f32_16x16x32_bf16 v[128:131], a[36:39], v[180:183], v[128:131]
    ds_read_b64_tr_b16 v[218:219], v16 offset:22528
    v_mfma_f32_16x16x32_bf16 v[144:147], a[40:43], v[180:183], v[144:147]
    ds_read_b64_tr_b16 v[220:221], v17 offset:20480
    buffer_load_dwordx4 a[156:159], v10, s[20:23], s45 offen offset:1024 sc1
    v_mfma_f32_16x16x32_bf16 v[160:163], a[44:47], v[180:183], v[160:163]
    ds_read_b64_tr_b16 v[222:223], v17 offset:22528
    v_mfma_f32_16x16x32_bf16 v[132:135], a[36:39], v[184:187], v[132:135]
    v_mfma_f32_16x16x32_bf16 v[148:151], a[40:43], v[184:187], v[148:151]
    buffer_load_dwordx4 a[160:163], v11, s[20:23], s45 offen offset:1024 sc1
    v_mfma_f32_16x16x32_bf16 v[164:167], a[44:47], v[184:187], v[164:167]
    s_waitcnt lgkmcnt(10)
    v_mfma_f32_16x16x32_bf16 v[168:171], v[104:107], v[104:107], v[168:171]
    ds_read_b64_tr_b16 v[100:101], v112 offset:24576
    v_mfma_f32_16x16x32_bf16 v[120:123], a[48:51], v[188:191], v[120:123]
    ds_read_b64_tr_b16 v[102:103], v112 offset:26624
    buffer_load_dwordx4 a[164:167], v12, s[20:23], s45 offen offset:1024 sc1
    v_mfma_f32_16x16x32_bf16 v[136:139], a[52:55], v[188:191], v[136:139]
    ds_read_b64_tr_b16 v[172:173], v14 offset:24576
    v_mfma_f32_16x16x32_bf16 v[152:155], a[56:59], v[188:191], v[152:155]
    ds_read_b64_tr_b16 v[174:175], v14 offset:26624
    v_mfma_f32_16x16x32_bf16 v[124:127], a[48:51], v[192:195], v[124:127]
    ds_read_b64_tr_b16 v[176:177], v15 offset:24576
    buffer_load_dwordx4 a[168:171], v10, s[20:23], s45 offen offset:2048 sc1
    v_mfma_f32_16x16x32_bf16 v[140:143], a[52:55], v[192:195], v[140:143]
    ds_read_b64_tr_b16 v[178:179], v15 offset:26624
    v_mfma_f32_16x16x32_bf16 v[156:159], a[56:59], v[192:195], v[156:159]
    ds_read_b64_tr_b16 v[180:181], v16 offset:24576
    v_mfma_f32_16x16x32_bf16 v[128:131], a[48:51], v[196:199], v[128:131]
    ds_read_b64_tr_b16 v[182:183], v16 offset:26624
    buffer_load_dwordx4 a[172:175], v11, s[20:23], s45 offen offset:2048 sc1
    v_mfma_f32_16x16x32_bf16 v[144:147], a[52:55], v[196:199], v[144:147]
    ds_read_b64_tr_b16 v[184:185], v17 offset:24576
    v_mfma_f32_16x16x32_bf16 v[160:163], a[56:59], v[196:199], v[160:163]
    ds_read_b64_tr_b16 v[186:187], v17 offset:26624
    v_mfma_f32_16x16x32_bf16 v[132:135], a[48:51], v[200:203], v[132:135]
    s_waitcnt vmcnt(18)
    ds_read_b32 v204, v18 offset:32768
    buffer_load_dwordx4 a[176:179], v12, s[20:23], s45 offen offset:2048 sc1
    v_mfma_f32_16x16x32_bf16 v[148:151], a[52:55], v[200:203], v[148:151]
    ds_read_b32 v205, v18 offset:33792
    v_mfma_f32_16x16x32_bf16 v[164:167], a[56:59], v[200:203], v[164:167]
    ds_read_b32 v206, v18 offset:34816
    ds_read_b32 v207, v18 offset:35840
    s_lshl_b32 s32, s30, 7
    s_add_u32 s32, s32, 18993152
    v_and_b32_e64 v224, 7, v1
    v_lshl_add_u32 v224, v224, 10, s32
    buffer_load_dwordx2 v[226:227], v224, s[20:23], 0 offen sc1
    s_waitcnt lgkmcnt(14)
    v_mfma_f32_16x16x32_bf16 v[168:171], v[108:111], v[108:111], v[168:171]
    ds_read_b64_tr_b16 v[104:105], v112 offset:28672
    v_mfma_f32_16x16x32_bf16 v[120:123], a[60:63], v[208:211], v[120:123]
    ds_read_b64_tr_b16 v[106:107], v112 offset:30720
    v_mfma_f32_16x16x32_bf16 v[136:139], a[64:67], v[208:211], v[136:139]
    ds_read_b64_tr_b16 v[188:189], v14 offset:28672
    v_mfma_f32_16x16x32_bf16 v[152:155], a[68:71], v[208:211], v[152:155]
    ds_read_b64_tr_b16 v[190:191], v14 offset:30720
    v_mfma_f32_16x16x32_bf16 v[124:127], a[60:63], v[212:215], v[124:127]
    ds_read_b64_tr_b16 v[192:193], v15 offset:28672
    v_mfma_f32_16x16x32_bf16 v[140:143], a[64:67], v[212:215], v[140:143]
    ds_read_b64_tr_b16 v[194:195], v15 offset:30720
    buffer_load_dwordx4 a[180:183], v10, s[20:23], s45 offen offset:3072 sc1
    v_mfma_f32_16x16x32_bf16 v[156:159], a[68:71], v[212:215], v[156:159]
    ds_read_b64_tr_b16 v[196:197], v16 offset:28672
    v_mfma_f32_16x16x32_bf16 v[128:131], a[60:63], v[216:219], v[128:131]
    ds_read_b64_tr_b16 v[198:199], v16 offset:30720
    v_mfma_f32_16x16x32_bf16 v[144:147], a[64:67], v[216:219], v[144:147]
    ds_read_b64_tr_b16 v[200:201], v17 offset:28672
    buffer_load_dwordx4 a[184:187], v11, s[20:23], s45 offen offset:3072 sc1
    v_mfma_f32_16x16x32_bf16 v[160:163], a[68:71], v[216:219], v[160:163]
    ds_read_b64_tr_b16 v[202:203], v17 offset:30720
    v_mfma_f32_16x16x32_bf16 v[132:135], a[60:63], v[220:223], v[132:135]
    s_waitcnt lgkmcnt(5)
    v_bitop3_b32 v2, v204, v205, v206 bitop3:0x80
    v_mfma_f32_16x16x32_bf16 v[148:151], a[64:67], v[220:223], v[148:151]
    buffer_load_dwordx4 a[188:191], v12, s[20:23], s45 offen offset:3072 sc1
    v_bitop3_b32 v2, v2, v207, 1 bitop3:0x80
    v_mfma_f32_16x16x32_bf16 v[164:167], a[68:71], v[220:223], v[164:167]
    v_cmp_eq_u32 vcc, 0, v2
    s_cbranch_vccnz kf_rt_h2
kf_ok_h2:
    s_waitcnt lgkmcnt(10)
    v_mfma_f32_16x16x32_bf16 v[168:171], v[100:103], v[100:103], v[168:171]
    v_mfma_f32_16x16x32_bf16 v[120:123], a[72:75], v[172:175], v[120:123]
    s_barrier
    v_mfma_f32_16x16x32_bf16 v[136:139], a[76:79], v[172:175], v[136:139]
    ds_read_b64_tr_b16 v[108:109], v112 offset:32768
    s_add_u32 s45, s44, 16384
    buffer_load_dwordx4 a[192:195], v10, s[20:23], s45 offen offset:0 sc1
    v_mfma_f32_16x16x32_bf16 v[152:155], a[80:83], v[172:175], v[152:155]
    ds_read_b64_tr_b16 v[110:111], v112 offset:34816
    v_mfma_f32_16x16x32_bf16 v[124:127], a[72:75], v[176:179], v[124:127]
    ds_read_b64_tr_b16 v[208:209], v14 offset:32768
    v_mfma_f32_16x16x32_bf16 v[140:143], a[76:79], v[176:179], v[140:143]
    ds_read_b64_tr_b16 v[210:211], v14 offset:34816
    buffer_load_dwordx4 a[196:199], v11, s[20:23], s45 offen offset:0 sc1
    v_mfma_f32_16x16x32_bf16 v[156:159], a[80:83], v[176:179], v[156:159]
    ds_read_b64_tr_b16 v[212:213], v15 offset:32768
    v_mfma_f32_16x16x32_bf16 v[128:131], a[72:75], v[180:183], v[128:131]
    ds_read_b64_tr_b16 v[214:215], v15 offset:34816
    v_mfma_f32_16x16x32_bf16 v[144:147], a[76:79], v[180:183], v[144:147]
    ds_read_b64_tr_b16 v[216:217], v16 offset:32768
    buffer_load_dwordx4 a[200:203], v12, s[20:23], s45 offen offset:0 sc1
    v_mfma_f32_16x16x32_bf16 v[160:163], a[80:83], v[180:183], v[160:163]
    ds_read_b64_tr_b16 v[218:219], v16 offset:34816
    v_mfma_f32_16x16x32_bf16 v[132:135], a[72:75], v[184:187], v[132:135]
    ds_read_b64_tr_b16 v[220:221], v17 offset:32768
    v_mfma_f32_16x16x32_bf16 v[148:151], a[76:79], v[184:187], v[148:151]
    ds_read_b64_tr_b16 v[222:223], v17 offset:34816
    buffer_load_dwordx4 a[204:207], v10, s[20:23], s45 offen offset:1024 sc1
    v_mfma_f32_16x16x32_bf16 v[164:167], a[80:83], v[184:187], v[164:167]
    s_waitcnt lgkmcnt(10)
    v_mfma_f32_16x16x32_bf16 v[168:171], v[104:107], v[104:107], v[168:171]
    ds_read_b64_tr_b16 v[100:101], v112 offset:36864
    v_mfma_f32_16x16x32_bf16 v[120:123], a[84:87], v[188:191], v[120:123]
    ds_read_b64_tr_b16 v[102:103], v112 offset:38912
    buffer_load_dwordx4 a[208:211], v11, s[20:23], s45 offen offset:1024 sc1
    v_mfma_f32_16x16x32_bf16 v[136:139], a[88:91], v[188:191], v[136:139]
    ds_read_b64_tr_b16 v[172:173], v14 offset:36864
    v_mfma_f32_16x16x32_bf16 v[152:155], a[92:95], v[188:191], v[152:155]
    ds_read_b64_tr_b16 v[174:175], v14 offset:38912
    v_mfma_f32_16x16x32_bf16 v[124:127], a[84:87], v[192:195], v[124:127]
    ds_read_b64_tr_b16 v[176:177], v15 offset:36864
    buffer_load_dwordx4 a[212:215], v12, s[20:23], s45 offen offset:1024 sc1
    v_mfma_f32_16x16x32_bf16 v[140:143], a[88:91], v[192:195], v[140:143]
    ds_read_b64_tr_b16 v[178:179], v15 offset:38912
    v_mfma_f32_16x16x32_bf16 v[156:159], a[92:95], v[192:195], v[156:159]
    ds_read_b64_tr_b16 v[180:181], v16 offset:36864
    v_mfma_f32_16x16x32_bf16 v[128:131], a[84:87], v[196:199], v[128:131]
    ds_read_b64_tr_b16 v[182:183], v16 offset:38912
    buffer_load_dwordx4 a[216:219], v10, s[20:23], s45 offen offset:2048 sc1
    v_mfma_f32_16x16x32_bf16 v[144:147], a[88:91], v[196:199], v[144:147]
    ds_read_b64_tr_b16 v[184:185], v17 offset:36864
    v_mfma_f32_16x16x32_bf16 v[160:163], a[92:95], v[196:199], v[160:163]
    ds_read_b64_tr_b16 v[186:187], v17 offset:38912
    v_mfma_f32_16x16x32_bf16 v[132:135], a[84:87], v[200:203], v[132:135]
    buffer_load_dwordx4 a[220:223], v11, s[20:23], s45 offen offset:2048 sc1
    v_mfma_f32_16x16x32_bf16 v[148:151], a[88:91], v[200:203], v[148:151]
    v_mfma_f32_16x16x32_bf16 v[164:167], a[92:95], v[200:203], v[164:167]
    s_waitcnt lgkmcnt(10)
    v_mfma_f32_16x16x32_bf16 v[168:171], v[108:111], v[108:111], v[168:171]
    ds_read_b64_tr_b16 v[104:105], v112 offset:40960
    buffer_load_dwordx4 a[224:227], v12, s[20:23], s45 offen offset:2048 sc1
    v_mfma_f32_16x16x32_bf16 v[120:123], a[96:99], v[208:211], v[120:123]
    ds_read_b64_tr_b16 v[106:107], v112 offset:43008
    s_waitcnt vmcnt(12)
    v_mfma_f32_16x16x32_bf16 v[136:139], a[100:103], v[208:211], v[136:139]
    ds_read_b64_tr_b16 v[188:189], v14 offset:40960
    v_cmp_ne_u64 vcc, s[10:11], v[226:227]
    v_mfma_f32_16x16x32_bf16 v[152:155], a[104:107], v[208:211], v[152:155]
    ds_read_b64_tr_b16 v[190:191], v14 offset:43008
    buffer_load_dwordx4 a[228:231], v10, s[20:23], s45 offen offset:3072 sc1
    v_mfma_f32_16x16x32_bf16 v[124:127], a[96:99], v[212:215], v[124:127]
    ds_read_b64_tr_b16 v[192:193], v15 offset:40960
    s_cbranch_vccnz kf_rt_f2
kf_ok_f2:
    v_mfma_f32_16x16x32_bf16 v[140:143], a[100:103], v[212:215], v[140:143]
    ds_read_b64_tr_b16 v[194:195], v15 offset:43008
    v_mfma_f32_16x16x32_bf16 v[156:159], a[104:107], v[212:215], v[156:159]
    ds_read_b64_tr_b16 v[196:197], v16 offset:40960
    buffer_load_dwordx4 a[232:235], v11, s[20:23], s45 offen offset:3072 sc1
    v_mfma_f32_16x16x32_bf16 v[128:131], a[96:99], v[216:219], v[128:131]
    ds_read_b64_tr_b16 v[198:199], v16 offset:43008
    v_mfma_f32_16x16x32_bf16 v[144:147], a[100:103], v[216:219], v[144:147]
    ds_read_b64_tr_b16 v[200:201], v17 offset:40960
    v_mfma_f32_16x16x32_bf16 v[160:163], a[104:107], v[216:219], v[160:163]
    ds_read_b64_tr_b16 v[202:203], v17 offset:43008
    buffer_load_dwordx4 a[236:239], v12, s[20:23], s45 offen offset:3072 sc1
    v_mfma_f32_16x16x32_bf16 v[132:135], a[96:99], v[220:223], v[132:135]
    ds_read_b32 v204, v18 offset:49152
    v_mfma_f32_16x16x32_bf16 v[148:151], a[100:103], v[220:223], v[148:151]
    ds_read_b32 v205, v18 offset:50176
    v_mfma_f32_16x16x32_bf16 v[164:167], a[104:107], v[220:223], v[164:167]
    ds_read_b32 v206, v18 offset:51200
    ds_read_b32 v207, v18 offset:52224
    s_waitcnt lgkmcnt(14)
    v_mfma_f32_16x16x32_bf16 v[168:171], v[100:103], v[100:103], v[168:171]
    ds_read_b64_tr_b16 v[108:109], v112 offset:45056
    v_mfma_f32_16x16x32_bf16 v[120:123], a[108:111], v[172:175], v[120:123]
    ds_read_b64_tr_b16 v[110:111], v112 offset:47104
    v_mfma_f32_16x16x32_bf16 v[136:139], a[112:115], v[172:175], v[136:139]
    ds_read_b64_tr_b16 v[208:209], v14 offset:45056
    v_mfma_f32_16x16x32_bf16 v[152:155], a[116:119], v[172:175], v[152:155]
    ds_read_b64_tr_b16 v[210:211], v14 offset:47104
    v_mfma_f32_16x16x32_bf16 v[124:127], a[108:111], v[176:179], v[124:127]
    ds_read_b64_tr_b16 v[212:213], v15 offset:45056
    v_mfma_f32_16x16x32_bf16 v[140:143], a[112:115], v[176:179], v[140:143]
    ds_read_b64_tr_b16 v[214:215], v15 offset:47104
    s_add_u32 s13, s12, 0
    buffer_load_dwordx4 a[0:3], v10, s[20:23], s13 offen offset:0 sc1
    v_mfma_f32_16x16x32_bf16 v[156:159], a[116:119], v[176:179], v[156:159]
    ds_read_b64_tr_b16 v[216:217], v16 offset:45056
    v_mfma_f32_16x16x32_bf16 v[128:131], a[108:111], v[180:183], v[128:131]
    ds_read_b64_tr_b16 v[218:219], v16 offset:47104
    v_mfma_f32_16x16x32_bf16 v[144:147], a[112:115], v[180:183], v[144:147]
    ds_read_b64_tr_b16 v[220:221], v17 offset:45056
    buffer_load_dwordx4 a[4:7], v10, s[20:23], s13 offen offset:1024 sc1
    v_mfma_f32_16x16x32_bf16 v[160:163], a[116:119], v[180:183], v[160:163]
    ds_read_b64_tr_b16 v[222:223], v17 offset:47104
    v_mfma_f32_16x16x32_bf16 v[132:135], a[108:111], v[184:187], v[132:135]
    s_waitcnt lgkmcnt(5)
    v_bitop3_b32 v2, v204, v205, v206 bitop3:0x80
    v_mfma_f32_16x16x32_bf16 v[148:151], a[112:115], v[184:187], v[148:151]
    buffer_load_dwordx4 a[8:11], v10, s[20:23], s13 offen offset:2048 sc1
    v_bitop3_b32 v2, v2, v207, 1 bitop3:0x80
    v_mfma_f32_16x16x32_bf16 v[164:167], a[116:119], v[184:187], v[164:167]
    v_cmp_eq_u32 vcc, 0, v2
    s_cbranch_vccnz kf_rt_h3
kf_ok_h3:
    s_waitcnt lgkmcnt(10)
    v_mfma_f32_16x16x32_bf16 v[168:171], v[104:107], v[104:107], v[168:171]
    v_mfma_f32_16x16x32_bf16 v[120:123], a[120:123], v[188:191], v[120:123]
    s_barrier
    v_mfma_f32_16x16x32_bf16 v[136:139], a[124:127], v[188:191], v[136:139]
    ds_read_b64_tr_b16 v[100:101], v112 offset:49152
    buffer_load_dwordx4 a[12:15], v10, s[20:23], s13 offen offset:3072 sc1
    v_mfma_f32_16x16x32_bf16 v[152:155], a[128:131], v[188:191], v[152:155]
    ds_read_b64_tr_b16 v[102:103], v112 offset:51200
    v_mfma_f32_16x16x32_bf16 v[124:127], a[120:123], v[192:195], v[124:127]
    ds_read_b64_tr_b16 v[172:173], v14 offset:49152
    v_mfma_f32_16x16x32_bf16 v[140:143], a[124:127], v[192:195], v[140:143]
    ds_read_b64_tr_b16 v[174:175], v14 offset:51200
    s_add_u32 s13, s12, 4096
    buffer_load_dwordx4 a[16:19], v10, s[20:23], s13 offen offset:0 sc1
    v_mfma_f32_16x16x32_bf16 v[156:159], a[128:131], v[192:195], v[156:159]
    ds_read_b64_tr_b16 v[176:177], v15 offset:49152
    v_mfma_f32_16x16x32_bf16 v[128:131], a[120:123], v[196:199], v[128:131]
    ds_read_b64_tr_b16 v[178:179], v15 offset:51200
    v_mfma_f32_16x16x32_bf16 v[144:147], a[124:127], v[196:199], v[144:147]
    ds_read_b64_tr_b16 v[180:181], v16 offset:49152
    buffer_load_dwordx4 a[20:23], v10, s[20:23], s13 offen offset:1024 sc1
    v_mfma_f32_16x16x32_bf16 v[160:163], a[128:131], v[196:199], v[160:163]
    ds_read_b64_tr_b16 v[182:183], v16 offset:51200
    v_mfma_f32_16x16x32_bf16 v[132:135], a[120:123], v[200:203], v[132:135]
    ds_read_b64_tr_b16 v[184:185], v17 offset:49152
    v_mfma_f32_16x16x32_bf16 v[148:151], a[124:127], v[200:203], v[148:151]
    ds_read_b64_tr_b16 v[186:187], v17 offset:51200
    v_mfma_f32_16x16x32_bf16 v[164:167], a[128:131], v[200:203], v[164:167]
    s_waitcnt lgkmcnt(10)
    v_mfma_f32_16x16x32_bf16 v[168:171], v[108:111], v[108:111], v[168:171]
    ds_read_b64_tr_b16 v[104:105], v112 offset:53248
    buffer_load_dwordx4 a[24:27], v10, s[20:23], s13 offen offset:2048 sc1
    v_mfma_f32_16x16x32_bf16 v[120:123], a[132:135], v[208:211], v[120:123]
    ds_read_b64_tr_b16 v[106:107], v112 offset:55296
    v_mfma_f32_16x16x32_bf16 v[136:139], a[136:139], v[208:211], v[136:139]
    ds_read_b64_tr_b16 v[188:189], v14 offset:53248
    v_mfma_f32_16x16x32_bf16 v[152:155], a[140:143], v[208:211], v[152:155]
    ds_read_b64_tr_b16 v[190:191], v14 offset:55296
    buffer_load_dwordx4 a[28:31], v10, s[20:23], s13 offen offset:3072 sc1
    v_mfma_f32_16x16x32_bf16 v[124:127], a[132:135], v[212:215], v[124:127]
    ds_read_b64_tr_b16 v[192:193], v15 offset:53248
    v_mfma_f32_16x16x32_bf16 v[140:143], a[136:139], v[212:215], v[140:143]
    ds_read_b64_tr_b16 v[194:195], v15 offset:55296
    v_mfma_f32_16x16x32_bf16 v[156:159], a[140:143], v[212:215], v[156:159]
    ds_read_b64_tr_b16 v[196:197], v16 offset:53248
    s_add_u32 s13, s12, 8192
    buffer_load_dwordx4 a[32:35], v10, s[20:23], s13 offen offset:0 sc1
    v_mfma_f32_16x16x32_bf16 v[128:131], a[132:135], v[216:219], v[128:131]
    ds_read_b64_tr_b16 v[198:199], v16 offset:55296
    v_mfma_f32_16x16x32_bf16 v[144:147], a[136:139], v[216:219], v[144:147]
    ds_read_b64_tr_b16 v[200:201], v17 offset:53248
    v_mfma_f32_16x16x32_bf16 v[160:163], a[140:143], v[216:219], v[160:163]
    ds_read_b64_tr_b16 v[202:203], v17 offset:55296
    v_mfma_f32_16x16x32_bf16 v[132:135], a[132:135], v[220:223], v[132:135]
    s_mul_i32 s32, s30, 384
    s_mul_i32 s34, s28, 96
    s_add_u32 s32, s32, s34
    v_mfma_f32_16x16x32_bf16 v[148:151], a[136:139], v[220:223], v[148:151]
    v_lshrrev_b32 v2, 4, v1
    v_lshl_add_u32 v240, v2, 3, s32
    v_mfma_f32_16x16x32_bf16 v[164:167], a[140:143], v[220:223], v[164:167]
    global_load_dwordx2 v[236:237], v240, s[54:55] offset:0
    global_load_dwordx2 v[238:239], v240, s[54:55] offset:32
    global_load_dwordx2 v[240:241], v240, s[54:55] offset:64
    s_waitcnt lgkmcnt(10)
    v_mfma_f32_16x16x32_bf16 v[168:171], v[100:103], v[100:103], v[168:171]
    ds_read_b64_tr_b16 v[108:109], v112 offset:57344
    s_mul_i32 s32, s30, 160
    v_mfma_f32_16x16x32_bf16 v[120:123], a[144:147], v[172:175], v[120:123]
    ds_read_b64_tr_b16 v[110:111], v112 offset:59392
    v_lshrrev_b32 v2, 4, v1
    v_mfma_f32_16x16x32_bf16 v[136:139], a[148:151], v[172:175], v[136:139]
    ds_read_b64_tr_b16 v[208:209], v14 offset:57344
    buffer_load_dwordx4 a[36:39], v10, s[20:23], s13 offen offset:1024 sc1
    v_mfma_f32_16x16x32_bf16 v[152:155], a[152:155], v[172:175], v[152:155]
    ds_read_b64_tr_b16 v[210:211], v14 offset:59392
    v_lshl_add_u32 v246, v2, 4, s32
    v_mfma_f32_16x16x32_bf16 v[124:127], a[144:147], v[176:179], v[124:127]
    ds_read_b64_tr_b16 v[212:213], v15 offset:57344
    v_lshl_add_u32 v250, v2, 3, s32
    v_mfma_f32_16x16x32_bf16 v[140:143], a[148:151], v[176:179], v[140:143]
    ds_read_b64_tr_b16 v[214:215], v15 offset:59392
    global_load_dwordx4 v[242:245], v246, s[58:59]
    v_mfma_f32_16x16x32_bf16 v[156:159], a[152:155], v[176:179], v[156:159]
    ds_read_b64_tr_b16 v[216:217], v16 offset:57344
    v_mfma_f32_16x16x32_bf16 v[128:131], a[144:147], v[180:183], v[128:131]
    ds_read_b64_tr_b16 v[218:219], v16 offset:59392
    v_mfma_f32_16x16x32_bf16 v[144:147], a[148:151], v[180:183], v[144:147]
    ds_read_b64_tr_b16 v[220:221], v17 offset:57344
    global_load_dwordx4 v[246:249], v246, s[58:59] offset:64
    v_mfma_f32_16x16x32_bf16 v[160:163], a[152:155], v[180:183], v[160:163]
    ds_read_b64_tr_b16 v[222:223], v17 offset:59392
    v_mfma_f32_16x16x32_bf16 v[132:135], a[144:147], v[184:187], v[132:135]
    ds_read_b32 v204, v19 offset:0
    v_mfma_f32_16x16x32_bf16 v[148:151], a[148:151], v[184:187], v[148:151]
    ds_read_b32 v205, v19 offset:1024
    global_load_dwordx2 v[250:251], v250, s[58:59] offset:128
    v_mfma_f32_16x16x32_bf16 v[164:167], a[152:155], v[184:187], v[164:167]
    ds_read_b32 v206, v19 offset:2048
    ds_read_b32 v207, v19 offset:3072
    s_waitcnt lgkmcnt(14)
    v_mfma_f32_16x16x32_bf16 v[168:171], v[104:107], v[104:107], v[168:171]
    ds_read_b64_tr_b16 v[100:101], v112 offset:61440
    v_mfma_f32_16x16x32_bf16 v[120:123], a[156:159], v[188:191], v[120:123]
    ds_read_b64_tr_b16 v[102:103], v112 offset:63488
    v_mfma_f32_16x16x32_bf16 v[136:139], a[160:163], v[188:191], v[136:139]
    ds_read_b64_tr_b16 v[172:173], v14 offset:61440
    v_mfma_f32_16x16x32_bf16 v[152:155], a[164:167], v[188:191], v[152:155]
    ds_read_b64_tr_b16 v[174:175], v14 offset:63488
    v_mfma_f32_16x16x32_bf16 v[124:127], a[156:159], v[192:195], v[124:127]
    ds_read_b64_tr_b16 v[176:177], v15 offset:61440
    v_mfma_f32_16x16x32_bf16 v[140:143], a[160:163], v[192:195], v[140:143]
    ds_read_b64_tr_b16 v[178:179], v15 offset:63488
    buffer_load_dwordx4 a[40:43], v10, s[20:23], s13 offen offset:2048 sc1
    v_mfma_f32_16x16x32_bf16 v[156:159], a[164:167], v[192:195], v[156:159]
    ds_read_b64_tr_b16 v[180:181], v16 offset:61440
    v_mfma_f32_16x16x32_bf16 v[128:131], a[156:159], v[196:199], v[128:131]
    ds_read_b64_tr_b16 v[182:183], v16 offset:63488
    v_mfma_f32_16x16x32_bf16 v[144:147], a[160:163], v[196:199], v[144:147]
    ds_read_b64_tr_b16 v[184:185], v17 offset:61440
    buffer_load_dwordx4 a[44:47], v10, s[20:23], s13 offen offset:3072 sc1
    v_mfma_f32_16x16x32_bf16 v[160:163], a[164:167], v[196:199], v[160:163]
    ds_read_b64_tr_b16 v[186:187], v17 offset:63488
    v_mfma_f32_16x16x32_bf16 v[132:135], a[156:159], v[200:203], v[132:135]
    s_waitcnt lgkmcnt(5)
    v_bitop3_b32 v2, v204, v205, v206 bitop3:0x80
    v_mfma_f32_16x16x32_bf16 v[148:151], a[160:163], v[200:203], v[148:151]
    s_add_u32 s13, s12, 12288
    buffer_load_dwordx4 a[48:51], v10, s[20:23], s13 offen offset:0 sc1
    v_mfma_f32_16x16x32_bf16 v[164:167], a[164:167], v[200:203], v[164:167]
    v_bitop3_b32 v2, v2, v207, 1 bitop3:0x80
    v_cmp_eq_u32 vcc, 0, v2
    s_cbranch_vccnz kf_rt_h4
kf_ok_h4:
    s_lshl_b32 s32, s29, 8
    s_lshl_b32 s34, s28, 6
    s_add_u32 s32, s32, s34
    s_add_u32 s32, s32, 2629632
    v_and_b32 v13, 15, v1
    v_lshlrev_b32_e64 v13, 2, v13
    s_waitcnt lgkmcnt(10)
    v_mfma_f32_16x16x32_bf16 v[168:171], v[108:111], v[108:111], v[168:171]
    v_add_u32 v14, 0x10000, v14
    v_add_u32 v15, 0x10000, v15
    v_mfma_f32_16x16x32_bf16 v[120:123], a[168:171], v[208:211], v[120:123]
    v_add_u32 v16, 0x10000, v16
    v_add_u32 v17, 0x10000, v17
    v_add_u32 v112, 0x10000, v112
    s_barrier
    v_mfma_f32_16x16x32_bf16 v[136:139], a[172:175], v[208:211], v[136:139]
    ds_read_b64_tr_b16 v[104:105], v112 offset:0
    buffer_load_dwordx4 a[52:55], v10, s[20:23], s13 offen offset:1024 sc1
    v_mfma_f32_16x16x32_bf16 v[152:155], a[176:179], v[208:211], v[152:155]
    ds_read_b64_tr_b16 v[106:107], v112 offset:2048
    s_lshl_b32 s8, s29, 3
    v_mfma_f32_16x16x32_bf16 v[124:127], a[168:171], v[212:215], v[124:127]
    ds_read_b64_tr_b16 v[188:189], v14 offset:0
    s_add_u32 s8, s8, s30
    v_mfma_f32_16x16x32_bf16 v[140:143], a[172:175], v[212:215], v[140:143]
    ds_read_b64_tr_b16 v[190:191], v14 offset:2048
    buffer_load_dwordx4 a[56:59], v10, s[20:23], s13 offen offset:2048 sc1
    v_mfma_f32_16x16x32_bf16 v[156:159], a[176:179], v[212:215], v[156:159]
    ds_read_b64_tr_b16 v[192:193], v15 offset:0
    s_mul_i32 s8, s8, 24576
    v_mfma_f32_16x16x32_bf16 v[128:131], a[168:171], v[216:219], v[128:131]
    ds_read_b64_tr_b16 v[194:195], v15 offset:2048
    s_add_u32 s8, s8, 12582912
    v_mfma_f32_16x16x32_bf16 v[144:147], a[172:175], v[216:219], v[144:147]
    ds_read_b64_tr_b16 v[196:197], v16 offset:0
    buffer_load_dwordx4 a[60:63], v10, s[20:23], s13 offen offset:3072 sc1
    v_mfma_f32_16x16x32_bf16 v[160:163], a[176:179], v[216:219], v[160:163]
    ds_read_b64_tr_b16 v[198:199], v16 offset:2048
    s_lshr_b32 s3, s28, 1
    v_mfma_f32_16x16x32_bf16 v[132:135], a[168:171], v[220:223], v[132:135]
    ds_read_b64_tr_b16 v[200:201], v17 offset:0
    s_add_u32 s3, s3, 4
    v_mfma_f32_16x16x32_bf16 v[148:151], a[172:175], v[220:223], v[148:151]
    ds_read_b64_tr_b16 v[202:203], v17 offset:2048
    s_lshl_b32 s3, s3, 10
    v_mfma_f32_16x16x32_bf16 v[164:167], a[176:179], v[220:223], v[164:167]
    s_add_u32 s3, s3, s8
    s_and_b32 s4, s28, 1
    s_lshl_b32 s4, s4, 9
    s_add_u32 s3, s3, s4
    s_lshl_b32 s4, s28, 10
    s_add_u32 s8, s8, s4
    s_movk_i32 s4, 0
    s_movk_i32 s5, 6144
    s_movk_i32 s6, 12288
    s_movk_i32 s7, 18432
    s_waitcnt vmcnt(34)
    s_waitcnt lgkmcnt(10)
    v_mfma_f32_16x16x32_bf16 v[168:171], v[100:103], v[100:103], v[168:171]
    ds_read_b64_tr_b16 v[108:109], v112 offset:4096
    buffer_load_dword v13, v13, s[20:23], s32 offen sc1
    v_mfma_f32_16x16x32_bf16 v[120:123], a[180:183], v[172:175], v[120:123]
    ds_read_b64_tr_b16 v[110:111], v112 offset:6144
    v_and_b32 v2, 31, v1
    v_mfma_f32_16x16x32_bf16 v[136:139], a[184:187], v[172:175], v[136:139]
    ds_read_b64_tr_b16 v[208:209], v14 offset:4096
    v_lshlrev_b32_e64 v2, 4, v2
    v_mfma_f32_16x16x32_bf16 v[152:155], a[188:191], v[172:175], v[152:155]
    ds_read_b64_tr_b16 v[210:211], v14 offset:6144
    s_add_u32 s13, s12, 16384
    buffer_load_dwordx4 a[64:67], v10, s[20:23], s13 offen offset:0 sc1
    v_mfma_f32_16x16x32_bf16 v[124:127], a[180:183], v[176:179], v[124:127]
    ds_read_b64_tr_b16 v[212:213], v15 offset:4096
    v_cmp_gt_u32 vcc, 32, v1
    v_mfma_f32_16x16x32_bf16 v[140:143], a[184:187], v[176:179], v[140:143]
    ds_read_b64_tr_b16 v[214:215], v15 offset:6144
    v_mov_b32 v204, s4
    v_mfma_f32_16x16x32_bf16 v[156:159], a[188:191], v[176:179], v[156:159]
    ds_read_b64_tr_b16 v[216:217], v16 offset:4096
    buffer_load_dwordx4 a[68:71], v10, s[20:23], s13 offen offset:1024 sc1
    v_mfma_f32_16x16x32_bf16 v[128:131], a[180:183], v[180:183], v[128:131]
    ds_read_b64_tr_b16 v[218:219], v16 offset:6144
    v_mov_b32 v205, s5
    v_mfma_f32_16x16x32_bf16 v[144:147], a[184:187], v[180:183], v[144:147]
    ds_read_b64_tr_b16 v[220:221], v17 offset:4096
    v_cndmask_b32 v204, v205, v204, vcc
    v_mfma_f32_16x16x32_bf16 v[160:163], a[188:191], v[180:183], v[160:163]
    ds_read_b64_tr_b16 v[222:223], v17 offset:6144
    buffer_load_dwordx4 a[72:75], v10, s[20:23], s13 offen offset:2048 sc1
    v_mfma_f32_16x16x32_bf16 v[132:135], a[180:183], v[184:187], v[132:135]
    v_add_u32_e64 v11, v2, v204
    v_mov_b32 v204, s6
    v_mfma_f32_16x16x32_bf16 v[148:151], a[184:187], v[184:187], v[148:151]
    v_mov_b32 v205, s7
    v_cndmask_b32 v204, v205, v204, vcc
    v_mfma_f32_16x16x32_bf16 v[164:167], a[188:191], v[184:187], v[164:167]
    v_add_u32 v12, v2, v204
    s_add_u32 s4, s4, s8
    s_add_u32 s5, s5, s8
    s_add_u32 s6, s6, s8
    s_add_u32 s7, s7, s8
    s_waitcnt vmcnt(35)
    s_waitcnt lgkmcnt(10)
    v_mfma_f32_16x16x32_bf16 v[168:171], v[104:107], v[104:107], v[168:171]
    ds_read_b64_tr_b16 v[100:101], v112 offset:8192
    buffer_load_dwordx4 a[76:79], v10, s[20:23], s13 offen offset:3072 sc1
    v_mfma_f32_16x16x32_bf16 v[120:123], a[192:195], v[188:191], v[120:123]
    ds_read_b64_tr_b16 v[102:103], v112 offset:10240
    v_and_b32 v2, 3, v1
    v_mfma_f32_16x16x32_bf16 v[136:139], a[196:199], v[188:191], v[136:139]
    ds_read_b64_tr_b16 v[172:173], v14 offset:8192
    v_cmp_eq_u32 vcc, 1, v2
    v_mfma_f32_16x16x32_bf16 v[152:155], a[200:203], v[188:191], v[152:155]
    ds_read_b64_tr_b16 v[174:175], v14 offset:10240
    s_add_u32 s13, s12, 20480
    buffer_load_dwordx4 a[80:83], v10, s[20:23], s13 offen offset:0 sc1
    v_mfma_f32_16x16x32_bf16 v[124:127], a[192:195], v[192:195], v[124:127]
    ds_read_b64_tr_b16 v[176:177], v15 offset:8192
    v_cmp_eq_u32 s[34:35], 2, v2
    v_mfma_f32_16x16x32_bf16 v[140:143], a[196:199], v[192:195], v[140:143]
    ds_read_b64_tr_b16 v[178:179], v15 offset:10240
    v_cmp_eq_u32 s[36:37], 3, v2
    v_mfma_f32_16x16x32_bf16 v[156:159], a[200:203], v[192:195], v[156:159]
    ds_read_b64_tr_b16 v[180:181], v16 offset:8192
    buffer_load_dwordx4 a[84:87], v10, s[20:23], s13 offen offset:1024 sc1
    v_mfma_f32_16x16x32_bf16 v[128:131], a[192:195], v[196:199], v[128:131]
    ds_read_b64_tr_b16 v[182:183], v16 offset:10240
    v_bfe_u32 v18, v1, 2, 2
    v_mfma_f32_16x16x32_bf16 v[144:147], a[196:199], v[196:199], v[144:147]
    ds_read_b64_tr_b16 v[184:185], v17 offset:8192
    v_lshrrev_b32_e64 v19, 4, v1
    v_mfma_f32_16x16x32_bf16 v[160:163], a[200:203], v[196:199], v[160:163]
    ds_read_b64_tr_b16 v[186:187], v17 offset:10240
    v_cmp_eq_u32 s[38:39], v18, v19
    v_mfma_f32_16x16x32_bf16 v[132:135], a[192:195], v[200:203], v[132:135]
    v_and_b32_e64 v18, 15, v1
    v_lshlrev_b32 v18, 2, v18
    v_mfma_f32_16x16x32_bf16 v[148:151], a[196:199], v[200:203], v[148:151]
    s_lshl_b32 s32, s28, 6
    s_add_u32 s32, s32, 143360
    v_mfma_f32_16x16x32_bf16 v[164:167], a[200:203], v[200:203], v[164:167]
    v_add_u32 v19, s32, v18
    v_add_u32 v18, 143360, v18
    s_waitcnt vmcnt(35)
    s_waitcnt lgkmcnt(10)
    v_mfma_f32_16x16x32_bf16 v[168:171], v[108:111], v[108:111], v[168:171]
    ds_read_b64_tr_b16 v[104:105], v112 offset:12288
    buffer_load_dwordx4 a[88:91], v10, s[20:23], s13 offen offset:2048 sc1
    v_mfma_f32_16x16x32_bf16 v[120:123], a[204:207], v[208:211], v[120:123]
    ds_read_b64_tr_b16 v[106:107], v112 offset:14336
    s_waitcnt vmcnt(18)
    v_mfma_f32_16x16x32_bf16 v[136:139], a[208:211], v[208:211], v[136:139]
    ds_read_b64_tr_b16 v[188:189], v14 offset:12288
    v_and_b32 v225, 0xffff0000, v236
    v_mfma_f32_16x16x32_bf16 v[152:155], a[212:215], v[208:211], v[152:155]
    ds_read_b64_tr_b16 v[190:191], v14 offset:14336
    buffer_load_dwordx4 a[92:95], v10, s[20:23], s13 offen offset:3072 sc1
    v_mfma_f32_16x16x32_bf16 v[124:127], a[204:207], v[212:215], v[124:127]
    ds_read_b64_tr_b16 v[192:193], v15 offset:12288
    v_lshlrev_b32_e64 v224, 16, v236
    v_mfma_f32_16x16x32_bf16 v[140:143], a[208:211], v[212:215], v[140:143]
    ds_read_b64_tr_b16 v[194:195], v15 offset:14336
    v_and_b32 v227, 0xffff0000, v237
    v_mfma_f32_16x16x32_bf16 v[156:159], a[212:215], v[212:215], v[156:159]
    ds_read_b64_tr_b16 v[196:197], v16 offset:12288
    s_add_u32 s13, s12, 24576
    buffer_load_dwordx4 a[96:99], v10, s[20:23], s13 offen offset:0 sc1
    v_mfma_f32_16x16x32_bf16 v[128:131], a[204:207], v[216:219], v[128:131]
    ds_read_b64_tr_b16 v[198:199], v16 offset:14336
    v_lshlrev_b32_e64 v226, 16, v237
    v_mfma_f32_16x16x32_bf16 v[144:147], a[208:211], v[216:219], v[144:147]
    ds_read_b64_tr_b16 v[200:201], v17 offset:12288
    v_and_b32 v229, 0xffff0000, v238
    s_waitcnt lgkmcnt(8)
    v_mfma_f32_16x16x32_bf16 v[168:171], v[100:103], v[100:103], v[168:171]
    ds_read_b64_tr_b16 v[202:203], v17 offset:14336
    v_lshlrev_b32 v228, 16, v238
    v_mfma_f32_16x16x32_bf16 v[160:163], a[212:215], v[216:219], v[160:163]
    v_and_b32 v231, 0xffff0000, v239
    v_lshlrev_b32_e64 v230, 16, v239
    v_mfma_f32_16x16x32_bf16 v[132:135], a[204:207], v[220:223], v[132:135]
    v_and_b32 v233, 0xffff0000, v240
    v_lshlrev_b32_e64 v232, 16, v240
    v_mfma_f32_16x16x32_bf16 v[148:151], a[208:211], v[220:223], v[148:151]
    v_and_b32 v235, 0xffff0000, v241
    v_lshlrev_b32_e64 v234, 16, v241
    v_mfma_f32_16x16x32_bf16 v[164:167], a[212:215], v[220:223], v[164:167]
    s_waitcnt lgkmcnt(8)
    v_mfma_f32_16x16x32_bf16 v[168:171], v[104:107], v[104:107], v[168:171]
    buffer_load_dwordx4 a[100:103], v10, s[20:23], s13 offen offset:1024 sc1
    s_mov_b32 s46, 0xbdd2d3e8
    v_mfma_f32_16x16x32_bf16 v[120:123], a[216:219], v[172:175], v[120:123]
    s_mov_b32 s47, 0xbdd2d3e8
    s_nop 0
    v_mfma_f32_16x16x32_bf16 v[136:139], a[220:223], v[172:175], v[136:139]
    s_nop 0
    s_nop 0
    v_mfma_f32_16x16x32_bf16 v[152:155], a[224:227], v[172:175], v[152:155]
    buffer_load_dwordx4 a[104:107], v10, s[20:23], s13 offen offset:2048 sc1
    s_nop 0
    v_mfma_f32_16x16x32_bf16 v[124:127], a[216:219], v[176:179], v[124:127]
    v_cndmask_b32 v204, v168, v169, vcc
    v_cndmask_b32 v204, v204, v170, s[34:35]
    v_mfma_f32_16x16x32_bf16 v[140:143], a[220:223], v[176:179], v[140:143]
    v_cndmask_b32 v204, v204, v171, s[36:37]
    v_mul_f32 v204, 0x36a3d70a, v204
    v_mfma_f32_16x16x32_bf16 v[156:159], a[224:227], v[176:179], v[156:159]
    buffer_load_dwordx4 a[108:111], v10, s[20:23], s13 offen offset:3072 sc1
    v_add_f32 v205, 0x3727c5ac, v204
    v_mfma_f32_16x16x32_bf16 v[128:131], a[216:219], v[180:183], v[128:131]
    v_rcp_f32 v206, v205
    v_mfma_f32_16x16x32_bf16 v[144:147], a[220:223], v[180:183], v[144:147]
    v_rsq_f32 v205, v205
    v_mfma_f32_16x16x32_bf16 v[160:163], a[224:227], v[180:183], v[160:163]
    v_fmaak_f32 v204, v204, v206, 0x3727c5ac
    v_mfma_f32_16x16x32_bf16 v[132:135], a[216:219], v[184:187], v[132:135]
    v_rsq_f32_e64 v204, v204
    v_mfma_f32_16x16x32_bf16 v[148:151], a[220:223], v[184:187], v[148:151]
    v_mul_f32 v205, 0x3b4ccccd, v205
    v_mul_f32_e64 v204, v204, v205
    v_mfma_f32_16x16x32_bf16 v[164:167], a[224:227], v[184:187], v[164:167]
    s_mov_b64 exec, s[38:39]
    ds_write_b32 v19, v204
    s_mov_b64 exec, -1
    s_waitcnt lgkmcnt(0)
    v_mfma_f32_16x16x32_bf16 v[120:123], a[228:231], v[188:191], v[120:123]
    v_mfma_f32_16x16x32_bf16 v[136:139], a[232:235], v[188:191], v[136:139]
    s_barrier
    v_mfma_f32_16x16x32_bf16 v[152:155], a[236:239], v[188:191], v[152:155]
    s_add_u32 s13, s12, 28672
    buffer_load_dwordx4 a[112:115], v10, s[20:23], s13 offen offset:0 sc1
    v_mfma_f32_16x16x32_bf16 v[124:127], a[228:231], v[192:195], v[124:127]
    ds_read_b32 v168, v18 offset:0
    v_mfma_f32_16x16x32_bf16 v[140:143], a[232:235], v[192:195], v[140:143]
    ds_read_b32 v169, v18 offset:64
    v_mfma_f32_16x16x32_bf16 v[156:159], a[236:239], v[192:195], v[156:159]
    buffer_load_dwordx4 a[116:119], v10, s[20:23], s13 offen offset:1024 sc1
    ds_read_b32 v170, v18 offset:128
    v_mfma_f32_16x16x32_bf16 v[128:131], a[228:231], v[196:199], v[128:131]
    ds_read_b32 v171, v18 offset:192
    v_mov_b32 v18, 0xc0135761
    v_mfma_f32_16x16x32_bf16 v[144:147], a[232:235], v[196:199], v[144:147]
    v_mov_b32 v19, 0xc0135761
    v_mfma_f32_16x16x32_bf16 v[160:163], a[236:239], v[196:199], v[160:163]
    buffer_load_dwordx4 a[120:123], v10, s[20:23], s13 offen offset:2048 sc1
    v_mfma_f32_16x16x32_bf16 v[132:135], a[228:231], v[200:203], v[132:135]
    v_mfma_f32_16x16x32_bf16 v[148:151], a[232:235], v[200:203], v[148:151]
    v_mfma_f32_16x16x32_bf16 v[164:167], a[236:239], v[200:203], v[164:167]
    s_waitcnt lgkmcnt(0)
    v_pk_fma_f32 v[120:121], v[120:121], v[168:169], v[224:225] op_sel:[0,0,0] op_sel_hi:[1,0,1]
    v_pk_fma_f32 v[122:123], v[122:123], v[168:169], v[226:227] op_sel:[0,0,0] op_sel_hi:[1,0,1]
    v_pk_mul_f32 v[204:205], v[120:121], v[120:121]
    v_pk_mul_f32 v[206:207], v[122:123], v[122:123]
    v_pk_fma_f32 v[204:205], v[204:205], s[46:47], v[18:19]
    v_pk_fma_f32 v[206:207], v[206:207], s[46:47], v[18:19]
    v_pk_mul_f32 v[204:205], v[204:205], v[120:121]
    v_pk_mul_f32 v[206:207], v[206:207], v[122:123]
    v_exp_f32 v204, v204
    v_exp_f32_e64 v205, v205
    v_exp_f32 v206, v206
    v_exp_f32 v207, v207
    v_pk_add_f32 v[204:205], v[204:205], 1.0 op_sel_hi:[1,0]
    v_pk_add_f32 v[206:207], v[206:207], 1.0 op_sel_hi:[1,0]
    v_rcp_f32 v204, v204
    v_rcp_f32 v205, v205
    buffer_load_dwordx4 a[124:127], v10, s[20:23], s13 offen offset:3072 sc1
    v_rcp_f32 v206, v206
    v_rcp_f32 v207, v207
    v_pk_mul_f32 v[204:205], v[204:205], v[120:121]
    v_pk_mul_f32 v[206:207], v[206:207], v[122:123]
    v_cvt_pk_bf16_f32 v172, v204, v205
    v_cvt_pk_bf16_f32 v173, v206, v207
    v_pk_fma_f32 v[136:137], v[136:137], v[168:169], v[228:229] op_sel:[0,0,0] op_sel_hi:[1,0,1]
    v_pk_fma_f32 v[138:139], v[138:139], v[168:169], v[230:231] op_sel:[0,0,0] op_sel_hi:[1,0,1]
    v_pk_mul_f32 v[208:209], v[136:137], v[136:137]
    v_pk_mul_f32 v[210:211], v[138:139], v[138:139]
    v_pk_fma_f32 v[208:209], v[208:209], s[46:47], v[18:19]
    v_pk_fma_f32 v[210:211], v[210:211], s[46:47], v[18:19]
    v_pk_mul_f32 v[208:209], v[208:209], v[136:137]
    v_pk_mul_f32 v[210:211], v[210:211], v[138:139]
    v_exp_f32 v208, v208
    v_exp_f32 v209, v209
    v_exp_f32_e64 v210, v210
    s_add_u32 s13, s12, 32768
    buffer_load_dwordx4 a[128:131], v10, s[20:23], s13 offen offset:0 sc1
    v_exp_f32_e64 v211, v211
    v_pk_add_f32 v[208:209], v[208:209], 1.0 op_sel_hi:[1,0]
    v_pk_add_f32 v[210:211], v[210:211], 1.0 op_sel_hi:[1,0]
    v_rcp_f32 v208, v208
    v_rcp_f32 v209, v209
    v_rcp_f32 v210, v210
    v_rcp_f32 v211, v211
    v_pk_mul_f32 v[208:209], v[208:209], v[136:137]
    v_pk_mul_f32 v[210:211], v[210:211], v[138:139]
    v_cvt_pk_bf16_f32 v174, v208, v209
    v_cvt_pk_bf16_f32 v175, v210, v211
    buffer_store_dwordx4 v[172:175], v10, s[20:23], s4 offen sc1
    v_pk_fma_f32 v[124:125], v[124:125], v[168:169], v[224:225] op_sel:[0,1,0] op_sel_hi:[1,1,1]
    v_pk_fma_f32 v[126:127], v[126:127], v[168:169], v[226:227] op_sel:[0,1,0] op_sel_hi:[1,1,1]
    v_pk_mul_f32 v[204:205], v[124:125], v[124:125]
    v_pk_mul_f32 v[206:207], v[126:127], v[126:127]
    v_pk_fma_f32 v[204:205], v[204:205], s[46:47], v[18:19]
    buffer_load_dwordx4 a[132:135], v10, s[20:23], s13 offen offset:1024 sc1
    v_pk_fma_f32 v[206:207], v[206:207], s[46:47], v[18:19]
    v_pk_mul_f32 v[204:205], v[204:205], v[124:125]
    v_pk_mul_f32 v[206:207], v[206:207], v[126:127]
    v_exp_f32 v204, v204
    v_exp_f32 v205, v205
    v_exp_f32 v206, v206
    v_exp_f32 v207, v207
    v_pk_add_f32 v[204:205], v[204:205], 1.0 op_sel_hi:[1,0]
    v_pk_add_f32 v[206:207], v[206:207], 1.0 op_sel_hi:[1,0]
    v_rcp_f32 v204, v204
    v_rcp_f32 v205, v205
    v_rcp_f32 v206, v206
    v_rcp_f32 v207, v207
    v_pk_mul_f32 v[204:205], v[204:205], v[124:125]
    buffer_load_dwordx4 a[136:139], v10, s[20:23], s13 offen offset:2048 sc1
    v_pk_mul_f32 v[206:207], v[206:207], v[126:127]
    v_cvt_pk_bf16_f32 v176, v204, v205
    v_cvt_pk_bf16_f32 v177, v206, v207
    v_pk_fma_f32 v[140:141], v[140:141], v[168:169], v[228:229] op_sel:[0,1,0] op_sel_hi:[1,1,1]
    v_pk_fma_f32 v[142:143], v[142:143], v[168:169], v[230:231] op_sel:[0,1,0] op_sel_hi:[1,1,1]
    v_pk_mul_f32 v[208:209], v[140:141], v[140:141]
    v_pk_mul_f32 v[210:211], v[142:143], v[142:143]
    v_pk_fma_f32 v[208:209], v[208:209], s[46:47], v[18:19]
    v_pk_fma_f32 v[210:211], v[210:211], s[46:47], v[18:19]
    v_pk_mul_f32 v[208:209], v[208:209], v[140:141]
    v_pk_mul_f32 v[210:211], v[210:211], v[142:143]
    v_exp_f32 v208, v208
    v_exp_f32 v209, v209
    v_exp_f32 v210, v210
    v_exp_f32 v211, v211
    v_pk_add_f32 v[208:209], v[208:209], 1.0 op_sel_hi:[1,0]
    v_pk_add_f32 v[210:211], v[210:211], 1.0 op_sel_hi:[1,0]
    buffer_load_dwordx4 a[140:143], v10, s[20:23], s13 offen offset:3072 sc1
    v_rcp_f32 v208, v208
    v_rcp_f32 v209, v209
    v_rcp_f32 v210, v210
    v_rcp_f32 v211, v211
    v_pk_mul_f32 v[208:209], v[208:209], v[140:141]
    v_pk_mul_f32 v[210:211], v[210:211], v[142:143]
    v_cvt_pk_bf16_f32 v178, v208, v209
    v_cvt_pk_bf16_f32 v179, v210, v211
    buffer_store_dwordx4 v[176:179], v10, s[20:23], s5 offen sc1
    v_pk_fma_f32 v[152:153], v[152:153], v[168:169], v[232:233] op_sel:[0,0,0] op_sel_hi:[1,0,1]
    v_pk_fma_f32 v[154:155], v[154:155], v[168:169], v[234:235] op_sel:[0,0,0] op_sel_hi:[1,0,1]
    v_pk_mul_f32 v[204:205], v[152:153], v[152:153]
    v_pk_mul_f32 v[206:207], v[154:155], v[154:155]
    v_pk_fma_f32 v[204:205], v[204:205], s[46:47], v[18:19]
    v_pk_fma_f32 v[206:207], v[206:207], s[46:47], v[18:19]
    v_pk_mul_f32 v[204:205], v[204:205], v[152:153]
    v_pk_mul_f32 v[206:207], v[206:207], v[154:155]
    s_add_u32 s13, s12, 36864
    buffer_load_dwordx4 a[144:147], v10, s[20:23], s13 offen offset:0 sc1
    v_exp_f32 v204, v204
    v_exp_f32 v205, v205
    v_exp_f32 v206, v206
    v_exp_f32 v207, v207
    v_pk_add_f32 v[204:205], v[204:205], 1.0 op_sel_hi:[1,0]
    v_pk_add_f32 v[206:207], v[206:207], 1.0 op_sel_hi:[1,0]
    v_rcp_f32 v204, v204
    v_rcp_f32 v205, v205
    v_rcp_f32 v206, v206
    v_rcp_f32 v207, v207
    v_pk_mul_f32 v[204:205], v[204:205], v[152:153]
    v_pk_mul_f32 v[206:207], v[206:207], v[154:155]
    v_cvt_pk_bf16_f32 v188, v204, v205
    v_cvt_pk_bf16_f32 v189, v206, v207
    buffer_load_dwordx4 a[148:151], v10, s[20:23], s13 offen offset:1024 sc1
    v_pk_fma_f32 v[156:157], v[156:157], v[168:169], v[232:233] op_sel:[0,1,0] op_sel_hi:[1,1,1]
    v_pk_fma_f32 v[158:159], v[158:159], v[168:169], v[234:235] op_sel:[0,1,0] op_sel_hi:[1,1,1]
    v_pk_mul_f32 v[208:209], v[156:157], v[156:157]
    v_pk_mul_f32 v[210:211], v[158:159], v[158:159]
    v_pk_fma_f32 v[208:209], v[208:209], s[46:47], v[18:19]
    v_pk_fma_f32 v[210:211], v[210:211], s[46:47], v[18:19]
    v_pk_mul_f32 v[208:209], v[208:209], v[156:157]
    v_pk_mul_f32 v[210:211], v[210:211], v[158:159]
    v_exp_f32 v208, v208
    v_exp_f32 v209, v209
    v_exp_f32 v210, v210
    v_exp_f32 v211, v211
    v_pk_add_f32 v[208:209], v[208:209], 1.0 op_sel_hi:[1,0]
    v_pk_add_f32 v[210:211], v[210:211], 1.0 op_sel_hi:[1,0]
    v_rcp_f32 v208, v208
    v_rcp_f32 v209, v209
    buffer_load_dwordx4 a[152:155], v10, s[20:23], s13 offen offset:2048 sc1
    v_rcp_f32_e64 v210, v210
    v_rcp_f32 v211, v211
    v_pk_mul_f32 v[208:209], v[208:209], v[156:157]
    v_pk_mul_f32 v[210:211], v[210:211], v[158:159]
    v_cvt_pk_bf16_f32 v190, v208, v209
    v_cvt_pk_bf16_f32 v191, v210, v211
    s_nop 0
    v_permlane32_swap_b32 v188, v190
    v_permlane32_swap_b32 v189, v191
    buffer_store_dwordx4 v[188:191], v11, s[20:23], s3 offen sc1
    v_pk_fma_f32 v[128:129], v[128:129], v[170:171], v[224:225] op_sel:[0,0,0] op_sel_hi:[1,0,1]
    v_pk_fma_f32 v[130:131], v[130:131], v[170:171], v[226:227] op_sel:[0,0,0] op_sel_hi:[1,0,1]
    v_pk_mul_f32 v[204:205], v[128:129], v[128:129]
    v_pk_mul_f32 v[206:207], v[130:131], v[130:131]
    v_pk_fma_f32 v[204:205], v[204:205], s[46:47], v[18:19]
    v_pk_fma_f32 v[206:207], v[206:207], s[46:47], v[18:19]
    v_pk_mul_f32 v[204:205], v[204:205], v[128:129]
    v_pk_mul_f32 v[206:207], v[206:207], v[130:131]
    v_exp_f32 v204, v204
    buffer_load_dwordx4 a[156:159], v10, s[20:23], s13 offen offset:3072 sc1
    v_exp_f32 v205, v205
    v_exp_f32 v206, v206
    v_exp_f32 v207, v207
    v_pk_add_f32 v[204:205], v[204:205], 1.0 op_sel_hi:[1,0]
    v_pk_add_f32 v[206:207], v[206:207], 1.0 op_sel_hi:[1,0]
    v_rcp_f32 v204, v204
    v_rcp_f32 v205, v205
    v_rcp_f32 v206, v206
    v_rcp_f32 v207, v207
    v_pk_mul_f32 v[204:205], v[204:205], v[128:129]
    v_pk_mul_f32 v[206:207], v[206:207], v[130:131]
    v_cvt_pk_bf16_f32 v180, v204, v205
    v_cvt_pk_bf16_f32 v181, v206, v207
    v_pk_fma_f32 v[144:145], v[144:145], v[170:171], v[228:229] op_sel:[0,0,0] op_sel_hi:[1,0,1]
    v_pk_fma_f32 v[146:147], v[146:147], v[170:171], v[230:231] op_sel:[0,0,0] op_sel_hi:[1,0,1]
    s_add_u32 s13, s12, 40960
    buffer_load_dwordx4 a[160:163], v10, s[20:23], s13 offen offset:0 sc1
    v_pk_mul_f32 v[208:209], v[144:145], v[144:145]
    v_pk_mul_f32 v[210:211], v[146:147], v[146:147]
    v_pk_fma_f32 v[208:209], v[208:209], s[46:47], v[18:19]
    v_pk_fma_f32 v[210:211], v[210:211], s[46:47], v[18:19]
    v_pk_mul_f32 v[208:209], v[208:209], v[144:145]
    v_pk_mul_f32 v[210:211], v[210:211], v[146:147]
    v_exp_f32 v208, v208
    v_exp_f32 v209, v209
    v_exp_f32 v210, v210
    v_exp_f32 v211, v211
    v_pk_add_f32 v[208:209], v[208:209], 1.0 op_sel_hi:[1,0]
    v_pk_add_f32 v[210:211], v[210:211], 1.0 op_sel_hi:[1,0]
    v_rcp_f32 v208, v208
    v_rcp_f32 v209, v209
    v_rcp_f32 v210, v210
    buffer_load_dwordx4 a[164:167], v10, s[20:23], s13 offen offset:1024 sc1
    v_rcp_f32 v211, v211
    v_pk_mul_f32 v[208:209], v[208:209], v[144:145]
    v_pk_mul_f32 v[210:211], v[210:211], v[146:147]
    v_cvt_pk_bf16_f32 v182, v208, v209
    v_cvt_pk_bf16_f32 v183, v210, v211
    buffer_store_dwordx4 v[180:183], v10, s[20:23], s6 offen sc1
    v_pk_fma_f32 v[132:133], v[132:133], v[170:171], v[224:225] op_sel:[0,1,0] op_sel_hi:[1,1,1]
    v_pk_fma_f32 v[134:135], v[134:135], v[170:171], v[226:227] op_sel:[0,1,0] op_sel_hi:[1,1,1]
    v_pk_mul_f32 v[204:205], v[132:133], v[132:133]
    v_pk_mul_f32 v[206:207], v[134:135], v[134:135]
    v_pk_fma_f32 v[204:205], v[204:205], s[46:47], v[18:19]
    v_pk_fma_f32 v[206:207], v[206:207], s[46:47], v[18:19]
    v_pk_mul_f32 v[204:205], v[204:205], v[132:133]
    v_pk_mul_f32 v[206:207], v[206:207], v[134:135]
    v_exp_f32 v204, v204
    v_exp_f32 v205, v205
    v_exp_f32 v206, v206
    buffer_load_dwordx4 a[168:171], v10, s[20:23], s13 offen offset:2048 sc1
    v_exp_f32 v207, v207
    v_pk_add_f32 v[204:205], v[204:205], 1.0 op_sel_hi:[1,0]
    v_pk_add_f32 v[206:207], v[206:207], 1.0 op_sel_hi:[1,0]
    v_rcp_f32 v204, v204
    v_rcp_f32 v205, v205
    v_rcp_f32 v206, v206
    v_rcp_f32 v207, v207
    v_pk_mul_f32 v[204:205], v[204:205], v[132:133]
    v_pk_mul_f32 v[206:207], v[206:207], v[134:135]
    v_cvt_pk_bf16_f32 v184, v204, v205
    v_cvt_pk_bf16_f32 v185, v206, v207
    v_pk_fma_f32 v[148:149], v[148:149], v[170:171], v[228:229] op_sel:[0,1,0] op_sel_hi:[1,1,1]
    s_lshl_b32 s35, s29, 3
    s_add_u32 s35, s35, s30
    s_lshl_b32 s35, s35, 4
    s_add_u32 s35, s35, s28
    s_lshl_b32 s35, s35, 3
    s_add_u32 s35, s35, 18907136
    buffer_load_dwordx4 a[172:175], v10, s[20:23], s13 offen offset:3072 sc1
    v_mov_b32 v200, s10
    v_mov_b32 v201, s11
    s_waitcnt vmcnt(6)
    buffer_store_dwordx2 v[200:201], off, s[20:23], s35 sc1
    v_pk_fma_f32 v[150:151], v[150:151], v[170:171], v[230:231] op_sel:[0,1,0] op_sel_hi:[1,1,1]
    v_pk_mul_f32 v[208:209], v[148:149], v[148:149]
    v_pk_mul_f32 v[210:211], v[150:151], v[150:151]
    v_pk_fma_f32 v[208:209], v[208:209], s[46:47], v[18:19]
    v_pk_fma_f32 v[210:211], v[210:211], s[46:47], v[18:19]
    v_pk_mul_f32 v[208:209], v[208:209], v[148:149]
    v_pk_mul_f32 v[210:211], v[210:211], v[150:151]
    v_exp_f32 v208, v208
    v_exp_f32 v209, v209
    v_exp_f32 v210, v210
    v_exp_f32 v211, v211
    v_pk_add_f32 v[208:209], v[208:209], 1.0 op_sel_hi:[1,0]
    v_pk_add_f32 v[210:211], v[210:211], 1.0 op_sel_hi:[1,0]
    s_add_u32 s13, s12, 45056
    buffer_load_dwordx4 a[176:179], v10, s[20:23], s13 offen offset:0 sc1
    v_rcp_f32 v208, v208
    v_rcp_f32 v209, v209
    v_rcp_f32 v210, v210
    v_rcp_f32 v211, v211
    v_pk_mul_f32 v[208:209], v[208:209], v[148:149]
    v_pk_mul_f32 v[210:211], v[210:211], v[150:151]
    v_cvt_pk_bf16_f32 v186, v208, v209
    v_cvt_pk_bf16_f32 v187, v210, v211
    buffer_store_dwordx4 v[184:187], v10, s[20:23], s7 offen sc1
    v_pk_fma_f32 v[160:161], v[160:161], v[170:171], v[232:233] op_sel:[0,0,0] op_sel_hi:[1,0,1]
    v_pk_fma_f32 v[162:163], v[162:163], v[170:171], v[234:235] op_sel:[0,0,0] op_sel_hi:[1,0,1]
    v_pk_mul_f32 v[204:205], v[160:161], v[160:161]
    v_pk_mul_f32 v[206:207], v[162:163], v[162:163]
    v_pk_fma_f32 v[204:205], v[204:205], s[46:47], v[18:19]
    v_pk_fma_f32 v[206:207], v[206:207], s[46:47], v[18:19]
    v_pk_mul_f32 v[204:205], v[204:205], v[160:161]
    v_pk_mul_f32 v[206:207], v[206:207], v[162:163]
    buffer_load_dwordx4 a[180:183], v10, s[20:23], s13 offen offset:1024 sc1
    v_exp_f32 v204, v204
    v_exp_f32 v205, v205
    v_exp_f32 v206, v206
    v_exp_f32 v207, v207
    v_pk_add_f32 v[204:205], v[204:205], 1.0 op_sel_hi:[1,0]
    v_pk_add_f32 v[206:207], v[206:207], 1.0 op_sel_hi:[1,0]
    v_rcp_f32 v204, v204
    v_rcp_f32 v205, v205
    v_rcp_f32 v206, v206
    v_rcp_f32 v207, v207
    v_pk_mul_f32 v[204:205], v[204:205], v[160:161]
    v_pk_mul_f32 v[206:207], v[206:207], v[162:163]
    v_cvt_pk_bf16_f32 v192, v204, v205
    v_cvt_pk_bf16_f32 v193, v206, v207
    buffer_load_dwordx4 a[184:187], v10, s[20:23], s13 offen offset:2048 sc1
    v_pk_fma_f32 v[164:165], v[164:165], v[170:171], v[232:233] op_sel:[0,1,0] op_sel_hi:[1,1,1]
    v_pk_fma_f32 v[166:167], v[166:167], v[170:171], v[234:235] op_sel:[0,1,0] op_sel_hi:[1,1,1]
    v_pk_mul_f32 v[208:209], v[164:165], v[164:165]
    v_pk_mul_f32 v[210:211], v[166:167], v[166:167]
    v_pk_fma_f32 v[208:209], v[208:209], s[46:47], v[18:19]
    v_pk_fma_f32 v[210:211], v[210:211], s[46:47], v[18:19]
    v_pk_mul_f32 v[208:209], v[208:209], v[164:165]
    v_pk_mul_f32 v[210:211], v[210:211], v[166:167]
    v_exp_f32 v208, v208
    v_exp_f32 v209, v209
    v_exp_f32 v210, v210
    v_exp_f32 v211, v211
    v_pk_add_f32 v[208:209], v[208:209], 1.0 op_sel_hi:[1,0]
    v_pk_add_f32 v[210:211], v[210:211], 1.0 op_sel_hi:[1,0]
    v_rcp_f32 v208, v208
    v_rcp_f32 v209, v209
    v_rcp_f32 v210, v210
    v_rcp_f32 v211, v211
    v_pk_mul_f32 v[208:209], v[208:209], v[164:165]
    v_pk_mul_f32 v[210:211], v[210:211], v[166:167]
    v_cvt_pk_bf16_f32 v194, v208, v209
    v_cvt_pk_bf16_f32 v195, v210, v211
    s_nop 0
    v_permlane32_swap_b32 v192, v194
    v_permlane32_swap_b32 v193, v195
    buffer_store_dwordx4 v[192:195], v12, s[20:23], s3 offen sc1
    v_mov_b32 v14, v113
    v_mov_b32_e64 v15, v114
    v_mov_b32 v16, v115
    v_mov_b32 v17, v116
    v_mul_f32 v4, 4.0, v0
    v_cos_f32 v120, v4
    v_sin_f32_e64 v121, -v4
    v_mul_f32 v5, 4.0, v252
    v_cos_f32 v122, v5
    v_sin_f32_e64 v123, -v5
    v_mul_f32 v4, 4.0, v253
    v_cos_f32 v124, v4
    v_sin_f32_e64 v125, -v4
    v_mul_f32 v5, 4.0, v254
    v_cos_f32 v126, v5
    buffer_load_dwordx4 a[188:191], v10, s[20:23], s13 offen offset:3072 sc1
    v_sin_f32_e64 v127, -v5
    v_mul_f32 v4, 4.0, v255
    v_cos_f32 v128, v4
    v_sin_f32_e64 v129, -v4
    s_add_u32 s9, s31, 4
    s_lshr_b32 s51, s9, 2
    s_lshl_b32 s51, s51, 6
    s_and_b32 s9, s9, 3
    s_add_u32 s9, s9, s51
    s_add_u32 s9, s9, 1
    v_and_b32 v3, 48, v1
    v_add_u32 v3, s9, v3
    v_cvt_f32_u32 v3, v3
    v_mul_f32 v4, v3, v0
    v_cos_f32_e64 v130, v4
    s_add_u32 s13, s12, 49152
    buffer_load_dwordx4 a[192:195], v10, s[20:23], s13 offen offset:0 sc1
    v_sin_f32_e64 v131, -v4
    v_mul_f32 v5, v3, v252
    v_cos_f32 v138, v5
    v_sin_f32_e64 v139, -v5
    v_mul_f32 v4, v3, v253
    v_cos_f32 v146, v4
    v_sin_f32_e64 v147, -v4
    v_mul_f32 v5, v3, v254
    v_cos_f32 v154, v5
    v_sin_f32_e64 v155, -v5
    v_mul_f32 v4, v3, v255
    buffer_load_dwordx4 a[196:199], v10, s[20:23], s13 offen offset:1024 sc1
    v_cos_f32 v162, v4
    v_sin_f32_e64 v163, -v4
    s_mov_b32 s8, 0x3b4ccccd
    v_pk_mul_f32 v[130:131], v[130:131], s[8:9] op_sel_hi:[1,0]
    v_pk_mul_f32 v[138:139], v[138:139], s[8:9] op_sel_hi:[1,0]
    v_pk_mul_f32 v[146:147], v[146:147], s[8:9] op_sel_hi:[1,0]
    v_pk_mul_f32 v[154:155], v[154:155], s[8:9] op_sel_hi:[1,0]
    v_pk_mul_f32 v[162:163], v[162:163], s[8:9] op_sel_hi:[1,0]
    v_pk_mul_f32 v[132:133], v[130:131], v[120:121] op_sel_hi:[1,0]
    v_pk_mul_f32 v[140:141], v[138:139], v[122:123] op_sel_hi:[1,0]
    v_pk_mul_f32 v[148:149], v[146:147], v[124:125] op_sel_hi:[1,0]
    v_pk_mul_f32 v[156:157], v[154:155], v[126:127] op_sel_hi:[1,0]
    v_pk_mul_f32 v[164:165], v[162:163], v[128:129] op_sel_hi:[1,0]
    v_pk_fma_f32 v[132:133], v[130:131], v[120:121], v[132:133] op_sel:[1,1,0] op_sel_hi:[0,1,1] neg_lo:[1,0,0]
    v_pk_fma_f32 v[140:141], v[138:139], v[122:123], v[140:141] op_sel:[1,1,0] op_sel_hi:[0,1,1] neg_lo:[1,0,0]
    v_pk_fma_f32 v[148:149], v[146:147], v[124:125], v[148:149] op_sel:[1,1,0] op_sel_hi:[0,1,1] neg_lo:[1,0,0]
    buffer_load_dwordx4 a[200:203], v10, s[20:23], s13 offen offset:2048 sc1
    v_pk_fma_f32 v[156:157], v[154:155], v[126:127], v[156:157] op_sel:[1,1,0] op_sel_hi:[0,1,1] neg_lo:[1,0,0]
    v_pk_fma_f32 v[164:165], v[162:163], v[128:129], v[164:165] op_sel:[1,1,0] op_sel_hi:[0,1,1] neg_lo:[1,0,0]
    v_pk_mul_f32 v[134:135], v[132:133], v[120:121] op_sel_hi:[1,0]
    v_pk_mul_f32 v[142:143], v[140:141], v[122:123] op_sel_hi:[1,0]
    v_pk_mul_f32 v[150:151], v[148:149], v[124:125] op_sel_hi:[1,0]
    v_pk_mul_f32 v[158:159], v[156:157], v[126:127] op_sel_hi:[1,0]
    v_pk_mul_f32 v[166:167], v[164:165], v[128:129] op_sel_hi:[1,0]
    v_pk_fma_f32 v[134:135], v[132:133], v[120:121], v[134:135] op_sel:[1,1,0] op_sel_hi:[0,1,1] neg_lo:[1,0,0]
    v_pk_fma_f32 v[142:143], v[140:141], v[122:123], v[142:143] op_sel:[1,1,0] op_sel_hi:[0,1,1] neg_lo:[1,0,0]
    v_pk_fma_f32 v[150:151], v[148:149], v[124:125], v[150:151] op_sel:[1,1,0] op_sel_hi:[0,1,1] neg_lo:[1,0,0]
    v_pk_fma_f32 v[158:159], v[156:157], v[126:127], v[158:159] op_sel:[1,1,0] op_sel_hi:[0,1,1] neg_lo:[1,0,0]
    v_pk_fma_f32 v[166:167], v[164:165], v[128:129], v[166:167] op_sel:[1,1,0] op_sel_hi:[0,1,1] neg_lo:[1,0,0]
    v_pk_mul_f32 v[136:137], v[134:135], v[120:121] op_sel_hi:[1,0]
    v_pk_mul_f32 v[144:145], v[142:143], v[122:123] op_sel_hi:[1,0]
    v_pk_mul_f32 v[152:153], v[150:151], v[124:125] op_sel_hi:[1,0]
    v_pk_mul_f32 v[160:161], v[158:159], v[126:127] op_sel_hi:[1,0]
    v_pk_mul_f32 v[168:169], v[166:167], v[128:129] op_sel_hi:[1,0]
    v_pk_fma_f32 v[136:137], v[134:135], v[120:121], v[136:137] op_sel:[1,1,0] op_sel_hi:[0,1,1] neg_lo:[1,0,0]
    buffer_load_dwordx4 a[204:207], v10, s[20:23], s13 offen offset:3072 sc1
    v_pk_fma_f32 v[144:145], v[142:143], v[122:123], v[144:145] op_sel:[1,1,0] op_sel_hi:[0,1,1] neg_lo:[1,0,0]
    v_pk_fma_f32 v[152:153], v[150:151], v[124:125], v[152:153] op_sel:[1,1,0] op_sel_hi:[0,1,1] neg_lo:[1,0,0]
    v_pk_fma_f32 v[160:161], v[158:159], v[126:127], v[160:161] op_sel:[1,1,0] op_sel_hi:[0,1,1] neg_lo:[1,0,0]
    v_pk_fma_f32 v[168:169], v[166:167], v[128:129], v[168:169] op_sel:[1,1,0] op_sel_hi:[0,1,1] neg_lo:[1,0,0]
    v_mul_f32 v4, 0x3f3504f3, v136
    v_cndmask_b32 v136, v136, v4, s[48:49]
    v_cvt_pk_bf16_f32 v100, v130, v132
    v_cvt_pk_bf16_f32 v102, v131, v133
    v_cvt_pk_bf16_f32 v101, v134, v136
    v_cvt_pk_bf16_f32 v103, v135, v137
    v_mul_f32 v4, 0x3f3504f3, v144
    v_cndmask_b32 v144, v144, v4, s[48:49]
    v_cvt_pk_bf16_f32 v104, v138, v140
    v_cvt_pk_bf16_f32 v106, v139, v141
    v_cvt_pk_bf16_f32 v105, v142, v144
    v_cvt_pk_bf16_f32 v107, v143, v145
    v_mul_f32 v4, 0x3f3504f3, v152
    v_cndmask_b32 v152, v152, v4, s[48:49]
    s_add_u32 s13, s12, 53248
    buffer_load_dwordx4 a[208:211], v10, s[20:23], s13 offen offset:0 sc1
    v_cvt_pk_bf16_f32 v108, v146, v148
    v_cvt_pk_bf16_f32 v110, v147, v149
    v_cvt_pk_bf16_f32 v109, v150, v152
    v_cvt_pk_bf16_f32 v111, v151, v153
    v_mul_f32 v4, 0x3f3504f3, v160
    v_cndmask_b32 v160, v160, v4, s[48:49]
    v_cvt_pk_bf16_f32 v112, v154, v156
    v_cvt_pk_bf16_f32 v114, v155, v157
    v_cvt_pk_bf16_f32 v113, v158, v160
    v_cvt_pk_bf16_f32 v115, v159, v161
    v_mul_f32 v4, 0x3f3504f3, v168
    v_cndmask_b32 v168, v168, v4, s[48:49]
    v_cvt_pk_bf16_f32 v116, v162, v164
    v_cvt_pk_bf16_f32 v118, v163, v165
    v_cvt_pk_bf16_f32 v117, v166, v168
    v_cvt_pk_bf16_f32 v119, v167, v169
    ds_read_b64_tr_b16 v[204:205], v14 offset:0
    ds_read_b64_tr_b16 v[206:207], v14 offset:2048
    ds_read_b64_tr_b16 v[208:209], v15 offset:0
    ds_read_b64_tr_b16 v[210:211], v15 offset:2048
    ds_read_b64_tr_b16 v[212:213], v16 offset:0
    ds_read_b64_tr_b16 v[214:215], v16 offset:2048
    ds_read_b64_tr_b16 v[216:217], v17 offset:0
    ds_read_b64_tr_b16 v[218:219], v17 offset:2048
    s_waitcnt lgkmcnt(0)
    v_mfma_f32_16x16x32_bf16 v[120:123], v[20:23], v[204:207], 0
    ds_read_b64_tr_b16 v[220:221], v14 offset:4096
    buffer_load_dwordx4 a[212:215], v10, s[20:23], s13 offen offset:1024 sc1
    v_mfma_f32_16x16x32_bf16 v[124:127], v[24:27], v[204:207], 0
    ds_read_b64_tr_b16 v[222:223], v14 offset:6144
    v_mfma_f32_16x16x32_bf16 v[128:131], v[28:31], v[204:207], 0
    ds_read_b64_tr_b16 v[224:225], v15 offset:4096
    v_mfma_f32_16x16x32_bf16 v[132:135], v[32:35], v[204:207], 0
    ds_read_b64_tr_b16 v[226:227], v15 offset:6144
    buffer_load_dwordx4 a[216:219], v10, s[20:23], s13 offen offset:2048 sc1
    v_mfma_f32_16x16x32_bf16 v[136:139], v[36:39], v[204:207], 0
    ds_read_b64_tr_b16 v[228:229], v16 offset:4096
    v_mfma_f32_16x16x32_bf16 v[140:143], v[20:23], v[208:211], 0
    ds_read_b64_tr_b16 v[230:231], v16 offset:6144
    v_mfma_f32_16x16x32_bf16 v[144:147], v[24:27], v[208:211], 0
    ds_read_b64_tr_b16 v[232:233], v17 offset:4096
    buffer_load_dwordx4 a[220:223], v10, s[20:23], s13 offen offset:3072 sc1
    v_mfma_f32_16x16x32_bf16 v[148:151], v[28:31], v[208:211], 0
    ds_read_b64_tr_b16 v[234:235], v17 offset:6144
    v_mfma_f32_16x16x32_bf16 v[152:155], v[32:35], v[208:211], 0
    s_lshl_b32 s32, s29, 3
    s_lshl_b32 s33, s28, 1
    s_add_u32 s32, s32, s33
    s_mul_i32 s32, s32, 24576
    s_add_u32 s32, s32, 12582912
    v_mfma_f32_16x16x32_bf16 v[156:159], v[36:39], v[208:211], 0
    s_add_u32 s13, s12, 57344
    buffer_load_dwordx4 a[224:227], v10, s[20:23], s13 offen offset:0 sc1
    v_mfma_f32_16x16x32_bf16 v[160:163], v[20:23], v[212:215], 0
    s_mul_i32 s36, s40, 6144
    s_add_u32 s36, s36, s32
    s_mul_i32 s37, s41, 6144
    s_add_u32 s37, s37, s32
    s_mul_i32 s38, s42, 6144
    s_add_u32 s38, s38, s32
    s_mul_i32 s39, s43, 6144
    s_add_u32 s39, s39, s32
    v_mfma_f32_16x16x32_bf16 v[164:167], v[24:27], v[212:215], 0
    s_lshl_b32 s32, s29, 3
    s_lshl_b32 s33, s28, 1
    s_add_u32 s33, s33, s32
    s_lshl_b32 s33, s33, 7
    s_add_u32 s33, s33, 19267584
    v_mfma_f32_16x16x32_bf16 v[168:171], v[28:31], v[212:215], 0
    buffer_load_dwordx4 a[228:231], v10, s[20:23], s13 offen offset:1024 sc1
    v_bfe_u32 v2, v1, 2, 1
    v_mfma_f32_16x16x32_bf16 v[172:175], v[32:35], v[212:215], 0
    v_and_b32 v3, 3, v1
    v_lshlrev_b32 v3, 3, v3
    v_mfma_f32_16x16x32_bf16 v[176:179], v[36:39], v[212:215], 0
    v_lshl_add_u32 v3, v2, 7, v3
    v_add_u32_e64 v11, s33, v3
    v_mfma_f32_16x16x32_bf16 v[180:183], v[20:23], v[216:219], 0
    buffer_load_dwordx4 a[232:235], v10, s[20:23], s13 offen offset:2048 sc1
    v_mfma_f32_16x16x32_bf16 v[184:187], v[24:27], v[216:219], 0
    v_add_u32 v12, 4294606848, v11
    v_mfma_f32_16x16x32_bf16 v[188:191], v[28:31], v[216:219], 0
    v_add_u32_e64 v6, 0, v10
    v_add_u32 v7, 3072, v10
    v_mfma_f32_16x16x32_bf16 v[192:195], v[32:35], v[216:219], 0
    buffer_load_dwordx4 a[236:239], v10, s[20:23], s13 offen offset:3072 sc1
    v_add_u32 v8, 24576, v10
    v_mfma_f32_16x16x32_bf16 v[196:199], v[36:39], v[216:219], 0
    v_add_u32 v9, 27648, v10
    s_waitcnt lgkmcnt(0)
    s_waitcnt vmcnt(13)
    buffer_load_dwordx2 v[200:201], v12, s[20:23], 0 offen sc1
    v_mfma_f32_16x16x32_bf16 v[120:123], v[40:43], v[220:223], v[120:123]
    ds_read_b64_tr_b16 v[204:205], v14 offset:8192
    v_mfma_f32_16x16x32_bf16 v[124:127], v[44:47], v[220:223], v[124:127]
    ds_read_b64_tr_b16 v[206:207], v14 offset:10240
    v_mfma_f32_16x16x32_bf16 v[128:131], v[48:51], v[220:223], v[128:131]
    ds_read_b64_tr_b16 v[208:209], v15 offset:8192
    v_mfma_f32_16x16x32_bf16 v[132:135], v[52:55], v[220:223], v[132:135]
    ds_read_b64_tr_b16 v[210:211], v15 offset:10240
    v_mfma_f32_16x16x32_bf16 v[136:139], v[56:59], v[220:223], v[136:139]
    ds_read_b64_tr_b16 v[212:213], v16 offset:8192
    v_mfma_f32_16x16x32_bf16 v[140:143], v[40:43], v[224:227], v[140:143]
    ds_read_b64_tr_b16 v[214:215], v16 offset:10240
    v_mfma_f32_16x16x32_bf16 v[144:147], v[44:47], v[224:227], v[144:147]
    ds_read_b64_tr_b16 v[216:217], v17 offset:8192
    v_mfma_f32_16x16x32_bf16 v[148:151], v[48:51], v[224:227], v[148:151]
    ds_read_b64_tr_b16 v[218:219], v17 offset:10240
    v_mfma_f32_16x16x32_bf16 v[152:155], v[52:55], v[224:227], v[152:155]
    s_lshl_b32 s35, s29, 3
    s_add_u32 s35, s35, s30
    s_lshl_b32 s35, s35, 4
    s_add_u32 s35, s35, s28
    s_lshl_b32 s35, s35, 3
    s_add_u32 s35, s35, 19267584
    v_mfma_f32_16x16x32_bf16 v[156:159], v[56:59], v[224:227], v[156:159]
    v_mov_b32 v18, s10
    v_mov_b32_e64 v19, s11
    v_mfma_f32_16x16x32_bf16 v[160:163], v[40:43], v[228:231], v[160:163]
    buffer_store_dwordx2 v[18:19], off, s[20:23], s35 sc1
    v_mfma_f32_16x16x32_bf16 v[164:167], v[44:47], v[228:231], v[164:167]
    v_lshlrev_b32_e64 v236, 16, v242
    v_and_b32 v237, 0xffff0000, v242
    v_mfma_f32_16x16x32_bf16 v[168:171], v[48:51], v[228:231], v[168:171]
    v_add_f32_e64 v236, v13, v236
    v_add_f32 v237, v13, v237
    v_mfma_f32_16x16x32_bf16 v[172:175], v[52:55], v[228:231], v[172:175]
    v_lshlrev_b32 v238, 16, v243
    v_and_b32 v239, 0xffff0000, v243
    v_mfma_f32_16x16x32_bf16 v[176:179], v[56:59], v[228:231], v[176:179]
    v_add_f32 v238, v13, v238
    v_add_f32 v239, v13, v239
    v_mfma_f32_16x16x32_bf16 v[180:183], v[40:43], v[232:235], v[180:183]
    v_lshlrev_b32_e64 v240, 16, v244
    v_and_b32 v241, 0xffff0000, v244
    v_mfma_f32_16x16x32_bf16 v[184:187], v[44:47], v[232:235], v[184:187]
    v_add_f32_e64 v240, v13, v240
    v_add_f32 v241, v13, v241
    v_mfma_f32_16x16x32_bf16 v[188:191], v[48:51], v[232:235], v[188:191]
    v_lshlrev_b32 v242, 16, v245
    v_and_b32 v243, 0xffff0000, v245
    v_mfma_f32_16x16x32_bf16 v[192:195], v[52:55], v[232:235], v[192:195]
    v_add_f32 v242, v13, v242
    v_add_f32 v243, v13, v243
    v_mfma_f32_16x16x32_bf16 v[196:199], v[56:59], v[232:235], v[196:199]
    v_lshlrev_b32 v244, 16, v246
    v_and_b32 v245, 0xffff0000, v246
    s_waitcnt lgkmcnt(0)
    v_mfma_f32_16x16x32_bf16 v[120:123], v[60:63], v[204:207], v[120:123]
    ds_read_b64_tr_b16 v[220:221], v14 offset:12288
    v_add_f32_e64 v244, v13, v244
    v_mfma_f32_16x16x32_bf16 v[124:127], v[64:67], v[204:207], v[124:127]
    ds_read_b64_tr_b16 v[222:223], v14 offset:14336
    v_add_f32_e64 v245, v13, v245
    v_mfma_f32_16x16x32_bf16 v[128:131], v[68:71], v[204:207], v[128:131]
    ds_read_b64_tr_b16 v[224:225], v15 offset:12288
    v_lshlrev_b32_e64 v246, 16, v247
    v_mfma_f32_16x16x32_bf16 v[132:135], v[72:75], v[204:207], v[132:135]
    ds_read_b64_tr_b16 v[226:227], v15 offset:14336
    v_and_b32 v247, 0xffff0000, v247
    v_mfma_f32_16x16x32_bf16 v[136:139], v[76:79], v[204:207], v[136:139]
    ds_read_b64_tr_b16 v[228:229], v16 offset:12288
    v_add_f32_e64 v246, v13, v246
    v_mfma_f32_16x16x32_bf16 v[140:143], v[60:63], v[208:211], v[140:143]
    ds_read_b64_tr_b16 v[230:231], v16 offset:14336
    v_add_f32_e64 v247, v13, v247
    v_mfma_f32_16x16x32_bf16 v[144:147], v[64:67], v[208:211], v[144:147]
    ds_read_b64_tr_b16 v[232:233], v17 offset:12288
    v_and_b32 v255, 0xffff0000, v251
    v_mfma_f32_16x16x32_bf16 v[148:151], v[68:71], v[208:211], v[148:151]
    ds_read_b64_tr_b16 v[234:235], v17 offset:14336
    v_lshlrev_b32_e64 v254, 16, v251
    v_mfma_f32_16x16x32_bf16 v[152:155], v[72:75], v[208:211], v[152:155]
    v_add_f32 v254, v13, v254
    v_add_f32 v255, v13, v255
    v_mfma_f32_16x16x32_bf16 v[156:159], v[76:79], v[208:211], v[156:159]
    v_and_b32 v253, 0xffff0000, v250
    v_lshlrev_b32 v252, 16, v250
    v_mfma_f32_16x16x32_bf16 v[160:163], v[60:63], v[212:215], v[160:163]
    v_add_f32 v252, v13, v252
    v_add_f32_e64 v253, v13, v253
    v_mfma_f32_16x16x32_bf16 v[164:167], v[64:67], v[212:215], v[164:167]
    v_and_b32 v251, 0xffff0000, v249
    v_lshlrev_b32_e64 v250, 16, v249
    v_mfma_f32_16x16x32_bf16 v[168:171], v[68:71], v[212:215], v[168:171]
    v_add_f32 v250, v13, v250
    v_add_f32 v251, v13, v251
    v_mfma_f32_16x16x32_bf16 v[172:175], v[72:75], v[212:215], v[172:175]
    v_and_b32 v249, 0xffff0000, v248
    v_lshlrev_b32 v248, 16, v248
    v_mfma_f32_16x16x32_bf16 v[176:179], v[76:79], v[212:215], v[176:179]
    v_add_f32 v248, v13, v248
    v_add_f32_e64 v249, v13, v249
    v_mfma_f32_16x16x32_bf16 v[180:183], v[60:63], v[216:219], v[180:183]
    v_mfma_f32_16x16x32_bf16 v[184:187], v[64:67], v[216:219], v[184:187]
    v_mfma_f32_16x16x32_bf16 v[188:191], v[68:71], v[216:219], v[188:191]
    v_mfma_f32_16x16x32_bf16 v[192:195], v[72:75], v[216:219], v[192:195]
    v_mfma_f32_16x16x32_bf16 v[196:199], v[76:79], v[216:219], v[196:199]
    s_waitcnt lgkmcnt(0)
    s_waitcnt vmcnt(1)
    v_cmp_ne_u64 vcc, s[10:11], v[200:201]
    s_cbranch_vccnz kf_rt_fa
kf_ok_fa:
    v_mfma_f32_16x16x32_bf16 v[120:123], v[80:83], v[220:223], v[120:123]
    ds_read_b64_tr_b16 v[204:205], v14 offset:16384
    buffer_load_dwordx4 v[20:23], v6, s[20:23], s37 offen offset:0 sc1
    v_mfma_f32_16x16x32_bf16 v[124:127], v[84:87], v[220:223], v[124:127]
    ds_read_b64_tr_b16 v[206:207], v14 offset:18432
    v_mfma_f32_16x16x32_bf16 v[128:131], v[88:91], v[220:223], v[128:131]
    ds_read_b64_tr_b16 v[208:209], v15 offset:16384
    v_mfma_f32_16x16x32_bf16 v[132:135], v[92:95], v[220:223], v[132:135]
    ds_read_b64_tr_b16 v[210:211], v15 offset:18432
    buffer_load_dwordx4 v[24:27], v6, s[20:23], s37 offen offset:1024 sc1
    v_mfma_f32_16x16x32_bf16 v[136:139], v[96:99], v[220:223], v[136:139]
    ds_read_b64_tr_b16 v[212:213], v16 offset:16384
    v_mfma_f32_16x16x32_bf16 v[140:143], v[80:83], v[224:227], v[140:143]
    ds_read_b64_tr_b16 v[214:215], v16 offset:18432
    v_mfma_f32_16x16x32_bf16 v[144:147], v[84:87], v[224:227], v[144:147]
    ds_read_b64_tr_b16 v[216:217], v17 offset:16384
    buffer_load_dwordx4 v[28:31], v6, s[20:23], s37 offen offset:2048 sc1
    v_mfma_f32_16x16x32_bf16 v[148:151], v[88:91], v[224:227], v[148:151]
    ds_read_b64_tr_b16 v[218:219], v17 offset:18432
    v_mfma_f32_16x16x32_bf16 v[152:155], v[92:95], v[224:227], v[152:155]
    v_mfma_f32_16x16x32_bf16 v[156:159], v[96:99], v[224:227], v[156:159]
    buffer_load_dwordx4 v[32:35], v7, s[20:23], s37 offen offset:0 sc1
    v_mfma_f32_16x16x32_bf16 v[160:163], v[80:83], v[228:231], v[160:163]
    v_mfma_f32_16x16x32_bf16 v[164:167], v[84:87], v[228:231], v[164:167]
    v_mfma_f32_16x16x32_bf16 v[168:171], v[88:91], v[228:231], v[168:171]
    buffer_load_dwordx4 v[36:39], v7, s[20:23], s37 offen offset:1024 sc1
    v_mfma_f32_16x16x32_bf16 v[172:175], v[92:95], v[228:231], v[172:175]
    v_mfma_f32_16x16x32_bf16 v[176:179], v[96:99], v[228:231], v[176:179]
    v_mfma_f32_16x16x32_bf16 v[180:183], v[80:83], v[232:235], v[180:183]
    buffer_load_dwordx4 v[40:43], v7, s[20:23], s37 offen offset:2048 sc1
    v_mfma_f32_16x16x32_bf16 v[184:187], v[84:87], v[232:235], v[184:187]
    v_mfma_f32_16x16x32_bf16 v[188:191], v[88:91], v[232:235], v[188:191]
    v_mfma_f32_16x16x32_bf16 v[192:195], v[92:95], v[232:235], v[192:195]
    buffer_load_dwordx4 v[44:47], v8, s[20:23], s37 offen offset:0 sc1
    v_mfma_f32_16x16x32_bf16 v[196:199], v[96:99], v[232:235], v[196:199]
    s_waitcnt lgkmcnt(0)
    v_mfma_f32_16x16x32_bf16 v[120:123], v[100:103], v[204:207], v[120:123]
    v_mfma_f32_16x16x32_bf16 v[124:127], v[104:107], v[204:207], v[124:127]
    buffer_load_dwordx4 v[48:51], v8, s[20:23], s37 offen offset:1024 sc1
    v_mfma_f32_16x16x32_bf16 v[128:131], v[108:111], v[204:207], v[128:131]
    v_mfma_f32_16x16x32_bf16 v[132:135], v[112:115], v[204:207], v[132:135]
    v_mfma_f32_16x16x32_bf16 v[136:139], v[116:119], v[204:207], v[136:139]
    buffer_load_dwordx4 v[52:55], v8, s[20:23], s37 offen offset:2048 sc1
    v_mfma_f32_16x16x32_bf16 v[140:143], v[100:103], v[208:211], v[140:143]
    v_mfma_f32_16x16x32_bf16 v[144:147], v[104:107], v[208:211], v[144:147]
    v_mfma_f32_16x16x32_bf16 v[148:151], v[108:111], v[208:211], v[148:151]
    buffer_load_dwordx4 v[56:59], v9, s[20:23], s37 offen offset:0 sc1
    v_mfma_f32_16x16x32_bf16 v[152:155], v[112:115], v[208:211], v[152:155]
    v_mfma_f32_16x16x32_bf16 v[156:159], v[116:119], v[208:211], v[156:159]
    buffer_load_dwordx2 v[18:19], v11, s[20:23], 0 offen sc1
    v_mfma_f32_16x16x32_bf16 v[160:163], v[100:103], v[212:215], v[160:163]
    buffer_load_dwordx4 v[60:63], v9, s[20:23], s37 offen offset:1024 sc1
    v_mfma_f32_16x16x32_bf16 v[164:167], v[104:107], v[212:215], v[164:167]
    v_mfma_f32_16x16x32_bf16 v[168:171], v[108:111], v[212:215], v[168:171]
    v_mfma_f32_16x16x32_bf16 v[172:175], v[112:115], v[212:215], v[172:175]
    buffer_load_dwordx4 v[64:67], v9, s[20:23], s37 offen offset:2048 sc1
    v_mfma_f32_16x16x32_bf16 v[176:179], v[116:119], v[212:215], v[176:179]
    v_mfma_f32_16x16x32_bf16 v[180:183], v[100:103], v[216:219], v[180:183]
    v_mfma_f32_16x16x32_bf16 v[184:187], v[104:107], v[216:219], v[184:187]
    v_mfma_f32_16x16x32_bf16 v[188:191], v[108:111], v[216:219], v[188:191]
    v_mfma_f32_16x16x32_bf16 v[192:195], v[112:115], v[216:219], v[192:195]
    v_mfma_f32_16x16x32_bf16 v[196:199], v[116:119], v[216:219], v[196:199]
    s_sub_u32 s34, s28, s41
    s_add_u32 s34, s34, 3
    s_and_b32 s34, s34, 3
    s_mul_i32 s34, s34, 5120
    s_mul_i32 s33, s41, 15360
    s_add_u32 s33, s33, s34
    s_add_u32 s33, s33, 81920
    v_add_u32 v14, s33, v10
    s_sub_u32 s34, s28, s42
    s_add_u32 s34, s34, 3
    s_and_b32 s34, s34, 3
    s_mul_i32 s34, s34, 5120
    s_mul_i32 s33, s42, 15360
    s_add_u32 s33, s33, s34
    s_add_u32 s33, s33, 81920
    v_add_u32 v15, s33, v10
    s_sub_u32 s34, s28, s43
    s_add_u32 s34, s34, 3
    s_and_b32 s34, s34, 3
    s_mul_i32 s34, s34, 5120
    s_mul_i32 s33, s43, 15360
    s_add_u32 s33, s33, s34
    s_add_u32 s33, s33, 81920
    v_add_u32 v16, s33, v10
    s_mul_i32 s33, s28, 15360
    s_add_u32 s33, s33, 81920
    v_add_u32 v17, s33, v10
    s_mov_b32 s16, s60
    s_and_b32 s17, s61, 0xffff
    s_mov_b32 s18, 2621440
    s_mov_b32 s19, 0x20000
    s_waitcnt vmcnt(12)
    v_mfma_f32_16x16x32_bf16 v[140:143], a[0:3], v[20:23], v[140:143]
    v_mfma_f32_16x16x32_bf16 v[144:147], a[4:7], v[20:23], v[144:147]
    v_mfma_f32_16x16x32_bf16 v[148:151], a[8:11], v[20:23], v[148:151]
    v_mfma_f32_16x16x32_bf16 v[152:155], a[12:15], v[20:23], v[152:155]
    v_mfma_f32_16x16x32_bf16 v[156:159], a[16:19], v[20:23], v[156:159]
    s_waitcnt vmcnt(11)
    v_mfma_f32_16x16x32_bf16 v[140:143], a[20:23], v[24:27], v[140:143]
    v_mfma_f32_16x16x32_bf16 v[144:147], a[24:27], v[24:27], v[144:147]
    v_mfma_f32_16x16x32_bf16 v[148:151], a[28:31], v[24:27], v[148:151]
    v_mfma_f32_16x16x32_bf16 v[152:155], a[32:35], v[24:27], v[152:155]
    v_mfma_f32_16x16x32_bf16 v[156:159], a[36:39], v[24:27], v[156:159]
    s_waitcnt vmcnt(10)
    v_mfma_f32_16x16x32_bf16 v[140:143], a[40:43], v[28:31], v[140:143]
    v_mfma_f32_16x16x32_bf16 v[144:147], a[44:47], v[28:31], v[144:147]
    v_mfma_f32_16x16x32_bf16 v[148:151], a[48:51], v[28:31], v[148:151]
    v_mfma_f32_16x16x32_bf16 v[152:155], a[52:55], v[28:31], v[152:155]
    v_mfma_f32_16x16x32_bf16 v[156:159], a[56:59], v[28:31], v[156:159]
    s_waitcnt vmcnt(9)
    v_mfma_f32_16x16x32_bf16 v[140:143], a[60:63], v[32:35], v[140:143]
    v_mfma_f32_16x16x32_bf16 v[144:147], a[64:67], v[32:35], v[144:147]
    v_mfma_f32_16x16x32_bf16 v[148:151], a[68:71], v[32:35], v[148:151]
    v_mfma_f32_16x16x32_bf16 v[152:155], a[72:75], v[32:35], v[152:155]
    v_mfma_f32_16x16x32_bf16 v[156:159], a[76:79], v[32:35], v[156:159]
    s_waitcnt vmcnt(8)
    v_mfma_f32_16x16x32_bf16 v[140:143], a[80:83], v[36:39], v[140:143]
    v_mfma_f32_16x16x32_bf16 v[144:147], a[84:87], v[36:39], v[144:147]
    v_mfma_f32_16x16x32_bf16 v[148:151], a[88:91], v[36:39], v[148:151]
    v_mfma_f32_16x16x32_bf16 v[152:155], a[92:95], v[36:39], v[152:155]
    v_mfma_f32_16x16x32_bf16 v[156:159], a[96:99], v[36:39], v[156:159]
    s_waitcnt vmcnt(7)
    v_mfma_f32_16x16x32_bf16 v[140:143], a[100:103], v[40:43], v[140:143]
    v_mfma_f32_16x16x32_bf16 v[144:147], a[104:107], v[40:43], v[144:147]
    v_mfma_f32_16x16x32_bf16 v[148:151], a[108:111], v[40:43], v[148:151]
    v_mfma_f32_16x16x32_bf16 v[152:155], a[112:115], v[40:43], v[152:155]
    v_mfma_f32_16x16x32_bf16 v[156:159], a[116:119], v[40:43], v[156:159]
    s_waitcnt vmcnt(6)
    s_waitcnt vmcnt(2)
    v_cmp_ne_u64 vcc, s[10:11], v[18:19]
    s_cbranch_vccnz kf_rt_gf
kf_ok_gf:
    v_mfma_f32_16x16x32_bf16 v[140:143], a[120:123], v[44:47], v[140:143]
    buffer_load_dwordx4 v[68:71], v6, s[20:23], s38 offen offset:0 sc1
    v_mfma_f32_16x16x32_bf16 v[144:147], a[124:127], v[44:47], v[144:147]
    v_mfma_f32_16x16x32_bf16 v[148:151], a[128:131], v[44:47], v[148:151]
    buffer_load_dwordx4 v[72:75], v6, s[20:23], s38 offen offset:1024 sc1
    v_mfma_f32_16x16x32_bf16 v[152:155], a[132:135], v[44:47], v[152:155]
    v_mfma_f32_16x16x32_bf16 v[156:159], a[136:139], v[44:47], v[156:159]
    v_mfma_f32_16x16x32_bf16 v[140:143], a[140:143], v[48:51], v[140:143]
    buffer_load_dwordx4 v[76:79], v6, s[20:23], s38 offen offset:2048 sc1
    v_mfma_f32_16x16x32_bf16 v[144:147], a[144:147], v[48:51], v[144:147]
    v_mfma_f32_16x16x32_bf16 v[148:151], a[148:151], v[48:51], v[148:151]
    buffer_load_dwordx4 v[80:83], v7, s[20:23], s38 offen offset:0 sc1
    v_mfma_f32_16x16x32_bf16 v[152:155], a[152:155], v[48:51], v[152:155]
    v_mfma_f32_16x16x32_bf16 v[156:159], a[156:159], v[48:51], v[156:159]
    v_mfma_f32_16x16x32_bf16 v[140:143], a[160:163], v[52:55], v[140:143]
    buffer_load_dwordx4 v[84:87], v7, s[20:23], s38 offen offset:1024 sc1
    v_mfma_f32_16x16x32_bf16 v[144:147], a[164:167], v[52:55], v[144:147]
    v_mfma_f32_16x16x32_bf16 v[148:151], a[168:171], v[52:55], v[148:151]
    buffer_load_dwordx4 v[88:91], v7, s[20:23], s38 offen offset:2048 sc1
    v_mfma_f32_16x16x32_bf16 v[152:155], a[172:175], v[52:55], v[152:155]
    v_mfma_f32_16x16x32_bf16 v[156:159], a[176:179], v[52:55], v[156:159]
    v_mfma_f32_16x16x32_bf16 v[140:143], a[180:183], v[56:59], v[140:143]
    buffer_load_dwordx4 v[92:95], v8, s[20:23], s38 offen offset:0 sc1
    v_mfma_f32_16x16x32_bf16 v[144:147], a[184:187], v[56:59], v[144:147]
    v_mfma_f32_16x16x32_bf16 v[148:151], a[188:191], v[56:59], v[148:151]
    buffer_load_dwordx4 v[96:99], v8, s[20:23], s38 offen offset:1024 sc1
    v_mfma_f32_16x16x32_bf16 v[152:155], a[192:195], v[56:59], v[152:155]
    v_mfma_f32_16x16x32_bf16 v[156:159], a[196:199], v[56:59], v[156:159]
    s_waitcnt vmcnt(9)
    v_mfma_f32_16x16x32_bf16 v[140:143], a[200:203], v[60:63], v[140:143]
    buffer_load_dwordx4 v[100:103], v8, s[20:23], s38 offen offset:2048 sc1
    v_mfma_f32_16x16x32_bf16 v[144:147], a[204:207], v[60:63], v[144:147]
    v_mfma_f32_16x16x32_bf16 v[148:151], a[208:211], v[60:63], v[148:151]
    buffer_load_dwordx4 v[104:107], v9, s[20:23], s38 offen offset:0 sc1
    v_mfma_f32_16x16x32_bf16 v[152:155], a[212:215], v[60:63], v[152:155]
    v_mfma_f32_16x16x32_bf16 v[156:159], a[216:219], v[60:63], v[156:159]
    s_waitcnt vmcnt(10)
    v_mfma_f32_16x16x32_bf16 v[140:143], a[220:223], v[64:67], v[140:143]
    buffer_load_dwordx4 v[108:111], v9, s[20:23], s38 offen offset:1024 sc1
    v_mfma_f32_16x16x32_bf16 v[144:147], a[224:227], v[64:67], v[144:147]
    v_mfma_f32_16x16x32_bf16 v[148:151], a[228:231], v[64:67], v[148:151]
    buffer_load_dwordx4 v[112:115], v9, s[20:23], s38 offen offset:2048 sc1
    v_mfma_f32_16x16x32_bf16 v[152:155], a[232:235], v[64:67], v[152:155]
    v_mfma_f32_16x16x32_bf16 v[156:159], a[236:239], v[64:67], v[156:159]
    s_waitcnt vmcnt(11)
    v_mfma_f32_16x16x32_bf16 v[160:163], a[0:3], v[68:71], v[160:163]
    v_mfma_f32_16x16x32_bf16 v[164:167], a[4:7], v[68:71], v[164:167]
    v_mfma_f32_16x16x32_bf16 v[168:171], a[8:11], v[68:71], v[168:171]
    buffer_load_dwordx4 v[20:23], v6, s[20:23], s39 offen offset:0 sc1
    ds_write_b128 v14, v[140:143] offset:0
    v_mfma_f32_16x16x32_bf16 v[172:175], a[12:15], v[68:71], v[172:175]
    v_mfma_f32_16x16x32_bf16 v[176:179], a[16:19], v[68:71], v[176:179]
    s_waitcnt vmcnt(11)
    v_mfma_f32_16x16x32_bf16 v[160:163], a[20:23], v[72:75], v[160:163]
    buffer_load_dwordx4 v[24:27], v6, s[20:23], s39 offen offset:1024 sc1
    ds_write_b128 v14, v[144:147] offset:1024
    v_mfma_f32_16x16x32_bf16 v[164:167], a[24:27], v[72:75], v[164:167]
    v_mfma_f32_16x16x32_bf16 v[168:171], a[28:31], v[72:75], v[168:171]
    v_mfma_f32_16x16x32_bf16 v[172:175], a[32:35], v[72:75], v[172:175]
    v_mfma_f32_16x16x32_bf16 v[176:179], a[36:39], v[72:75], v[176:179]
    s_waitcnt vmcnt(11)
    v_mfma_f32_16x16x32_bf16 v[160:163], a[40:43], v[76:79], v[160:163]
    buffer_load_dwordx4 v[28:31], v6, s[20:23], s39 offen offset:2048 sc1
    ds_write_b128 v14, v[148:151] offset:2048
    v_mfma_f32_16x16x32_bf16 v[164:167], a[44:47], v[76:79], v[164:167]
    v_mfma_f32_16x16x32_bf16 v[168:171], a[48:51], v[76:79], v[168:171]
    v_mfma_f32_16x16x32_bf16 v[172:175], a[52:55], v[76:79], v[172:175]
    v_mfma_f32_16x16x32_bf16 v[176:179], a[56:59], v[76:79], v[176:179]
    s_waitcnt vmcnt(11)
    v_mfma_f32_16x16x32_bf16 v[160:163], a[60:63], v[80:83], v[160:163]
    buffer_load_dwordx4 v[32:35], v7, s[20:23], s39 offen offset:0 sc1
    ds_write_b128 v14, v[152:155] offset:3072
    v_mfma_f32_16x16x32_bf16 v[164:167], a[64:67], v[80:83], v[164:167]
    v_mfma_f32_16x16x32_bf16 v[168:171], a[68:71], v[80:83], v[168:171]
    v_mfma_f32_16x16x32_bf16 v[172:175], a[72:75], v[80:83], v[172:175]
    v_mfma_f32_16x16x32_bf16 v[176:179], a[76:79], v[80:83], v[176:179]
    s_waitcnt vmcnt(11)
    v_mfma_f32_16x16x32_bf16 v[160:163], a[80:83], v[84:87], v[160:163]
    buffer_load_dwordx4 v[36:39], v7, s[20:23], s39 offen offset:1024 sc1
    ds_write_b128 v14, v[156:159] offset:4096
    v_mfma_f32_16x16x32_bf16 v[164:167], a[84:87], v[84:87], v[164:167]
    v_mfma_f32_16x16x32_bf16 v[168:171], a[88:91], v[84:87], v[168:171]
    v_mfma_f32_16x16x32_bf16 v[172:175], a[92:95], v[84:87], v[172:175]
    v_mfma_f32_16x16x32_bf16 v[176:179], a[96:99], v[84:87], v[176:179]
    s_waitcnt vmcnt(11)
    v_mfma_f32_16x16x32_bf16 v[160:163], a[100:103], v[88:91], v[160:163]
    buffer_load_dwordx4 v[40:43], v7, s[20:23], s39 offen offset:2048 sc1
    v_mfma_f32_16x16x32_bf16 v[164:167], a[104:107], v[88:91], v[164:167]
    v_mfma_f32_16x16x32_bf16 v[168:171], a[108:111], v[88:91], v[168:171]
    v_mfma_f32_16x16x32_bf16 v[172:175], a[112:115], v[88:91], v[172:175]
    v_mfma_f32_16x16x32_bf16 v[176:179], a[116:119], v[88:91], v[176:179]
    s_waitcnt vmcnt(11)
    v_mfma_f32_16x16x32_bf16 v[160:163], a[120:123], v[92:95], v[160:163]
    buffer_load_dwordx4 v[44:47], v8, s[20:23], s39 offen offset:0 sc1
    v_mfma_f32_16x16x32_bf16 v[164:167], a[124:127], v[92:95], v[164:167]
    v_mfma_f32_16x16x32_bf16 v[168:171], a[128:131], v[92:95], v[168:171]
    v_mfma_f32_16x16x32_bf16 v[172:175], a[132:135], v[92:95], v[172:175]
    v_mfma_f32_16x16x32_bf16 v[176:179], a[136:139], v[92:95], v[176:179]
    s_waitcnt vmcnt(11)
    v_mfma_f32_16x16x32_bf16 v[160:163], a[140:143], v[96:99], v[160:163]
    buffer_load_dwordx4 v[48:51], v8, s[20:23], s39 offen offset:1024 sc1
    v_mfma_f32_16x16x32_bf16 v[164:167], a[144:147], v[96:99], v[164:167]
    v_mfma_f32_16x16x32_bf16 v[168:171], a[148:151], v[96:99], v[168:171]
    v_mfma_f32_16x16x32_bf16 v[172:175], a[152:155], v[96:99], v[172:175]
    v_mfma_f32_16x16x32_bf16 v[176:179], a[156:159], v[96:99], v[176:179]
    s_waitcnt vmcnt(11)
    v_mfma_f32_16x16x32_bf16 v[160:163], a[160:163], v[100:103], v[160:163]
    buffer_load_dwordx4 v[52:55], v8, s[20:23], s39 offen offset:2048 sc1
    v_mfma_f32_16x16x32_bf16 v[164:167], a[164:167], v[100:103], v[164:167]
    v_mfma_f32_16x16x32_bf16 v[168:171], a[168:171], v[100:103], v[168:171]
    v_mfma_f32_16x16x32_bf16 v[172:175], a[172:175], v[100:103], v[172:175]
    v_mfma_f32_16x16x32_bf16 v[176:179], a[176:179], v[100:103], v[176:179]
    s_waitcnt vmcnt(11)
    v_mfma_f32_16x16x32_bf16 v[160:163], a[180:183], v[104:107], v[160:163]
    buffer_load_dwordx4 v[56:59], v9, s[20:23], s39 offen offset:0 sc1
    v_mfma_f32_16x16x32_bf16 v[164:167], a[184:187], v[104:107], v[164:167]
    v_mfma_f32_16x16x32_bf16 v[168:171], a[188:191], v[104:107], v[168:171]
    v_mfma_f32_16x16x32_bf16 v[172:175], a[192:195], v[104:107], v[172:175]
    v_mfma_f32_16x16x32_bf16 v[176:179], a[196:199], v[104:107], v[176:179]
    s_waitcnt vmcnt(11)
    v_mfma_f32_16x16x32_bf16 v[160:163], a[200:203], v[108:111], v[160:163]
    buffer_load_dwordx4 v[60:63], v9, s[20:23], s39 offen offset:1024 sc1
    v_mfma_f32_16x16x32_bf16 v[164:167], a[204:207], v[108:111], v[164:167]
    v_mfma_f32_16x16x32_bf16 v[168:171], a[208:211], v[108:111], v[168:171]
    v_mfma_f32_16x16x32_bf16 v[172:175], a[212:215], v[108:111], v[172:175]
    v_mfma_f32_16x16x32_bf16 v[176:179], a[216:219], v[108:111], v[176:179]
    s_waitcnt vmcnt(11)
    v_mfma_f32_16x16x32_bf16 v[160:163], a[220:223], v[112:115], v[160:163]
    buffer_load_dwordx4 v[64:67], v9, s[20:23], s39 offen offset:2048 sc1
    v_mfma_f32_16x16x32_bf16 v[164:167], a[224:227], v[112:115], v[164:167]
    v_mfma_f32_16x16x32_bf16 v[168:171], a[228:231], v[112:115], v[168:171]
    v_mfma_f32_16x16x32_bf16 v[172:175], a[232:235], v[112:115], v[172:175]
    v_mfma_f32_16x16x32_bf16 v[176:179], a[236:239], v[112:115], v[176:179]
    s_waitcnt vmcnt(11)
    v_mfma_f32_16x16x32_bf16 v[180:183], a[0:3], v[20:23], v[180:183]
    v_mfma_f32_16x16x32_bf16 v[184:187], a[4:7], v[20:23], v[184:187]
    v_mfma_f32_16x16x32_bf16 v[188:191], a[8:11], v[20:23], v[188:191]
    buffer_load_dwordx4 v[68:71], v6, s[20:23], s36 offen offset:0 sc1
    ds_write_b128 v15, v[160:163] offset:0
    v_mfma_f32_16x16x32_bf16 v[192:195], a[12:15], v[20:23], v[192:195]
    v_mfma_f32_16x16x32_bf16 v[196:199], a[16:19], v[20:23], v[196:199]
    s_waitcnt vmcnt(11)
    v_mfma_f32_16x16x32_bf16 v[180:183], a[20:23], v[24:27], v[180:183]
    buffer_load_dwordx4 v[72:75], v6, s[20:23], s36 offen offset:1024 sc1
    ds_write_b128 v15, v[164:167] offset:1024
    v_mfma_f32_16x16x32_bf16 v[184:187], a[24:27], v[24:27], v[184:187]
    v_mfma_f32_16x16x32_bf16 v[188:191], a[28:31], v[24:27], v[188:191]
    v_mfma_f32_16x16x32_bf16 v[192:195], a[32:35], v[24:27], v[192:195]
    v_mfma_f32_16x16x32_bf16 v[196:199], a[36:39], v[24:27], v[196:199]
    s_waitcnt vmcnt(11)
    v_mfma_f32_16x16x32_bf16 v[180:183], a[40:43], v[28:31], v[180:183]
    buffer_load_dwordx4 v[76:79], v6, s[20:23], s36 offen offset:2048 sc1
    ds_write_b128 v15, v[168:171] offset:2048
    v_mfma_f32_16x16x32_bf16 v[184:187], a[44:47], v[28:31], v[184:187]
    v_mfma_f32_16x16x32_bf16 v[188:191], a[48:51], v[28:31], v[188:191]
    v_mfma_f32_16x16x32_bf16 v[192:195], a[52:55], v[28:31], v[192:195]
    v_mfma_f32_16x16x32_bf16 v[196:199], a[56:59], v[28:31], v[196:199]
    s_waitcnt vmcnt(11)
    v_mfma_f32_16x16x32_bf16 v[180:183], a[60:63], v[32:35], v[180:183]
    buffer_load_dwordx4 v[80:83], v7, s[20:23], s36 offen offset:0 sc1
    ds_write_b128 v15, v[172:175] offset:3072
    v_mfma_f32_16x16x32_bf16 v[184:187], a[64:67], v[32:35], v[184:187]
    v_mfma_f32_16x16x32_bf16 v[188:191], a[68:71], v[32:35], v[188:191]
    v_mfma_f32_16x16x32_bf16 v[192:195], a[72:75], v[32:35], v[192:195]
    v_mfma_f32_16x16x32_bf16 v[196:199], a[76:79], v[32:35], v[196:199]
    s_waitcnt vmcnt(11)
    v_mfma_f32_16x16x32_bf16 v[180:183], a[80:83], v[36:39], v[180:183]
    buffer_load_dwordx4 v[84:87], v7, s[20:23], s36 offen offset:1024 sc1
    ds_write_b128 v15, v[176:179] offset:4096
    v_mfma_f32_16x16x32_bf16 v[184:187], a[84:87], v[36:39], v[184:187]
    v_mfma_f32_16x16x32_bf16 v[188:191], a[88:91], v[36:39], v[188:191]
    v_mfma_f32_16x16x32_bf16 v[192:195], a[92:95], v[36:39], v[192:195]
    v_mfma_f32_16x16x32_bf16 v[196:199], a[96:99], v[36:39], v[196:199]
    s_waitcnt vmcnt(11)
    v_mfma_f32_16x16x32_bf16 v[180:183], a[100:103], v[40:43], v[180:183]
    buffer_load_dwordx4 v[88:91], v7, s[20:23], s36 offen offset:2048 sc1
    v_mfma_f32_16x16x32_bf16 v[184:187], a[104:107], v[40:43], v[184:187]
    s_lshr_b32 s32, s29, 2
    s_lshl_b32 s32, s32, 8
    s_and_b32 s33, s29, 3
    s_lshl_b32 s33, s33, 3
    s_add_u32 s32, s32, s33
    s_lshl_b32 s33, s28, 6
    s_add_u32 s32, s32, s33
    v_mfma_f32_16x16x32_bf16 v[188:191], a[108:111], v[40:43], v[188:191]
    v_lshrrev_b32 v3, 5, v1
    v_bfe_u32 v4, v1, 2, 3
    v_mfma_f32_16x16x32_bf16 v[192:195], a[112:115], v[40:43], v[192:195]
    v_lshl_add_u32 v3, v3, 5, v4
    v_add_u32_e64 v3, s32, v3
    v_mfma_f32_16x16x32_bf16 v[196:199], a[116:119], v[40:43], v[196:199]
    v_mul_u32_u24 v3, 1280, v3
    v_and_b32 v5, 3, v1
    s_waitcnt vmcnt(11)
    v_mfma_f32_16x16x32_bf16 v[180:183], a[120:123], v[44:47], v[180:183]
    buffer_load_dwordx4 v[92:95], v8, s[20:23], s36 offen offset:0 sc1
    v_mfma_f32_16x16x32_bf16 v[184:187], a[124:127], v[44:47], v[184:187]
    v_and_b32_e64 v12, 60, v1
    v_lshl_add_u32 v12, v5, 6, v12
    v_mfma_f32_16x16x32_bf16 v[188:191], a[128:131], v[44:47], v[188:191]
    v_lshl_add_u32 v4, v5, 4, v3
    v_lshl_add_u32 v5, v5, 3, v3
    v_mfma_f32_16x16x32_bf16 v[192:195], a[132:135], v[44:47], v[192:195]
    s_mul_i32 s32, s30, 160
    v_mfma_f32_16x16x32_bf16 v[196:199], a[136:139], v[44:47], v[196:199]
    s_waitcnt vmcnt(11)
    v_mfma_f32_16x16x32_bf16 v[180:183], a[140:143], v[48:51], v[180:183]
    buffer_load_dwordx4 v[96:99], v8, s[20:23], s36 offen offset:1024 sc1
    v_mfma_f32_16x16x32_bf16 v[184:187], a[144:147], v[48:51], v[184:187]
    v_mfma_f32_16x16x32_bf16 v[188:191], a[148:151], v[48:51], v[188:191]
    v_mfma_f32_16x16x32_bf16 v[192:195], a[152:155], v[48:51], v[192:195]
    v_mfma_f32_16x16x32_bf16 v[196:199], a[156:159], v[48:51], v[196:199]
    s_waitcnt vmcnt(11)
    v_mfma_f32_16x16x32_bf16 v[180:183], a[160:163], v[52:55], v[180:183]
    buffer_load_dwordx4 v[100:103], v8, s[20:23], s36 offen offset:2048 sc1
    v_mfma_f32_16x16x32_bf16 v[184:187], a[164:167], v[52:55], v[184:187]
    v_mfma_f32_16x16x32_bf16 v[188:191], a[168:171], v[52:55], v[188:191]
    v_mfma_f32_16x16x32_bf16 v[192:195], a[172:175], v[52:55], v[192:195]
    v_mfma_f32_16x16x32_bf16 v[196:199], a[176:179], v[52:55], v[196:199]
    s_waitcnt vmcnt(11)
    v_mfma_f32_16x16x32_bf16 v[180:183], a[180:183], v[56:59], v[180:183]
    buffer_load_dwordx4 v[104:107], v9, s[20:23], s36 offen offset:0 sc1
    v_mfma_f32_16x16x32_bf16 v[184:187], a[184:187], v[56:59], v[184:187]
    v_mfma_f32_16x16x32_bf16 v[188:191], a[188:191], v[56:59], v[188:191]
    v_mfma_f32_16x16x32_bf16 v[192:195], a[192:195], v[56:59], v[192:195]
    v_mfma_f32_16x16x32_bf16 v[196:199], a[196:199], v[56:59], v[196:199]
    s_waitcnt vmcnt(11)
    v_mfma_f32_16x16x32_bf16 v[180:183], a[200:203], v[60:63], v[180:183]
    buffer_load_dwordx4 v[108:111], v9, s[20:23], s36 offen offset:1024 sc1
    v_mfma_f32_16x16x32_bf16 v[184:187], a[204:207], v[60:63], v[184:187]
    v_mfma_f32_16x16x32_bf16 v[188:191], a[208:211], v[60:63], v[188:191]
    v_mfma_f32_16x16x32_bf16 v[192:195], a[212:215], v[60:63], v[192:195]
    v_mfma_f32_16x16x32_bf16 v[196:199], a[216:219], v[60:63], v[196:199]
    s_waitcnt vmcnt(11)
    v_mfma_f32_16x16x32_bf16 v[180:183], a[220:223], v[64:67], v[180:183]
    buffer_load_dwordx4 v[112:115], v9, s[20:23], s36 offen offset:2048 sc1
    v_mfma_f32_16x16x32_bf16 v[184:187], a[224:227], v[64:67], v[184:187]
    v_mfma_f32_16x16x32_bf16 v[188:191], a[228:231], v[64:67], v[188:191]
    v_mfma_f32_16x16x32_bf16 v[192:195], a[232:235], v[64:67], v[192:195]
    v_mfma_f32_16x16x32_bf16 v[196:199], a[236:239], v[64:67], v[196:199]
    s_waitcnt vmcnt(11)
    v_mfma_f32_16x16x32_bf16 v[120:123], a[0:3], v[68:71], v[120:123]
    v_mfma_f32_16x16x32_bf16 v[124:127], a[4:7], v[68:71], v[124:127]
    v_mfma_f32_16x16x32_bf16 v[128:131], a[8:11], v[68:71], v[128:131]
    ds_write_b128 v16, v[180:183] offset:0
    v_mfma_f32_16x16x32_bf16 v[132:135], a[12:15], v[68:71], v[132:135]
    v_mfma_f32_16x16x32_bf16 v[136:139], a[16:19], v[68:71], v[136:139]
    s_waitcnt vmcnt(10)
    v_mfma_f32_16x16x32_bf16 v[120:123], a[20:23], v[72:75], v[120:123]
    ds_write_b128 v16, v[184:187] offset:1024
    v_mfma_f32_16x16x32_bf16 v[124:127], a[24:27], v[72:75], v[124:127]
    v_mfma_f32_16x16x32_bf16 v[128:131], a[28:31], v[72:75], v[128:131]
    v_mfma_f32_16x16x32_bf16 v[132:135], a[32:35], v[72:75], v[132:135]
    v_mfma_f32_16x16x32_bf16 v[136:139], a[36:39], v[72:75], v[136:139]
    s_waitcnt vmcnt(9)
    v_mfma_f32_16x16x32_bf16 v[120:123], a[40:43], v[76:79], v[120:123]
    ds_write_b128 v16, v[188:191] offset:2048
    v_mfma_f32_16x16x32_bf16 v[124:127], a[44:47], v[76:79], v[124:127]
    v_mfma_f32_16x16x32_bf16 v[128:131], a[48:51], v[76:79], v[128:131]
    v_mfma_f32_16x16x32_bf16 v[132:135], a[52:55], v[76:79], v[132:135]
    v_mfma_f32_16x16x32_bf16 v[136:139], a[56:59], v[76:79], v[136:139]
    s_waitcnt vmcnt(8)
    v_mfma_f32_16x16x32_bf16 v[120:123], a[60:63], v[80:83], v[120:123]
    ds_write_b128 v16, v[192:195] offset:3072
    v_mfma_f32_16x16x32_bf16 v[124:127], a[64:67], v[80:83], v[124:127]
    v_mfma_f32_16x16x32_bf16 v[128:131], a[68:71], v[80:83], v[128:131]
    v_mfma_f32_16x16x32_bf16 v[132:135], a[72:75], v[80:83], v[132:135]
    v_mfma_f32_16x16x32_bf16 v[136:139], a[76:79], v[80:83], v[136:139]
    s_waitcnt vmcnt(7)
    v_mfma_f32_16x16x32_bf16 v[120:123], a[80:83], v[84:87], v[120:123]
    ds_write_b128 v16, v[196:199] offset:4096
    v_mfma_f32_16x16x32_bf16 v[124:127], a[84:87], v[84:87], v[124:127]
    v_mfma_f32_16x16x32_bf16 v[128:131], a[88:91], v[84:87], v[128:131]
    v_mfma_f32_16x16x32_bf16 v[132:135], a[92:95], v[84:87], v[132:135]
    v_mfma_f32_16x16x32_bf16 v[136:139], a[96:99], v[84:87], v[136:139]
    s_waitcnt vmcnt(6)
    v_mfma_f32_16x16x32_bf16 v[120:123], a[100:103], v[88:91], v[120:123]
    v_mfma_f32_16x16x32_bf16 v[124:127], a[104:107], v[88:91], v[124:127]
    s_waitcnt lgkmcnt(0)
    s_barrier
    v_mfma_f32_16x16x32_bf16 v[128:131], a[108:111], v[88:91], v[128:131]
    ds_read_b128 v[204:207], v17 offset:0
    v_mfma_f32_16x16x32_bf16 v[132:135], a[112:115], v[88:91], v[132:135]
    ds_read_b128 v[208:211], v17 offset:1024
    v_mfma_f32_16x16x32_bf16 v[136:139], a[116:119], v[88:91], v[136:139]
    ds_read_b128 v[212:215], v17 offset:2048
    s_waitcnt vmcnt(5)
    v_mfma_f32_16x16x32_bf16 v[120:123], a[120:123], v[92:95], v[120:123]
    v_mfma_f32_16x16x32_bf16 v[124:127], a[124:127], v[92:95], v[124:127]
    ds_read_b128 v[216:219], v17 offset:3072
    v_mfma_f32_16x16x32_bf16 v[128:131], a[128:131], v[92:95], v[128:131]
    ds_read_b128 v[220:223], v17 offset:4096
    v_mfma_f32_16x16x32_bf16 v[132:135], a[132:135], v[92:95], v[132:135]
    ds_read_b128 v[20:23], v17 offset:5120
    v_mfma_f32_16x16x32_bf16 v[136:139], a[136:139], v[92:95], v[136:139]
    ds_read_b128 v[24:27], v17 offset:6144
    s_waitcnt vmcnt(4)
    v_mfma_f32_16x16x32_bf16 v[120:123], a[140:143], v[96:99], v[120:123]
    v_mfma_f32_16x16x32_bf16 v[124:127], a[144:147], v[96:99], v[124:127]
    ds_read_b128 v[28:31], v17 offset:7168
    v_mfma_f32_16x16x32_bf16 v[128:131], a[148:151], v[96:99], v[128:131]
    ds_read_b128 v[32:35], v17 offset:8192
    v_mfma_f32_16x16x32_bf16 v[132:135], a[152:155], v[96:99], v[132:135]
    ds_read_b128 v[36:39], v17 offset:9216
    s_waitcnt lgkmcnt(5)
    v_mfma_f32_16x16x32_bf16 v[136:139], a[156:159], v[96:99], v[136:139]
    ds_read_b128 v[40:43], v17 offset:10240
    v_add_f32 v236, v236, v204
    s_waitcnt vmcnt(3)
    v_mfma_f32_16x16x32_bf16 v[120:123], a[160:163], v[100:103], v[120:123]
    v_mfma_f32_16x16x32_bf16 v[124:127], a[164:167], v[100:103], v[124:127]
    ds_read_b128 v[44:47], v17 offset:11264
    v_add_f32_e64 v237, v237, v205
    v_mfma_f32_16x16x32_bf16 v[128:131], a[168:171], v[100:103], v[128:131]
    ds_read_b128 v[48:51], v17 offset:12288
    v_add_f32_e64 v238, v238, v206
    v_mfma_f32_16x16x32_bf16 v[132:135], a[172:175], v[100:103], v[132:135]
    ds_read_b128 v[52:55], v17 offset:13312
    v_add_f32_e64 v239, v239, v207
    v_mfma_f32_16x16x32_bf16 v[136:139], a[176:179], v[100:103], v[136:139]
    ds_read_b128 v[56:59], v17 offset:14336
    v_add_f32 v240, v240, v208
    s_waitcnt vmcnt(2)
    v_mfma_f32_16x16x32_bf16 v[120:123], a[180:183], v[104:107], v[120:123]
    v_mfma_f32_16x16x32_bf16 v[124:127], a[184:187], v[104:107], v[124:127]
    v_add_f32 v241, v241, v209
    v_add_f32 v242, v242, v210
    v_mfma_f32_16x16x32_bf16 v[128:131], a[188:191], v[104:107], v[128:131]
    v_add_f32 v243, v243, v211
    v_add_f32 v244, v244, v212
    v_mfma_f32_16x16x32_bf16 v[132:135], a[192:195], v[104:107], v[132:135]
    v_add_f32 v245, v245, v213
    v_add_f32 v246, v246, v214
    v_mfma_f32_16x16x32_bf16 v[136:139], a[196:199], v[104:107], v[136:139]
    v_add_f32 v247, v247, v215
    v_add_f32_e64 v248, v248, v216
    s_waitcnt vmcnt(1)
    v_mfma_f32_16x16x32_bf16 v[120:123], a[200:203], v[108:111], v[120:123]
    v_mfma_f32_16x16x32_bf16 v[124:127], a[204:207], v[108:111], v[124:127]
    v_add_f32_e64 v249, v249, v217
    v_add_f32 v250, v250, v218
    v_mfma_f32_16x16x32_bf16 v[128:131], a[208:211], v[108:111], v[128:131]
    v_add_f32 v251, v251, v219
    v_add_f32 v252, v252, v220
    v_mfma_f32_16x16x32_bf16 v[132:135], a[212:215], v[108:111], v[132:135]
    v_add_f32 v253, v253, v221
    v_add_f32 v254, v254, v222
    v_mfma_f32_16x16x32_bf16 v[136:139], a[216:219], v[108:111], v[136:139]
    v_add_f32 v255, v255, v223
    s_waitcnt lgkmcnt(5)
    s_waitcnt vmcnt(0)
    v_mfma_f32_16x16x32_bf16 v[120:123], a[220:223], v[112:115], v[120:123]
    v_mfma_f32_16x16x32_bf16 v[124:127], a[224:227], v[112:115], v[124:127]
    v_add_f32 v236, v236, v20
    v_add_f32 v237, v237, v21
    v_mfma_f32_16x16x32_bf16 v[128:131], a[228:231], v[112:115], v[128:131]
    v_add_f32 v238, v238, v22
    v_add_f32 v239, v239, v23
    v_mfma_f32_16x16x32_bf16 v[132:135], a[232:235], v[112:115], v[132:135]
    v_add_f32 v240, v240, v24
    v_add_f32 v241, v241, v25
    v_mfma_f32_16x16x32_bf16 v[136:139], a[236:239], v[112:115], v[136:139]
    v_add_f32 v242, v242, v26
    v_add_f32 v243, v243, v27
    v_add_f32 v244, v244, v28
    v_add_f32 v245, v245, v29
    v_add_f32 v246, v246, v30
    v_add_f32 v247, v247, v31
    v_add_f32 v248, v248, v32
    v_add_f32 v249, v249, v33
    v_add_f32 v250, v250, v34
    v_add_f32 v251, v251, v35
    v_add_f32 v252, v252, v36
    v_add_f32 v253, v253, v37
    v_add_f32 v254, v254, v38
    v_add_f32_e64 v255, v255, v39
    s_waitcnt lgkmcnt(0)
    v_pk_add_f32 v[236:237], v[236:237], v[40:41]
    v_pk_add_f32 v[238:239], v[238:239], v[42:43]
    v_pk_add_f32 v[240:241], v[240:241], v[44:45]
    v_pk_add_f32 v[242:243], v[242:243], v[46:47]
    v_pk_add_f32 v[244:245], v[244:245], v[48:49]
    v_pk_add_f32 v[246:247], v[246:247], v[50:51]
    v_pk_add_f32 v[248:249], v[248:249], v[52:53]
    v_pk_add_f32 v[250:251], v[250:251], v[54:55]
    v_pk_add_f32 v[252:253], v[252:253], v[56:57]
    v_pk_add_f32 v[254:255], v[254:255], v[58:59]
    v_pk_add_f32 v[120:121], v[120:121], v[236:237]
    v_cvt_pk_bf16_f32 v204, v120, v121
    ds_bpermute_b32 v214, v12, v204
    v_pk_add_f32 v[122:123], v[122:123], v[238:239]
    v_cvt_pk_bf16_f32 v205, v122, v123
    ds_bpermute_b32 v215, v12, v205
    v_pk_add_f32 v[124:125], v[124:125], v[240:241]
    v_cvt_pk_bf16_f32 v206, v124, v125
    ds_bpermute_b32 v216, v12, v206
    v_pk_add_f32 v[126:127], v[126:127], v[242:243]
    v_cvt_pk_bf16_f32 v207, v126, v127
    ds_bpermute_b32 v217, v12, v207
    v_pk_add_f32 v[128:129], v[128:129], v[244:245]
    v_cvt_pk_bf16_f32 v208, v128, v129
    ds_bpermute_b32 v218, v12, v208
    v_pk_add_f32 v[130:131], v[130:131], v[246:247]
    v_cvt_pk_bf16_f32 v209, v130, v131
    ds_bpermute_b32 v219, v12, v209
    v_pk_add_f32 v[132:133], v[132:133], v[248:249]
    v_cvt_pk_bf16_f32 v210, v132, v133
    ds_bpermute_b32 v220, v12, v210
    s_waitcnt lgkmcnt(3)
    buffer_store_dwordx4 v[214:217], v4, s[16:19], s32 offen
    v_pk_add_f32 v[134:135], v[134:135], v[250:251]
    v_cvt_pk_bf16_f32 v211, v134, v135
    ds_bpermute_b32 v221, v12, v211
    v_pk_add_f32 v[136:137], v[136:137], v[252:253]
    v_cvt_pk_bf16_f32 v212, v136, v137
    ds_bpermute_b32 v222, v12, v212
    v_pk_add_f32 v[138:139], v[138:139], v[254:255]
    v_cvt_pk_bf16_f32 v213, v138, v139
    ds_bpermute_b32 v223, v12, v213
    s_waitcnt lgkmcnt(2)
    buffer_store_dwordx4 v[218:221], v4, s[16:19], s32 offen offset:64
    s_waitcnt lgkmcnt(0)
    buffer_store_dwordx2 v[222:223], v5, s[16:19], s32 offen offset:128
kf_done:
kf_exit:
    s_endpgm
kf_notx:
    s_cmp_ge_u32 s2, 240
    s_cbranch_scc1 kf_spare
    s_sub_u32 s32, s2, 160
    s_and_b32 s29, s32, 7
    s_lshl_b32 s29, s29, 1
    s_bfe_u32 s33, s32, 0x10003
    s_add_u32 s29, s29, s33
    s_lshr_b32 s30, s32, 4
    v_add_u32 v3, 0, v1
    v_mul_u32_u24 v2, 5462, v3
    v_lshrrev_b32_e64 v2, 16, v2
    v_mul_u32_u24 v9, 12, v2
    v_sub_u32 v3, v3, v9
    v_bfe_u32 v4, v2, 3, 1
    v_lshlrev_b32 v4, 1, v4
    v_xor_b32 v3, v3, v4
    v_mul_u32_u24 v2, 3072, v2
    v_lshl_add_u32 v14, v3, 4, v2
    v_add_u32 v3, 64, v1
    v_mul_u32_u24 v2, 5462, v3
    v_lshrrev_b32 v2, 16, v2
    v_mul_u32_u24 v9, 12, v2
    v_sub_u32 v3, v3, v9
    v_bfe_u32 v4, v2, 3, 1
    v_lshlrev_b32 v4, 1, v4
    v_xor_b32 v3, v3, v4
    v_mul_u32_u24 v2, 3072, v2
    v_lshl_add_u32 v15, v3, 4, v2
    v_add_u32 v3, 128, v1
    v_mul_u32_u24 v2, 5462, v3
    v_lshrrev_b32 v2, 16, v2
    v_mul_u32_u24 v9, 12, v2
    v_sub_u32 v3, v3, v9
    v_bfe_u32 v4, v2, 3, 1
    v_lshlrev_b32 v4, 1, v4
    v_xor_b32_e64 v3, v3, v4
    v_mul_u32_u24 v2, 3072, v2
    v_lshl_add_u32 v16, v3, 4, v2
    s_lshr_b32 s32, s28, 1
    s_and_b32 s33, s28, 1
    s_mul_i32 s33, s33, 10
    s_add_u32 s32, s32, s33
    s_mul_i32 s41, s32, 6144
    s_lshl_b32 s33, s30, 1
    s_add_u32 s42, s32, s33
    s_mul_i32 s40, s29, 192
    s_waitcnt lgkmcnt(0)
    s_mov_b32 s24, s52
    s_and_b32 s25, s53, 0xffff
    s_mov_b32 s26, 1966080
    s_mov_b32 s27, 0x20000
    s_add_u32 m0, s41, 0
    s_add_u32 s43, s42, 0
    s_cmp_ge_u32 s43, 20
    s_cselect_b32 s44, 20, 0
    s_sub_u32 s43, s43, s44
    s_mul_i32 s43, s43, 98304
    s_add_u32 s43, s43, s40
    buffer_load_dwordx4 v14, s[24:27], s43 offen  lds
    s_add_u32 m0, s41, 1024
    s_nop 0
    buffer_load_dwordx4 v15, s[24:27], s43 offen  lds
    s_add_u32 m0, s41, 2048
    s_nop 0
    buffer_load_dwordx4 v16, s[24:27], s43 offen  lds
    s_add_u32 m0, s41, 3072
    s_add_u32 s43, s43, 49152
    buffer_load_dwordx4 v14, s[24:27], s43 offen  lds
    s_add_u32 m0, s41, 4096
    s_nop 0
    buffer_load_dwordx4 v15, s[24:27], s43 offen  lds
    s_add_u32 m0, s41, 5120
    s_nop 0
    buffer_load_dwordx4 v16, s[24:27], s43 offen  lds
    s_lshl_b32 s31, s30, 6
    s_add_u32 s32, s31, s28
    s_add_u32 s32, s32, 1
    v_and_b32 v2, 15, v1
    v_lshl_add_u32 v2, v2, 2, s32
    v_cvt_f32_u32_e64 v2, v2
    v_mul_f32 v2, 0x3acccccd, v2
    v_lshrrev_b32 v3, 4, v1
    v_lshl_add_u32 v3, v3, 3, s31
    v_cvt_f32_u32 v3, v3
    v_mul_f32 v3, v3, v2
    v_cos_f32 v120, v2
    v_sin_f32_e64 v121, -v2
    v_fmamk_f32 v4, v2, 0x00000000, v3
    v_cos_f32_e64 v100, v4
    v_sin_f32_e64 v101, -v4
    v_fmamk_f32 v5, v2, 0x42000000, v3
    v_cos_f32_e64 v104, v5
    v_sin_f32_e64 v105, -v5
    v_fmamk_f32 v4, v2, 0x42800000, v3
    v_cos_f32_e64 v108, v4
    v_sin_f32_e64 v109, -v4
    v_fmamk_f32 v5, v2, 0x42c00000, v3
    v_cos_f32_e64 v112, v5
    v_sin_f32_e64 v113, -v5
    v_fmamk_f32 v4, v2, 0x43000000, v3
    v_cos_f32_e64 v116, v4
    v_sin_f32_e64 v117, -v4
    s_mov_b32 s20, s14
    s_and_b32 s21, s15, 0xffff
    s_mov_b32 s22, 19398656
    s_mov_b32 s23, 0x20000
    v_pk_mul_f32 v[102:103], v[100:101], v[120:121] op_sel_hi:[1,0]
    s_add_u32 m0, s41, 12288
    s_add_u32 s43, s42, 2
    s_cmp_ge_u32 s43, 20
    s_cselect_b32 s44, 20, 0
    s_sub_u32 s43, s43, s44
    s_mul_i32 s43, s43, 98304
    s_add_u32 s43, s43, s40
    buffer_load_dwordx4 v14, s[24:27], s43 offen  lds
    v_pk_mul_f32 v[106:107], v[104:105], v[120:121] op_sel_hi:[1,0]
    v_pk_mul_f32 v[110:111], v[108:109], v[120:121] op_sel_hi:[1,0]
    v_pk_mul_f32 v[114:115], v[112:113], v[120:121] op_sel_hi:[1,0]
    v_pk_mul_f32 v[118:119], v[116:117], v[120:121] op_sel_hi:[1,0]
    v_pk_fma_f32 v[102:103], v[100:101], v[120:121], v[102:103] op_sel:[1,1,0] op_sel_hi:[0,1,1] neg_lo:[1,0,0]
    v_pk_fma_f32 v[106:107], v[104:105], v[120:121], v[106:107] op_sel:[1,1,0] op_sel_hi:[0,1,1] neg_lo:[1,0,0]
    v_pk_fma_f32 v[110:111], v[108:109], v[120:121], v[110:111] op_sel:[1,1,0] op_sel_hi:[0,1,1] neg_lo:[1,0,0]
    v_pk_fma_f32 v[114:115], v[112:113], v[120:121], v[114:115] op_sel:[1,1,0] op_sel_hi:[0,1,1] neg_lo:[1,0,0]
    v_pk_fma_f32 v[118:119], v[116:117], v[120:121], v[118:119] op_sel:[1,1,0] op_sel_hi:[0,1,1] neg_lo:[1,0,0]
    v_cvt_pk_bf16_f32 v20, v100, v102
    v_cvt_pk_bf16_f32 v24, v101, v103
    v_cvt_pk_bf16_f32 v28, v104, v106
    s_add_u32 m0, s41, 13312
    s_nop 0
    buffer_load_dwordx4 v15, s[24:27], s43 offen  lds
    v_cvt_pk_bf16_f32 v32, v105, v107
    v_cvt_pk_bf16_f32 v36, v108, v110
    v_cvt_pk_bf16_f32 v40, v109, v111
    v_cvt_pk_bf16_f32 v44, v112, v114
    v_cvt_pk_bf16_f32 v48, v113, v115
    v_cvt_pk_bf16_f32 v52, v116, v118
    v_cvt_pk_bf16_f32 v56, v117, v119
    v_pk_mul_f32 v[100:101], v[102:103], v[120:121] op_sel_hi:[1,0]
    v_pk_mul_f32 v[104:105], v[106:107], v[120:121] op_sel_hi:[1,0]
    v_pk_mul_f32 v[108:109], v[110:111], v[120:121] op_sel_hi:[1,0]
    v_pk_mul_f32 v[112:113], v[114:115], v[120:121] op_sel_hi:[1,0]
    v_pk_mul_f32 v[116:117], v[118:119], v[120:121] op_sel_hi:[1,0]
    s_add_u32 m0, s41, 14336
    s_nop 0
    buffer_load_dwordx4 v16, s[24:27], s43 offen  lds
    v_pk_fma_f32 v[100:101], v[102:103], v[120:121], v[100:101] op_sel:[1,1,0] op_sel_hi:[0,1,1] neg_lo:[1,0,0]
    v_pk_fma_f32 v[104:105], v[106:107], v[120:121], v[104:105] op_sel:[1,1,0] op_sel_hi:[0,1,1] neg_lo:[1,0,0]
    v_pk_fma_f32 v[108:109], v[110:111], v[120:121], v[108:109] op_sel:[1,1,0] op_sel_hi:[0,1,1] neg_lo:[1,0,0]
    v_pk_fma_f32 v[112:113], v[114:115], v[120:121], v[112:113] op_sel:[1,1,0] op_sel_hi:[0,1,1] neg_lo:[1,0,0]
    v_pk_fma_f32 v[116:117], v[118:119], v[120:121], v[116:117] op_sel:[1,1,0] op_sel_hi:[0,1,1] neg_lo:[1,0,0]
    v_pk_mul_f32 v[102:103], v[100:101], v[120:121] op_sel_hi:[1,0]
    v_pk_mul_f32 v[106:107], v[104:105], v[120:121] op_sel_hi:[1,0]
    v_pk_mul_f32 v[110:111], v[108:109], v[120:121] op_sel_hi:[1,0]
    v_pk_mul_f32 v[114:115], v[112:113], v[120:121] op_sel_hi:[1,0]
    v_pk_mul_f32 v[118:119], v[116:117], v[120:121] op_sel_hi:[1,0]
    v_pk_fma_f32 v[102:103], v[100:101], v[120:121], v[102:103] op_sel:[1,1,0] op_sel_hi:[0,1,1] neg_lo:[1,0,0]
    v_pk_fma_f32 v[106:107], v[104:105], v[120:121], v[106:107] op_sel:[1,1,0] op_sel_hi:[0,1,1] neg_lo:[1,0,0]
    s_add_u32 m0, s41, 15360
    s_add_u32 s43, s43, 49152
    buffer_load_dwordx4 v14, s[24:27], s43 offen  lds
    v_pk_fma_f32 v[110:111], v[108:109], v[120:121], v[110:111] op_sel:[1,1,0] op_sel_hi:[0,1,1] neg_lo:[1,0,0]
    v_pk_fma_f32 v[114:115], v[112:113], v[120:121], v[114:115] op_sel:[1,1,0] op_sel_hi:[0,1,1] neg_lo:[1,0,0]
    v_pk_fma_f32 v[118:119], v[116:117], v[120:121], v[118:119] op_sel:[1,1,0] op_sel_hi:[0,1,1] neg_lo:[1,0,0]
    v_cvt_pk_bf16_f32 v21, v100, v102
    v_cvt_pk_bf16_f32 v25, v101, v103
    v_cvt_pk_bf16_f32 v29, v104, v106
    v_cvt_pk_bf16_f32 v33, v105, v107
    v_cvt_pk_bf16_f32 v37, v108, v110
    v_cvt_pk_bf16_f32 v41, v109, v111
    v_cvt_pk_bf16_f32 v45, v112, v114
    v_cvt_pk_bf16_f32 v49, v113, v115
    v_cvt_pk_bf16_f32 v53, v116, v118
    s_add_u32 m0, s41, 16384
    s_nop 0
    buffer_load_dwordx4 v15, s[24:27], s43 offen  lds
    v_cvt_pk_bf16_f32 v57, v117, v119
    v_pk_mul_f32 v[100:101], v[102:103], v[120:121] op_sel_hi:[1,0]
    v_pk_mul_f32 v[104:105], v[106:107], v[120:121] op_sel_hi:[1,0]
    v_pk_mul_f32 v[108:109], v[110:111], v[120:121] op_sel_hi:[1,0]
    v_pk_mul_f32 v[112:113], v[114:115], v[120:121] op_sel_hi:[1,0]
    v_pk_mul_f32 v[116:117], v[118:119], v[120:121] op_sel_hi:[1,0]
    v_pk_fma_f32 v[100:101], v[102:103], v[120:121], v[100:101] op_sel:[1,1,0] op_sel_hi:[0,1,1] neg_lo:[1,0,0]
    v_pk_fma_f32 v[104:105], v[106:107], v[120:121], v[104:105] op_sel:[1,1,0] op_sel_hi:[0,1,1] neg_lo:[1,0,0]
    v_pk_fma_f32 v[108:109], v[110:111], v[120:121], v[108:109] op_sel:[1,1,0] op_sel_hi:[0,1,1] neg_lo:[1,0,0]
    v_pk_fma_f32 v[112:113], v[114:115], v[120:121], v[112:113] op_sel:[1,1,0] op_sel_hi:[0,1,1] neg_lo:[1,0,0]
    v_pk_fma_f32 v[116:117], v[118:119], v[120:121], v[116:117] op_sel:[1,1,0] op_sel_hi:[0,1,1] neg_lo:[1,0,0]
    v_pk_mul_f32 v[102:103], v[100:101], v[120:121] op_sel_hi:[1,0]
    s_add_u32 m0, s41, 17408
    s_nop 0
    buffer_load_dwordx4 v16, s[24:27], s43 offen  lds
    v_pk_mul_f32 v[106:107], v[104:105], v[120:121] op_sel_hi:[1,0]
    v_pk_mul_f32 v[110:111], v[108:109], v[120:121] op_sel_hi:[1,0]
    v_pk_mul_f32 v[114:115], v[112:113], v[120:121] op_sel_hi:[1,0]
    v_pk_mul_f32 v[118:119], v[116:117], v[120:121] op_sel_hi:[1,0]
    v_pk_fma_f32 v[102:103], v[100:101], v[120:121], v[102:103] op_sel:[1,1,0] op_sel_hi:[0,1,1] neg_lo:[1,0,0]
    v_pk_fma_f32 v[106:107], v[104:105], v[120:121], v[106:107] op_sel:[1,1,0] op_sel_hi:[0,1,1] neg_lo:[1,0,0]
    v_pk_fma_f32 v[110:111], v[108:109], v[120:121], v[110:111] op_sel:[1,1,0] op_sel_hi:[0,1,1] neg_lo:[1,0,0]
    v_pk_fma_f32 v[114:115], v[112:113], v[120:121], v[114:115] op_sel:[1,1,0] op_sel_hi:[0,1,1] neg_lo:[1,0,0]
    v_pk_fma_f32 v[118:119], v[116:117], v[120:121], v[118:119] op_sel:[1,1,0] op_sel_hi:[0,1,1] neg_lo:[1,0,0]
    v_cvt_pk_bf16_f32 v22, v100, v102
    v_cvt_pk_bf16_f32 v26, v101, v103
    v_cvt_pk_bf16_f32 v30, v104, v106
    s_add_u32 m0, s41, 24576
    s_add_u32 s43, s42, 4
    s_cmp_ge_u32 s43, 20
    s_cselect_b32 s44, 20, 0
    s_sub_u32 s43, s43, s44
    s_mul_i32 s43, s43, 98304
    s_add_u32 s43, s43, s40
    buffer_load_dwordx4 v14, s[24:27], s43 offen  lds
    v_cvt_pk_bf16_f32 v34, v105, v107
    v_cvt_pk_bf16_f32 v38, v108, v110
    v_cvt_pk_bf16_f32 v42, v109, v111
    v_cvt_pk_bf16_f32 v46, v112, v114
    v_cvt_pk_bf16_f32 v50, v113, v115
    v_cvt_pk_bf16_f32 v54, v116, v118
    v_cvt_pk_bf16_f32 v58, v117, v119
    v_pk_mul_f32 v[100:101], v[102:103], v[120:121] op_sel_hi:[1,0]
    v_pk_mul_f32 v[104:105], v[106:107], v[120:121] op_sel_hi:[1,0]
    v_pk_mul_f32 v[108:109], v[110:111], v[120:121] op_sel_hi:[1,0]
    v_pk_mul_f32 v[112:113], v[114:115], v[120:121] op_sel_hi:[1,0]
    v_pk_mul_f32 v[116:117], v[118:119], v[120:121] op_sel_hi:[1,0]
    s_add_u32 m0, s41, 25600
    s_nop 0
    buffer_load_dwordx4 v15, s[24:27], s43 offen  lds
    v_pk_fma_f32 v[100:101], v[102:103], v[120:121], v[100:101] op_sel:[1,1,0] op_sel_hi:[0,1,1] neg_lo:[1,0,0]
    v_pk_fma_f32 v[104:105], v[106:107], v[120:121], v[104:105] op_sel:[1,1,0] op_sel_hi:[0,1,1] neg_lo:[1,0,0]
    v_pk_fma_f32 v[108:109], v[110:111], v[120:121], v[108:109] op_sel:[1,1,0] op_sel_hi:[0,1,1] neg_lo:[1,0,0]
    v_pk_fma_f32 v[112:113], v[114:115], v[120:121], v[112:113] op_sel:[1,1,0] op_sel_hi:[0,1,1] neg_lo:[1,0,0]
    v_pk_fma_f32 v[116:117], v[118:119], v[120:121], v[116:117] op_sel:[1,1,0] op_sel_hi:[0,1,1] neg_lo:[1,0,0]
    v_pk_mul_f32 v[102:103], v[100:101], v[120:121] op_sel_hi:[1,0]
    v_pk_mul_f32 v[106:107], v[104:105], v[120:121] op_sel_hi:[1,0]
    v_pk_mul_f32 v[110:111], v[108:109], v[120:121] op_sel_hi:[1,0]
    v_pk_mul_f32 v[114:115], v[112:113], v[120:121] op_sel_hi:[1,0]
    v_pk_mul_f32 v[118:119], v[116:117], v[120:121] op_sel_hi:[1,0]
    v_pk_fma_f32 v[102:103], v[100:101], v[120:121], v[102:103] op_sel:[1,1,0] op_sel_hi:[0,1,1] neg_lo:[1,0,0]
    v_pk_fma_f32 v[106:107], v[104:105], v[120:121], v[106:107] op_sel:[1,1,0] op_sel_hi:[0,1,1] neg_lo:[1,0,0]
    s_add_u32 m0, s41, 26624
    s_nop 0
    buffer_load_dwordx4 v16, s[24:27], s43 offen  lds
    v_pk_fma_f32 v[110:111], v[108:109], v[120:121], v[110:111] op_sel:[1,1,0] op_sel_hi:[0,1,1] neg_lo:[1,0,0]
    v_pk_fma_f32 v[114:115], v[112:113], v[120:121], v[114:115] op_sel:[1,1,0] op_sel_hi:[0,1,1] neg_lo:[1,0,0]
    v_pk_fma_f32 v[118:119], v[116:117], v[120:121], v[118:119] op_sel:[1,1,0] op_sel_hi:[0,1,1] neg_lo:[1,0,0]
    v_cvt_pk_bf16_f32 v23, v100, v102
    v_cvt_pk_bf16_f32 v27, v101, v103
    v_cvt_pk_bf16_f32 v31, v104, v106
    v_cvt_pk_bf16_f32 v35, v105, v107
    v_cvt_pk_bf16_f32 v39, v108, v110
    v_cvt_pk_bf16_f32 v43, v109, v111
    v_cvt_pk_bf16_f32 v47, v112, v114
    v_cvt_pk_bf16_f32 v51, v113, v115
    v_cvt_pk_bf16_f32 v55, v116, v118
    s_add_u32 m0, s41, 27648
    s_add_u32 s43, s43, 49152
    buffer_load_dwordx4 v14, s[24:27], s43 offen  lds
    v_cvt_pk_bf16_f32 v59, v117, v119
    s_lshl_b32 s32, s30, 2
    s_add_u32 s32, s32, s28
    s_cmp_eq_u32 s32, 19
    s_cbranch_scc0 kw_nofix
    v_and_b32 v2, 15, v1
    v_cmp_eq_u32 vcc, 15, v2
    v_mov_b32 v3, 0xbf353f35
    v_mov_b32 v4, 0
    v_cndmask_b32 v20, v20, v3, vcc
    v_cndmask_b32 v24, v24, v4, vcc
    v_cndmask_b32 v21, v21, v3, vcc
    v_cndmask_b32 v25, v25, v4, vcc
    v_cndmask_b32 v22, v22, v3, vcc
    v_cndmask_b32 v26, v26, v4, vcc
    v_cndmask_b32 v23, v23, v3, vcc
    v_cndmask_b32 v27, v27, v4, vcc
    v_cndmask_b32 v28, v28, v3, vcc
    v_cndmask_b32 v32, v32, v4, vcc
    v_cndmask_b32 v29, v29, v3, vcc
    v_cndmask_b32 v33, v33, v4, vcc
    v_cndmask_b32 v30, v30, v3, vcc
    v_cndmask_b32 v34, v34, v4, vcc
    v_cndmask_b32 v31, v31, v3, vcc
    v_cndmask_b32 v35, v35, v4, vcc
    v_cndmask_b32 v36, v36, v3, vcc
    v_cndmask_b32 v40, v40, v4, vcc
    v_cndmask_b32 v37, v37, v3, vcc
    v_cndmask_b32 v41, v41, v4, vcc
    v_cndmask_b32 v38, v38, v3, vcc
    v_cndmask_b32 v42, v42, v4, vcc
    v_cndmask_b32 v39, v39, v3, vcc
    v_cndmask_b32 v43, v43, v4, vcc
    v_cndmask_b32 v44, v44, v3, vcc
    v_cndmask_b32 v48, v48, v4, vcc
    v_cndmask_b32 v45, v45, v3, vcc
    v_cndmask_b32 v49, v49, v4, vcc
    v_cndmask_b32 v46, v46, v3, vcc
    v_cndmask_b32 v50, v50, v4, vcc
    v_cndmask_b32 v47, v47, v3, vcc
    v_cndmask_b32 v51, v51, v4, vcc
    v_cndmask_b32 v52, v52, v3, vcc
    v_cndmask_b32 v56, v56, v4, vcc
    v_cndmask_b32 v53, v53, v3, vcc
    v_cndmask_b32 v57, v57, v4, vcc
    v_cndmask_b32 v54, v54, v3, vcc
    v_cndmask_b32 v58, v58, v4, vcc
    v_cndmask_b32 v55, v55, v3, vcc
    v_cndmask_b32 v59, v59, v4, vcc
kw_nofix:
    s_add_u32 s32, s28, 1
    s_and_b32 s32, s32, 2
    s_cmp_lg_u32 s32, 0
    s_cselect_b32 s33, 0x80008000, 0
    s_cmp_lt_u32 s28, 2
    s_cselect_b32 s34, 0x80008000, 0
    s_bitcmp1_b32 s28, 0
    s_cselect_b32 s46, 1.0, -1.0
    s_cselect_b32 s47, 1.0, -1.0
    s_cbranch_scc1 kw_keep
    v_xor_b32 v60, s33, v24
    v_xor_b32 v64, s34, v20
    v_xor_b32 v61, s33, v25
    v_xor_b32 v65, s34, v21
    v_xor_b32 v62, s33, v26
    v_xor_b32 v66, s34, v22
    v_xor_b32 v63, s33, v27
    v_xor_b32 v67, s34, v23
    v_xor_b32 v68, s33, v32
    v_xor_b32 v72, s34, v28
    v_xor_b32 v69, s33, v33
    v_xor_b32 v73, s34, v29
    v_xor_b32 v70, s33, v34
    v_xor_b32 v74, s34, v30
    v_xor_b32 v71, s33, v35
    v_xor_b32 v75, s34, v31
    v_xor_b32 v76, s33, v40
    v_xor_b32 v80, s34, v36
    v_xor_b32 v77, s33, v41
    v_xor_b32 v81, s34, v37
    v_xor_b32 v78, s33, v42
    v_xor_b32 v82, s34, v38
    v_xor_b32 v79, s33, v43
    v_xor_b32 v83, s34, v39
    v_xor_b32 v84, s33, v48
    v_xor_b32 v88, s34, v44
    v_xor_b32 v85, s33, v49
    v_xor_b32 v89, s34, v45
    v_xor_b32 v86, s33, v50
    v_xor_b32 v90, s34, v46
    v_xor_b32 v87, s33, v51
    v_xor_b32 v91, s34, v47
    v_xor_b32 v92, s33, v56
    v_xor_b32 v96, s34, v52
    v_xor_b32 v93, s33, v57
    v_xor_b32 v97, s34, v53
    v_xor_b32 v94, s33, v58
    v_xor_b32 v98, s34, v54
    v_xor_b32 v95, s33, v59
    v_xor_b32 v99, s34, v55
    s_branch kw_shifted
kw_keep:
    v_xor_b32 v60, s33, v20
    v_xor_b32 v64, s34, v24
    v_xor_b32 v61, s33, v21
    v_xor_b32 v65, s34, v25
    v_xor_b32 v62, s33, v22
    v_xor_b32 v66, s34, v26
    v_xor_b32 v63, s33, v23
    v_xor_b32 v67, s34, v27
    v_xor_b32 v68, s33, v28
    v_xor_b32 v72, s34, v32
    v_xor_b32 v69, s33, v29
    v_xor_b32 v73, s34, v33
    v_xor_b32 v70, s33, v30
    v_xor_b32 v74, s34, v34
    v_xor_b32 v71, s33, v31
    v_xor_b32 v75, s34, v35
    v_xor_b32 v76, s33, v36
    v_xor_b32 v80, s34, v40
    v_xor_b32 v77, s33, v37
    v_xor_b32 v81, s34, v41
    v_xor_b32 v78, s33, v38
    v_xor_b32 v82, s34, v42
    v_xor_b32 v79, s33, v39
    v_xor_b32 v83, s34, v43
    v_xor_b32 v84, s33, v44
    v_xor_b32 v88, s34, v48
    v_xor_b32 v85, s33, v45
    v_xor_b32 v89, s34, v49
    v_xor_b32 v86, s33, v46
    v_xor_b32 v90, s34, v50
    v_xor_b32 v87, s33, v47
    v_xor_b32 v91, s34, v51
    v_xor_b32 v92, s33, v52
    v_xor_b32 v96, s34, v56
    v_xor_b32 v93, s33, v53
    v_xor_b32 v97, s34, v57
    v_xor_b32 v94, s33, v54
    v_xor_b32 v98, s34, v58
    v_xor_b32 v95, s33, v55
    v_xor_b32 v99, s34, v59
kw_shifted:
    v_lshrrev_b32 v2, 4, v1
    v_bfe_u32 v3, v1, 2, 2
    v_lshl_add_u32 v3, v2, 3, v3
    v_mul_u32_u24 v3, 192, v3
    v_and_b32 v4, 3, v1
    v_lshl_add_u32 v3, v4, 3, v3
    v_and_b32 v2, 1, v2
    v_lshlrev_b32 v2, 5, v2
    v_add_u32 v10, v3, v2
    v_sub_u32 v11, v3, v2
    v_add_u32 v11, 32, v11
    v_add_u32 v12, 61440, v10
    v_add_u32 v13, 61440, v11
    s_waitcnt vmcnt(10)
    s_barrier
    ds_read_b64_tr_b16 v[100:101], v10 offset:0
    ds_read_b64_tr_b16 v[102:103], v10 offset:768
    ds_read_b64_tr_b16 v[104:105], v11 offset:0
    ds_read_b64_tr_b16 v[106:107], v11 offset:768
    ds_read_b64_tr_b16 v[108:109], v10 offset:64
    ds_read_b64_tr_b16 v[110:111], v10 offset:832
    ds_read_b64_tr_b16 v[112:113], v11 offset:64
    ds_read_b64_tr_b16 v[114:115], v11 offset:832
    ds_read_b64_tr_b16 v[116:117], v10 offset:128
    ds_read_b64_tr_b16 v[118:119], v10 offset:896
    ds_read_b64_tr_b16 v[120:121], v11 offset:128
    ds_read_b64_tr_b16 v[122:123], v11 offset:896
    s_waitcnt lgkmcnt(6)
    v_mfma_f32_16x16x32_bf16 v[148:151], v[20:23], v[100:103], 0
    ds_read_b64_tr_b16 v[124:125], v12 offset:0
    s_add_u32 m0, s41, 28672
    v_mfma_f32_16x16x32_bf16 v[152:155], v[24:27], v[100:103], 0
    ds_read_b64_tr_b16 v[126:127], v12 offset:768
    buffer_load_dwordx4 v15, s[24:27], s43 offen  lds
    v_mfma_f32_16x16x32_bf16 v[156:159], v[20:23], v[104:107], 0
    ds_read_b64_tr_b16 v[128:129], v13 offset:0
    s_add_u32 m0, s41, 29696
    v_mfma_f32_16x16x32_bf16 v[160:163], v[24:27], v[104:107], 0
    ds_read_b64_tr_b16 v[130:131], v13 offset:768
    v_mfma_f32_16x16x32_bf16 v[164:167], v[20:23], v[108:111], 0
    ds_read_b64_tr_b16 v[132:133], v12 offset:64
    v_mfma_f32_16x16x32_bf16 v[168:171], v[24:27], v[108:111], 0
    ds_read_b64_tr_b16 v[134:135], v12 offset:832
    buffer_load_dwordx4 v16, s[24:27], s43 offen  lds
    s_waitcnt lgkmcnt(6)
    v_mfma_f32_16x16x32_bf16 v[172:175], v[20:23], v[112:115], 0
    ds_read_b64_tr_b16 v[136:137], v13 offset:64
    s_add_u32 m0, s41, 36864
    v_mfma_f32_16x16x32_bf16 v[176:179], v[24:27], v[112:115], 0
    ds_read_b64_tr_b16 v[138:139], v13 offset:832
    s_add_u32 s43, s42, 6
    v_mfma_f32_16x16x32_bf16 v[180:183], v[20:23], v[116:119], 0
    ds_read_b64_tr_b16 v[140:141], v12 offset:128
    s_cmp_ge_u32 s43, 20
    v_mfma_f32_16x16x32_bf16 v[184:187], v[24:27], v[116:119], 0
    ds_read_b64_tr_b16 v[142:143], v12 offset:896
    s_cselect_b32 s44, 20, 0
    v_mfma_f32_16x16x32_bf16 v[188:191], v[20:23], v[120:123], 0
    ds_read_b64_tr_b16 v[144:145], v13 offset:128
    s_sub_u32 s43, s43, s44
    v_mfma_f32_16x16x32_bf16 v[192:195], v[24:27], v[120:123], 0
    ds_read_b64_tr_b16 v[146:147], v13 offset:896
    s_mul_i32 s43, s43, 98304
    s_waitcnt lgkmcnt(6)
    v_mfma_f32_16x16x32_bf16 v[196:199], v[20:23], v[124:127], 0
    ds_read_b64_tr_b16 v[100:101], v10 offset:6144
    s_add_u32 s43, s43, s40
    v_mfma_f32_16x16x32_bf16 v[200:203], v[24:27], v[124:127], 0
    ds_read_b64_tr_b16 v[102:103], v10 offset:6912
    buffer_load_dwordx4 v14, s[24:27], s43 offen  lds
    v_mfma_f32_16x16x32_bf16 v[204:207], v[20:23], v[128:131], 0
    ds_read_b64_tr_b16 v[104:105], v11 offset:6144
    s_add_u32 m0, s41, 37888
    v_mfma_f32_16x16x32_bf16 v[208:211], v[24:27], v[128:131], 0
    ds_read_b64_tr_b16 v[106:107], v11 offset:6912
    v_mfma_f32_16x16x32_bf16 v[212:215], v[20:23], v[132:135], 0
    ds_read_b64_tr_b16 v[108:109], v10 offset:6208
    v_mfma_f32_16x16x32_bf16 v[216:219], v[24:27], v[132:135], 0
    ds_read_b64_tr_b16 v[110:111], v10 offset:6976
    buffer_load_dwordx4 v15, s[24:27], s43 offen  lds
    s_waitcnt lgkmcnt(6)
    v_mfma_f32_16x16x32_bf16 v[220:223], v[20:23], v[136:139], 0
    ds_read_b64_tr_b16 v[112:113], v11 offset:6208
    s_add_u32 m0, s41, 38912
    v_mfma_f32_16x16x32_bf16 v[224:227], v[24:27], v[136:139], 0
    ds_read_b64_tr_b16 v[114:115], v11 offset:6976
    v_mfma_f32_16x16x32_bf16 v[228:231], v[20:23], v[140:143], 0
    ds_read_b64_tr_b16 v[116:117], v10 offset:6272
    v_mfma_f32_16x16x32_bf16 v[232:235], v[24:27], v[140:143], 0
    ds_read_b64_tr_b16 v[118:119], v10 offset:7040
    buffer_load_dwordx4 v16, s[24:27], s43 offen  lds
    v_mfma_f32_16x16x32_bf16 v[236:239], v[20:23], v[144:147], 0
    ds_read_b64_tr_b16 v[120:121], v11 offset:6272
    s_add_u32 m0, s41, 39936
    v_mfma_f32_16x16x32_bf16 v[240:243], v[24:27], v[144:147], 0
    ds_read_b64_tr_b16 v[122:123], v11 offset:7040
    s_add_u32 s43, s43, 49152
    s_waitcnt lgkmcnt(6)
    v_mfma_f32_16x16x32_bf16 v[148:151], v[28:31], v[100:103], v[148:151]
    ds_read_b64_tr_b16 v[124:125], v12 offset:6144
    v_mfma_f32_16x16x32_bf16 v[152:155], v[32:35], v[100:103], v[152:155]
    ds_read_b64_tr_b16 v[126:127], v12 offset:6912
    buffer_load_dwordx4 v14, s[24:27], s43 offen  lds
    v_mfma_f32_16x16x32_bf16 v[156:159], v[28:31], v[104:107], v[156:159]
    ds_read_b64_tr_b16 v[128:129], v13 offset:6144
    s_add_u32 m0, s41, 40960
    v_mfma_f32_16x16x32_bf16 v[160:163], v[32:35], v[104:107], v[160:163]
    ds_read_b64_tr_b16 v[130:131], v13 offset:6912
    v_mfma_f32_16x16x32_bf16 v[164:167], v[28:31], v[108:111], v[164:167]
    ds_read_b64_tr_b16 v[132:133], v12 offset:6208
    v_mfma_f32_16x16x32_bf16 v[168:171], v[32:35], v[108:111], v[168:171]
    ds_read_b64_tr_b16 v[134:135], v12 offset:6976
    buffer_load_dwordx4 v15, s[24:27], s43 offen  lds
    s_waitcnt lgkmcnt(6)
    v_mfma_f32_16x16x32_bf16 v[172:175], v[28:31], v[112:115], v[172:175]
    ds_read_b64_tr_b16 v[136:137], v13 offset:6208
    s_add_u32 m0, s41, 41984
    v_mfma_f32_16x16x32_bf16 v[176:179], v[32:35], v[112:115], v[176:179]
    ds_read_b64_tr_b16 v[138:139], v13 offset:6976
    v_mfma_f32_16x16x32_bf16 v[180:183], v[28:31], v[116:119], v[180:183]
    ds_read_b64_tr_b16 v[140:141], v12 offset:6272
    v_mfma_f32_16x16x32_bf16 v[184:187], v[32:35], v[116:119], v[184:187]
    ds_read_b64_tr_b16 v[142:143], v12 offset:7040
    buffer_load_dwordx4 v16, s[24:27], s43 offen  lds
    v_mfma_f32_16x16x32_bf16 v[188:191], v[28:31], v[120:123], v[188:191]
    ds_read_b64_tr_b16 v[144:145], v13 offset:6272
    s_sub_u32 s51, s2, 160
    v_mfma_f32_16x16x32_bf16 v[192:195], v[32:35], v[120:123], v[192:195]
    ds_read_b64_tr_b16 v[146:147], v13 offset:7040
    s_waitcnt lgkmcnt(6)
    v_mfma_f32_16x16x32_bf16 v[196:199], v[28:31], v[124:127], v[196:199]
    s_mov_b32 s4, s56
    s_and_b32 s5, s57, 0xffff
    s_cmp_lt_u32 s51, 64
    s_cselect_b32 s6, 1966080, 0
    s_mov_b32 s7, 0x20000
    v_mfma_f32_16x16x32_bf16 v[200:203], v[32:35], v[124:127], v[200:203]
    v_add_u32_e64 v3, 0, v1
    v_mul_u32_u24 v2, 5462, v3
    s_waitcnt vmcnt(12)
    s_barrier
    v_mfma_f32_16x16x32_bf16 v[204:207], v[28:31], v[128:131], v[204:207]
    ds_read_b64_tr_b16 v[100:101], v10 offset:12288
    v_lshrrev_b32_e64 v2, 16, v2
    v_mfma_f32_16x16x32_bf16 v[208:211], v[32:35], v[128:131], v[208:211]
    ds_read_b64_tr_b16 v[102:103], v10 offset:13056
    v_mul_u32_u24_e64 v4, 12, v2
    v_mfma_f32_16x16x32_bf16 v[212:215], v[28:31], v[132:135], v[212:215]
    ds_read_b64_tr_b16 v[104:105], v11 offset:12288
    v_sub_u32 v3, v3, v4
    v_mfma_f32_16x16x32_bf16 v[216:219], v[32:35], v[132:135], v[216:219]
    ds_read_b64_tr_b16 v[106:107], v11 offset:13056
    v_mul_u32_u24 v2, 1280, v2
    s_waitcnt lgkmcnt(4)
    v_mfma_f32_16x16x32_bf16 v[220:223], v[28:31], v[136:139], v[220:223]
    ds_read_b64_tr_b16 v[108:109], v10 offset:12352
    v_lshl_add_u32 v244, v3, 4, v2
    v_mfma_f32_16x16x32_bf16 v[224:227], v[32:35], v[136:139], v[224:227]
    ds_read_b64_tr_b16 v[110:111], v10 offset:13120
    v_add_u32_e64 v3, 64, v1
    v_mfma_f32_16x16x32_bf16 v[228:231], v[28:31], v[140:143], v[228:231]
    ds_read_b64_tr_b16 v[112:113], v11 offset:12352
    v_mul_u32_u24 v2, 5462, v3
    v_mfma_f32_16x16x32_bf16 v[232:235], v[32:35], v[140:143], v[232:235]
    ds_read_b64_tr_b16 v[114:115], v11 offset:13120
    v_lshrrev_b32_e64 v2, 16, v2
    v_mfma_f32_16x16x32_bf16 v[236:239], v[28:31], v[144:147], v[236:239]
    ds_read_b64_tr_b16 v[116:117], v10 offset:12416
    v_mul_u32_u24_e64 v4, 12, v2
    v_mfma_f32_16x16x32_bf16 v[240:243], v[32:35], v[144:147], v[240:243]
    ds_read_b64_tr_b16 v[118:119], v10 offset:13184
    v_sub_u32 v3, v3, v4
    ds_read_b64_tr_b16 v[120:121], v11 offset:12416
    ds_read_b64_tr_b16 v[122:123], v11 offset:13184
    s_waitcnt lgkmcnt(6)
    v_mfma_f32_16x16x32_bf16 v[148:151], v[36:39], v[100:103], v[148:151]
    ds_read_b64_tr_b16 v[124:125], v12 offset:12288
    v_mul_u32_u24 v2, 1280, v2
    v_mfma_f32_16x16x32_bf16 v[152:155], v[40:43], v[100:103], v[152:155]
    ds_read_b64_tr_b16 v[126:127], v12 offset:13056
    v_lshl_add_u32 v245, v3, 4, v2
    v_mfma_f32_16x16x32_bf16 v[156:159], v[36:39], v[104:107], v[156:159]
    ds_read_b64_tr_b16 v[128:129], v13 offset:12288
    v_add_u32 v3, 128, v1
    v_mfma_f32_16x16x32_bf16 v[160:163], v[40:43], v[104:107], v[160:163]
    ds_read_b64_tr_b16 v[130:131], v13 offset:13056
    v_mul_u32_u24 v2, 5462, v3
    v_mfma_f32_16x16x32_bf16 v[164:167], v[36:39], v[108:111], v[164:167]
    ds_read_b64_tr_b16 v[132:133], v12 offset:12352
    v_lshrrev_b32_e64 v2, 16, v2
    v_mfma_f32_16x16x32_bf16 v[168:171], v[40:43], v[108:111], v[168:171]
    ds_read_b64_tr_b16 v[134:135], v12 offset:13120
    v_mul_u32_u24 v4, 12, v2
    s_waitcnt lgkmcnt(6)
    v_mfma_f32_16x16x32_bf16 v[172:175], v[36:39], v[112:115], v[172:175]
    ds_read_b64_tr_b16 v[136:137], v13 offset:12352
    v_sub_u32 v3, v3, v4
    v_mfma_f32_16x16x32_bf16 v[176:179], v[40:43], v[112:115], v[176:179]
    ds_read_b64_tr_b16 v[138:139], v13 offset:13120
    v_mul_u32_u24 v2, 1280, v2
    v_mfma_f32_16x16x32_bf16 v[180:183], v[36:39], v[116:119], v[180:183]
    ds_read_b64_tr_b16 v[140:141], v12 offset:12416
    v_lshl_add_u32 v246, v3, 4, v2
    v_mfma_f32_16x16x32_bf16 v[184:187], v[40:43], v[116:119], v[184:187]
    ds_read_b64_tr_b16 v[142:143], v12 offset:13184
    v_mfma_f32_16x16x32_bf16 v[188:191], v[36:39], v[120:123], v[188:191]
    ds_read_b64_tr_b16 v[144:145], v13 offset:12416
    v_mfma_f32_16x16x32_bf16 v[192:195], v[40:43], v[120:123], v[192:195]
    ds_read_b64_tr_b16 v[146:147], v13 offset:13184
    s_waitcnt lgkmcnt(6)
    v_mfma_f32_16x16x32_bf16 v[196:199], v[36:39], v[124:127], v[196:199]
    ds_read_b64_tr_b16 v[100:101], v10 offset:18432
    v_mfma_f32_16x16x32_bf16 v[200:203], v[40:43], v[124:127], v[200:203]
    ds_read_b64_tr_b16 v[102:103], v10 offset:19200
    v_mfma_f32_16x16x32_bf16 v[204:207], v[36:39], v[128:131], v[204:207]
    ds_read_b64_tr_b16 v[104:105], v11 offset:18432
    v_mfma_f32_16x16x32_bf16 v[208:211], v[40:43], v[128:131], v[208:211]
    ds_read_b64_tr_b16 v[106:107], v11 offset:19200
    v_mfma_f32_16x16x32_bf16 v[212:215], v[36:39], v[132:135], v[212:215]
    ds_read_b64_tr_b16 v[108:109], v10 offset:18496
    v_mfma_f32_16x16x32_bf16 v[216:219], v[40:43], v[132:135], v[216:219]
    ds_read_b64_tr_b16 v[110:111], v10 offset:19264
    s_waitcnt lgkmcnt(6)
    v_mfma_f32_16x16x32_bf16 v[220:223], v[36:39], v[136:139], v[220:223]
    ds_read_b64_tr_b16 v[112:113], v11 offset:18496
    v_mfma_f32_16x16x32_bf16 v[224:227], v[40:43], v[136:139], v[224:227]
    ds_read_b64_tr_b16 v[114:115], v11 offset:19264
    v_mfma_f32_16x16x32_bf16 v[228:231], v[36:39], v[140:143], v[228:231]
    ds_read_b64_tr_b16 v[116:117], v10 offset:18560
    v_mfma_f32_16x16x32_bf16 v[232:235], v[40:43], v[140:143], v[232:235]
    ds_read_b64_tr_b16 v[118:119], v10 offset:19328
    v_mfma_f32_16x16x32_bf16 v[236:239], v[36:39], v[144:147], v[236:239]
    ds_read_b64_tr_b16 v[120:121], v11 offset:18560
    v_mfma_f32_16x16x32_bf16 v[240:243], v[40:43], v[144:147], v[240:243]
    ds_read_b64_tr_b16 v[122:123], v11 offset:19328
    s_waitcnt lgkmcnt(6)
    v_mfma_f32_16x16x32_bf16 v[148:151], v[44:47], v[100:103], v[148:151]
    ds_read_b64_tr_b16 v[124:125], v12 offset:18432
    v_mfma_f32_16x16x32_bf16 v[152:155], v[48:51], v[100:103], v[152:155]
    ds_read_b64_tr_b16 v[126:127], v12 offset:19200
    v_mfma_f32_16x16x32_bf16 v[156:159], v[44:47], v[104:107], v[156:159]
    ds_read_b64_tr_b16 v[128:129], v13 offset:18432
    v_mfma_f32_16x16x32_bf16 v[160:163], v[48:51], v[104:107], v[160:163]
    ds_read_b64_tr_b16 v[130:131], v13 offset:19200
    v_mfma_f32_16x16x32_bf16 v[164:167], v[44:47], v[108:111], v[164:167]
    ds_read_b64_tr_b16 v[132:133], v12 offset:18496
    v_mfma_f32_16x16x32_bf16 v[168:171], v[48:51], v[108:111], v[168:171]
    ds_read_b64_tr_b16 v[134:135], v12 offset:19264
    s_waitcnt lgkmcnt(6)
    v_mfma_f32_16x16x32_bf16 v[172:175], v[44:47], v[112:115], v[172:175]
    ds_read_b64_tr_b16 v[136:137], v13 offset:18496
    v_mfma_f32_16x16x32_bf16 v[176:179], v[48:51], v[112:115], v[176:179]
    ds_read_b64_tr_b16 v[138:139], v13 offset:19264
    v_mfma_f32_16x16x32_bf16 v[180:183], v[44:47], v[116:119], v[180:183]
    ds_read_b64_tr_b16 v[140:141], v12 offset:18560
    v_mfma_f32_16x16x32_bf16 v[184:187], v[48:51], v[116:119], v[184:187]
    ds_read_b64_tr_b16 v[142:143], v12 offset:19328
    v_mfma_f32_16x16x32_bf16 v[188:191], v[44:47], v[120:123], v[188:191]
    ds_read_b64_tr_b16 v[144:145], v13 offset:18560
    v_mfma_f32_16x16x32_bf16 v[192:195], v[48:51], v[120:123], v[192:195]
    ds_read_b64_tr_b16 v[146:147], v13 offset:19328
    s_waitcnt lgkmcnt(6)
    v_mfma_f32_16x16x32_bf16 v[196:199], v[44:47], v[124:127], v[196:199]
    s_lshr_b32 s36, s51, 3
    s_and_b32 s37, s51, 7
    s_mul_i32 s38, s36, 192
    s_mul_i32 s39, s28, 48
    s_add_u32 s38, s38, s39
    s_mul_i32 s38, s38, 1280
    v_mfma_f32_16x16x32_bf16 v[200:203], v[48:51], v[124:127], v[200:203]
    s_mul_i32 s48, s37, 160
    s_and_b32 s49, s48, 63
    s_sub_u32 s48, s48, s49
    s_add_u32 s38, s38, s48
    s_mul_i32 s39, s28, 9216
    s_add_u32 s39, s39, 122880
    s_waitcnt vmcnt(6)
    s_barrier
    v_mfma_f32_16x16x32_bf16 v[204:207], v[44:47], v[128:131], v[204:207]
    ds_read_b64_tr_b16 v[100:101], v10 offset:24576
    s_add_u32 m0, s41, 49152
    v_mfma_f32_16x16x32_bf16 v[208:211], v[48:51], v[128:131], v[208:211]
    ds_read_b64_tr_b16 v[102:103], v10 offset:25344
    s_add_u32 s43, s42, 8
    v_mfma_f32_16x16x32_bf16 v[212:215], v[44:47], v[132:135], v[212:215]
    ds_read_b64_tr_b16 v[104:105], v11 offset:24576
    s_cmp_ge_u32 s43, 20
    v_mfma_f32_16x16x32_bf16 v[216:219], v[48:51], v[132:135], v[216:219]
    ds_read_b64_tr_b16 v[106:107], v11 offset:25344
    s_cselect_b32 s44, 20, 0
    s_waitcnt lgkmcnt(4)
    v_mfma_f32_16x16x32_bf16 v[220:223], v[44:47], v[136:139], v[220:223]
    ds_read_b64_tr_b16 v[108:109], v10 offset:24640
    s_sub_u32 s43, s43, s44
    v_mfma_f32_16x16x32_bf16 v[224:227], v[48:51], v[136:139], v[224:227]
    ds_read_b64_tr_b16 v[110:111], v10 offset:25408
    s_mul_i32 s43, s43, 98304
    v_mfma_f32_16x16x32_bf16 v[228:231], v[44:47], v[140:143], v[228:231]
    ds_read_b64_tr_b16 v[112:113], v11 offset:24640
    s_add_u32 s43, s43, s40
    v_mfma_f32_16x16x32_bf16 v[232:235], v[48:51], v[140:143], v[232:235]
    ds_read_b64_tr_b16 v[114:115], v11 offset:25408
    buffer_load_dwordx4 v14, s[24:27], s43 offen  lds
    v_mfma_f32_16x16x32_bf16 v[236:239], v[44:47], v[144:147], v[236:239]
    ds_read_b64_tr_b16 v[116:117], v10 offset:24704
    s_add_u32 m0, s41, 50176
    v_mfma_f32_16x16x32_bf16 v[240:243], v[48:51], v[144:147], v[240:243]
    ds_read_b64_tr_b16 v[118:119], v10 offset:25472
    ds_read_b64_tr_b16 v[120:121], v11 offset:24704
    ds_read_b64_tr_b16 v[122:123], v11 offset:25472
    s_waitcnt lgkmcnt(6)
    v_mfma_f32_16x16x32_bf16 v[148:151], v[52:55], v[100:103], v[148:151]
    ds_read_b64_tr_b16 v[124:125], v12 offset:24576
    v_mfma_f32_16x16x32_bf16 v[152:155], v[56:59], v[100:103], v[152:155]
    ds_read_b64_tr_b16 v[126:127], v12 offset:25344
    buffer_load_dwordx4 v15, s[24:27], s43 offen  lds
    v_mfma_f32_16x16x32_bf16 v[156:159], v[52:55], v[104:107], v[156:159]
    ds_read_b64_tr_b16 v[128:129], v13 offset:24576
    s_add_u32 m0, s41, 51200
    v_mfma_f32_16x16x32_bf16 v[160:163], v[56:59], v[104:107], v[160:163]
    ds_read_b64_tr_b16 v[130:131], v13 offset:25344
    v_mfma_f32_16x16x32_bf16 v[164:167], v[52:55], v[108:111], v[164:167]
    ds_read_b64_tr_b16 v[132:133], v12 offset:24640
    v_mfma_f32_16x16x32_bf16 v[168:171], v[56:59], v[108:111], v[168:171]
    ds_read_b64_tr_b16 v[134:135], v12 offset:25408
    buffer_load_dwordx4 v16, s[24:27], s43 offen  lds
    s_waitcnt lgkmcnt(6)
    v_mfma_f32_16x16x32_bf16 v[172:175], v[52:55], v[112:115], v[172:175]
    ds_read_b64_tr_b16 v[136:137], v13 offset:24640
    s_add_u32 m0, s41, 52224
    v_mfma_f32_16x16x32_bf16 v[176:179], v[56:59], v[112:115], v[176:179]
    ds_read_b64_tr_b16 v[138:139], v13 offset:25408
    s_add_u32 s43, s43, 49152
    v_mfma_f32_16x16x32_bf16 v[180:183], v[52:55], v[116:119], v[180:183]
    ds_read_b64_tr_b16 v[140:141], v12 offset:24704
    v_mfma_f32_16x16x32_bf16 v[184:187], v[56:59], v[116:119], v[184:187]
    ds_read_b64_tr_b16 v[142:143], v12 offset:25472
    buffer_load_dwordx4 v14, s[24:27], s43 offen  lds
    v_mfma_f32_16x16x32_bf16 v[188:191], v[52:55], v[120:123], v[188:191]
    ds_read_b64_tr_b16 v[144:145], v13 offset:24704
    s_add_u32 m0, s41, 53248
    v_mfma_f32_16x16x32_bf16 v[192:195], v[56:59], v[120:123], v[192:195]
    ds_read_b64_tr_b16 v[146:147], v13 offset:25472
    s_waitcnt lgkmcnt(6)
    v_mfma_f32_16x16x32_bf16 v[196:199], v[52:55], v[124:127], v[196:199]
    ds_read_b64_tr_b16 v[100:101], v10 offset:30720
    v_mfma_f32_16x16x32_bf16 v[200:203], v[56:59], v[124:127], v[200:203]
    ds_read_b64_tr_b16 v[102:103], v10 offset:31488
    buffer_load_dwordx4 v15, s[24:27], s43 offen  lds
    v_mfma_f32_16x16x32_bf16 v[204:207], v[52:55], v[128:131], v[204:207]
    ds_read_b64_tr_b16 v[104:105], v11 offset:30720
    s_add_u32 m0, s41, 54272
    v_mfma_f32_16x16x32_bf16 v[208:211], v[56:59], v[128:131], v[208:211]
    ds_read_b64_tr_b16 v[106:107], v11 offset:31488
    v_mfma_f32_16x16x32_bf16 v[212:215], v[52:55], v[132:135], v[212:215]
    ds_read_b64_tr_b16 v[108:109], v10 offset:30784
    v_mfma_f32_16x16x32_bf16 v[216:219], v[56:59], v[132:135], v[216:219]
    ds_read_b64_tr_b16 v[110:111], v10 offset:31552
    buffer_load_dwordx4 v16, s[24:27], s43 offen  lds
    s_waitcnt lgkmcnt(6)
    v_mfma_f32_16x16x32_bf16 v[220:223], v[52:55], v[136:139], v[220:223]
    ds_read_b64_tr_b16 v[112:113], v11 offset:30784
    s_add_u32 m0, s39, 0
    v_mfma_f32_16x16x32_bf16 v[224:227], v[56:59], v[136:139], v[224:227]
    ds_read_b64_tr_b16 v[114:115], v11 offset:31552
    v_mfma_f32_16x16x32_bf16 v[228:231], v[52:55], v[140:143], v[228:231]
    ds_read_b64_tr_b16 v[116:117], v10 offset:30848
    v_mfma_f32_16x16x32_bf16 v[232:235], v[56:59], v[140:143], v[232:235]
    ds_read_b64_tr_b16 v[118:119], v10 offset:31616
    buffer_load_dwordx4 v244, s[4:7], s38 offen  lds
    v_mfma_f32_16x16x32_bf16 v[236:239], v[52:55], v[144:147], v[236:239]
    ds_read_b64_tr_b16 v[120:121], v11 offset:30848
    s_add_u32 m0, s39, 1024
    v_mfma_f32_16x16x32_bf16 v[240:243], v[56:59], v[144:147], v[240:243]
    ds_read_b64_tr_b16 v[122:123], v11 offset:31616
    s_waitcnt lgkmcnt(6)
    v_mfma_f32_16x16x32_bf16 v[148:151], v[60:63], v[100:103], v[148:151]
    ds_read_b64_tr_b16 v[124:125], v12 offset:30720
    v_mfma_f32_16x16x32_bf16 v[152:155], v[64:67], v[100:103], v[152:155]
    ds_read_b64_tr_b16 v[126:127], v12 offset:31488
    buffer_load_dwordx4 v245, s[4:7], s38 offen  lds
    v_mfma_f32_16x16x32_bf16 v[156:159], v[60:63], v[104:107], v[156:159]
    ds_read_b64_tr_b16 v[128:129], v13 offset:30720
    s_add_u32 m0, s39, 2048
    v_mfma_f32_16x16x32_bf16 v[160:163], v[64:67], v[104:107], v[160:163]
    ds_read_b64_tr_b16 v[130:131], v13 offset:31488
    v_mfma_f32_16x16x32_bf16 v[164:167], v[60:63], v[108:111], v[164:167]
    ds_read_b64_tr_b16 v[132:133], v12 offset:30784
    v_mfma_f32_16x16x32_bf16 v[168:171], v[64:67], v[108:111], v[168:171]
    ds_read_b64_tr_b16 v[134:135], v12 offset:31552
    buffer_load_dwordx4 v246, s[4:7], s38 offen  lds
    s_waitcnt lgkmcnt(6)
    v_mfma_f32_16x16x32_bf16 v[172:175], v[60:63], v[112:115], v[172:175]
    ds_read_b64_tr_b16 v[136:137], v13 offset:30784
    s_add_u32 m0, s39, 3072
    v_mfma_f32_16x16x32_bf16 v[176:179], v[64:67], v[112:115], v[176:179]
    ds_read_b64_tr_b16 v[138:139], v13 offset:31552
    s_add_u32 s38, s38, 20480
    v_mfma_f32_16x16x32_bf16 v[180:183], v[60:63], v[116:119], v[180:183]
    ds_read_b64_tr_b16 v[140:141], v12 offset:30848
    v_mfma_f32_16x16x32_bf16 v[184:187], v[64:67], v[116:119], v[184:187]
    ds_read_b64_tr_b16 v[142:143], v12 offset:31616
    buffer_load_dwordx4 v244, s[4:7], s38 offen  lds
    v_mfma_f32_16x16x32_bf16 v[188:191], v[60:63], v[120:123], v[188:191]
    ds_read_b64_tr_b16 v[144:145], v13 offset:30848
    s_add_u32 m0, s39, 4096
    v_mfma_f32_16x16x32_bf16 v[192:195], v[64:67], v[120:123], v[192:195]
    ds_read_b64_tr_b16 v[146:147], v13 offset:31616
    s_waitcnt lgkmcnt(6)
    v_mfma_f32_16x16x32_bf16 v[196:199], v[60:63], v[124:127], v[196:199]
    v_mfma_f32_16x16x32_bf16 v[200:203], v[64:67], v[124:127], v[200:203]
    buffer_load_dwordx4 v245, s[4:7], s38 offen  lds
    s_add_u32 m0, s39, 5120
    s_waitcnt vmcnt(11)
    s_barrier
    v_mfma_f32_16x16x32_bf16 v[204:207], v[60:63], v[128:131], v[204:207]
    ds_read_b64_tr_b16 v[100:101], v10 offset:36864
    v_mfma_f32_16x16x32_bf16 v[208:211], v[64:67], v[128:131], v[208:211]
    ds_read_b64_tr_b16 v[102:103], v10 offset:37632
    v_mfma_f32_16x16x32_bf16 v[212:215], v[60:63], v[132:135], v[212:215]
    ds_read_b64_tr_b16 v[104:105], v11 offset:36864
    v_mfma_f32_16x16x32_bf16 v[216:219], v[64:67], v[132:135], v[216:219]
    ds_read_b64_tr_b16 v[106:107], v11 offset:37632
    buffer_load_dwordx4 v246, s[4:7], s38 offen  lds
    s_waitcnt lgkmcnt(4)
    v_mfma_f32_16x16x32_bf16 v[220:223], v[60:63], v[136:139], v[220:223]
    ds_read_b64_tr_b16 v[108:109], v10 offset:36928
    s_add_u32 m0, s39, 6144
    v_mfma_f32_16x16x32_bf16 v[224:227], v[64:67], v[136:139], v[224:227]
    ds_read_b64_tr_b16 v[110:111], v10 offset:37696
    s_add_u32 s38, s38, 20480
    v_mfma_f32_16x16x32_bf16 v[228:231], v[60:63], v[140:143], v[228:231]
    ds_read_b64_tr_b16 v[112:113], v11 offset:36928
    v_mfma_f32_16x16x32_bf16 v[232:235], v[64:67], v[140:143], v[232:235]
    ds_read_b64_tr_b16 v[114:115], v11 offset:37696
    buffer_load_dwordx4 v244, s[4:7], s38 offen  lds
    v_mfma_f32_16x16x32_bf16 v[236:239], v[60:63], v[144:147], v[236:239]
    ds_read_b64_tr_b16 v[116:117], v10 offset:36992
    s_add_u32 m0, s39, 7168
    v_mfma_f32_16x16x32_bf16 v[240:243], v[64:67], v[144:147], v[240:243]
    ds_read_b64_tr_b16 v[118:119], v10 offset:37760
    ds_read_b64_tr_b16 v[120:121], v11 offset:36992
    ds_read_b64_tr_b16 v[122:123], v11 offset:37760
    s_waitcnt lgkmcnt(6)
    v_mfma_f32_16x16x32_bf16 v[148:151], v[68:71], v[100:103], v[148:151]
    ds_read_b64_tr_b16 v[124:125], v12 offset:36864
    v_mfma_f32_16x16x32_bf16 v[152:155], v[72:75], v[100:103], v[152:155]
    ds_read_b64_tr_b16 v[126:127], v12 offset:37632
    buffer_load_dwordx4 v245, s[4:7], s38 offen  lds
    v_mfma_f32_16x16x32_bf16 v[156:159], v[68:71], v[104:107], v[156:159]
    ds_read_b64_tr_b16 v[128:129], v13 offset:36864
    s_add_u32 m0, s39, 8192
    v_mfma_f32_16x16x32_bf16 v[160:163], v[72:75], v[104:107], v[160:163]
    ds_read_b64_tr_b16 v[130:131], v13 offset:37632
    v_mfma_f32_16x16x32_bf16 v[164:167], v[68:71], v[108:111], v[164:167]
    ds_read_b64_tr_b16 v[132:133], v12 offset:36928
    v_mfma_f32_16x16x32_bf16 v[168:171], v[72:75], v[108:111], v[168:171]
    ds_read_b64_tr_b16 v[134:135], v12 offset:37696
    buffer_load_dwordx4 v246, s[4:7], s38 offen  lds
    s_waitcnt lgkmcnt(6)
    v_mfma_f32_16x16x32_bf16 v[172:175], v[68:71], v[112:115], v[172:175]
    ds_read_b64_tr_b16 v[136:137], v13 offset:36928
    v_mfma_f32_16x16x32_bf16 v[176:179], v[72:75], v[112:115], v[176:179]
    ds_read_b64_tr_b16 v[138:139], v13 offset:37696
    v_mfma_f32_16x16x32_bf16 v[180:183], v[68:71], v[116:119], v[180:183]
    ds_read_b64_tr_b16 v[140:141], v12 offset:36992
    v_mfma_f32_16x16x32_bf16 v[184:187], v[72:75], v[116:119], v[184:187]
    ds_read_b64_tr_b16 v[142:143], v12 offset:37760
    v_mfma_f32_16x16x32_bf16 v[188:191], v[68:71], v[120:123], v[188:191]
    ds_read_b64_tr_b16 v[144:145], v13 offset:36992
    v_mfma_f32_16x16x32_bf16 v[192:195], v[72:75], v[120:123], v[192:195]
    ds_read_b64_tr_b16 v[146:147], v13 offset:37760
    s_waitcnt lgkmcnt(6)
    v_mfma_f32_16x16x32_bf16 v[196:199], v[68:71], v[124:127], v[196:199]
    ds_read_b64_tr_b16 v[100:101], v10 offset:43008
    v_mfma_f32_16x16x32_bf16 v[200:203], v[72:75], v[124:127], v[200:203]
    ds_read_b64_tr_b16 v[102:103], v10 offset:43776
    v_mfma_f32_16x16x32_bf16 v[204:207], v[68:71], v[128:131], v[204:207]
    ds_read_b64_tr_b16 v[104:105], v11 offset:43008
    v_mfma_f32_16x16x32_bf16 v[208:211], v[72:75], v[128:131], v[208:211]
    ds_read_b64_tr_b16 v[106:107], v11 offset:43776
    v_mfma_f32_16x16x32_bf16 v[212:215], v[68:71], v[132:135], v[212:215]
    ds_read_b64_tr_b16 v[108:109], v10 offset:43072
    v_mfma_f32_16x16x32_bf16 v[216:219], v[72:75], v[132:135], v[216:219]
    ds_read_b64_tr_b16 v[110:111], v10 offset:43840
    s_waitcnt lgkmcnt(6)
    v_mfma_f32_16x16x32_bf16 v[220:223], v[68:71], v[136:139], v[220:223]
    ds_read_b64_tr_b16 v[112:113], v11 offset:43072
    v_mfma_f32_16x16x32_bf16 v[224:227], v[72:75], v[136:139], v[224:227]
    ds_read_b64_tr_b16 v[114:115], v11 offset:43840
    v_mfma_f32_16x16x32_bf16 v[228:231], v[68:71], v[140:143], v[228:231]
    ds_read_b64_tr_b16 v[116:117], v10 offset:43136
    v_mfma_f32_16x16x32_bf16 v[232:235], v[72:75], v[140:143], v[232:235]
    ds_read_b64_tr_b16 v[118:119], v10 offset:43904
    v_mfma_f32_16x16x32_bf16 v[236:239], v[68:71], v[144:147], v[236:239]
    ds_read_b64_tr_b16 v[120:121], v11 offset:43136
    v_mfma_f32_16x16x32_bf16 v[240:243], v[72:75], v[144:147], v[240:243]
    ds_read_b64_tr_b16 v[122:123], v11 offset:43904
    s_waitcnt lgkmcnt(6)
    v_mfma_f32_16x16x32_bf16 v[148:151], v[76:79], v[100:103], v[148:151]
    ds_read_b64_tr_b16 v[124:125], v12 offset:43008
    v_mfma_f32_16x16x32_bf16 v[152:155], v[80:83], v[100:103], v[152:155]
    ds_read_b64_tr_b16 v[126:127], v12 offset:43776
    v_mfma_f32_16x16x32_bf16 v[156:159], v[76:79], v[104:107], v[156:159]
    ds_read_b64_tr_b16 v[128:129], v13 offset:43008
    v_mfma_f32_16x16x32_bf16 v[160:163], v[80:83], v[104:107], v[160:163]
    ds_read_b64_tr_b16 v[130:131], v13 offset:43776
    v_mfma_f32_16x16x32_bf16 v[164:167], v[76:79], v[108:111], v[164:167]
    ds_read_b64_tr_b16 v[132:133], v12 offset:43072
    v_mfma_f32_16x16x32_bf16 v[168:171], v[80:83], v[108:111], v[168:171]
    ds_read_b64_tr_b16 v[134:135], v12 offset:43840
    s_waitcnt lgkmcnt(6)
    v_mfma_f32_16x16x32_bf16 v[172:175], v[76:79], v[112:115], v[172:175]
    ds_read_b64_tr_b16 v[136:137], v13 offset:43072
    v_mfma_f32_16x16x32_bf16 v[176:179], v[80:83], v[112:115], v[176:179]
    ds_read_b64_tr_b16 v[138:139], v13 offset:43840
    v_mfma_f32_16x16x32_bf16 v[180:183], v[76:79], v[116:119], v[180:183]
    ds_read_b64_tr_b16 v[140:141], v12 offset:43136
    v_mfma_f32_16x16x32_bf16 v[184:187], v[80:83], v[116:119], v[184:187]
    ds_read_b64_tr_b16 v[142:143], v12 offset:43904
    v_mfma_f32_16x16x32_bf16 v[188:191], v[76:79], v[120:123], v[188:191]
    ds_read_b64_tr_b16 v[144:145], v13 offset:43136
    v_mfma_f32_16x16x32_bf16 v[192:195], v[80:83], v[120:123], v[192:195]
    ds_read_b64_tr_b16 v[146:147], v13 offset:43904
    s_waitcnt lgkmcnt(6)
    v_mfma_f32_16x16x32_bf16 v[196:199], v[76:79], v[124:127], v[196:199]
    s_mul_i32 s12, s29, 122880
    s_lshl_b32 s13, s30, 2
    s_add_u32 s13, s13, s28
    v_mfma_f32_16x16x32_bf16 v[200:203], v[80:83], v[124:127], v[200:203]
    s_lshl_b32 s13, s13, 10
    s_add_u32 s12, s12, s13
    s_add_u32 s12, s12, 3145728
    s_waitcnt vmcnt(9)
    s_barrier
    v_mfma_f32_16x16x32_bf16 v[204:207], v[76:79], v[128:131], v[204:207]
    ds_read_b64_tr_b16 v[100:101], v10 offset:49152
    v_lshlrev_b32 v17, 4, v1
    v_mfma_f32_16x16x32_bf16 v[208:211], v[80:83], v[128:131], v[208:211]
    ds_read_b64_tr_b16 v[102:103], v10 offset:49920
    v_mov_b32 v18, 0
    v_mfma_f32_16x16x32_bf16 v[212:215], v[76:79], v[132:135], v[212:215]
    ds_read_b64_tr_b16 v[104:105], v11 offset:49152
    global_load_dwordx2 v[18:19], v18, s[62:63] sc1
    v_mfma_f32_16x16x32_bf16 v[216:219], v[80:83], v[132:135], v[216:219]
    ds_read_b64_tr_b16 v[106:107], v11 offset:49920
    s_waitcnt lgkmcnt(4)
    v_mfma_f32_16x16x32_bf16 v[220:223], v[76:79], v[136:139], v[220:223]
    ds_read_b64_tr_b16 v[108:109], v10 offset:49216
    v_mfma_f32_16x16x32_bf16 v[224:227], v[80:83], v[136:139], v[224:227]
    ds_read_b64_tr_b16 v[110:111], v10 offset:49984
    v_mfma_f32_16x16x32_bf16 v[228:231], v[76:79], v[140:143], v[228:231]
    ds_read_b64_tr_b16 v[112:113], v11 offset:49216
    v_mfma_f32_16x16x32_bf16 v[232:235], v[80:83], v[140:143], v[232:235]
    ds_read_b64_tr_b16 v[114:115], v11 offset:49984
    v_mfma_f32_16x16x32_bf16 v[236:239], v[76:79], v[144:147], v[236:239]
    ds_read_b64_tr_b16 v[116:117], v10 offset:49280
    v_mfma_f32_16x16x32_bf16 v[240:243], v[80:83], v[144:147], v[240:243]
    ds_read_b64_tr_b16 v[118:119], v10 offset:50048
    ds_read_b64_tr_b16 v[120:121], v11 offset:49280
    ds_read_b64_tr_b16 v[122:123], v11 offset:50048
    s_waitcnt lgkmcnt(6)
    v_mfma_f32_16x16x32_bf16 v[148:151], v[84:87], v[100:103], v[148:151]
    ds_read_b64_tr_b16 v[124:125], v12 offset:49152
    v_mfma_f32_16x16x32_bf16 v[152:155], v[88:91], v[100:103], v[152:155]
    ds_read_b64_tr_b16 v[126:127], v12 offset:49920
    v_mfma_f32_16x16x32_bf16 v[156:159], v[84:87], v[104:107], v[156:159]
    ds_read_b64_tr_b16 v[128:129], v13 offset:49152
    v_mfma_f32_16x16x32_bf16 v[160:163], v[88:91], v[104:107], v[160:163]
    ds_read_b64_tr_b16 v[130:131], v13 offset:49920
    v_mfma_f32_16x16x32_bf16 v[164:167], v[84:87], v[108:111], v[164:167]
    ds_read_b64_tr_b16 v[132:133], v12 offset:49216
    v_mfma_f32_16x16x32_bf16 v[168:171], v[88:91], v[108:111], v[168:171]
    ds_read_b64_tr_b16 v[134:135], v12 offset:49984
    s_waitcnt lgkmcnt(6)
    v_mfma_f32_16x16x32_bf16 v[172:175], v[84:87], v[112:115], v[172:175]
    ds_read_b64_tr_b16 v[136:137], v13 offset:49216
    v_mfma_f32_16x16x32_bf16 v[176:179], v[88:91], v[112:115], v[176:179]
    ds_read_b64_tr_b16 v[138:139], v13 offset:49984
    v_mfma_f32_16x16x32_bf16 v[180:183], v[84:87], v[116:119], v[180:183]
    ds_read_b64_tr_b16 v[140:141], v12 offset:49280
    v_mfma_f32_16x16x32_bf16 v[184:187], v[88:91], v[116:119], v[184:187]
    ds_read_b64_tr_b16 v[142:143], v12 offset:50048
    v_mfma_f32_16x16x32_bf16 v[188:191], v[84:87], v[120:123], v[188:191]
    ds_read_b64_tr_b16 v[144:145], v13 offset:49280
    v_mfma_f32_16x16x32_bf16 v[192:195], v[88:91], v[120:123], v[192:195]
    ds_read_b64_tr_b16 v[146:147], v13 offset:50048
    s_waitcnt lgkmcnt(6)
    v_mfma_f32_16x16x32_bf16 v[196:199], v[84:87], v[124:127], v[196:199]
    ds_read_b64_tr_b16 v[100:101], v10 offset:55296
    v_mfma_f32_16x16x32_bf16 v[200:203], v[88:91], v[124:127], v[200:203]
    ds_read_b64_tr_b16 v[102:103], v10 offset:56064
    v_mfma_f32_16x16x32_bf16 v[204:207], v[84:87], v[128:131], v[204:207]
    ds_read_b64_tr_b16 v[104:105], v11 offset:55296
    v_mfma_f32_16x16x32_bf16 v[208:211], v[88:91], v[128:131], v[208:211]
    ds_read_b64_tr_b16 v[106:107], v11 offset:56064
    v_mfma_f32_16x16x32_bf16 v[212:215], v[84:87], v[132:135], v[212:215]
    ds_read_b64_tr_b16 v[108:109], v10 offset:55360
    v_mfma_f32_16x16x32_bf16 v[216:219], v[88:91], v[132:135], v[216:219]
    ds_read_b64_tr_b16 v[110:111], v10 offset:56128
    s_waitcnt lgkmcnt(6)
    v_mfma_f32_16x16x32_bf16 v[220:223], v[84:87], v[136:139], v[220:223]
    ds_read_b64_tr_b16 v[112:113], v11 offset:55360
    v_mfma_f32_16x16x32_bf16 v[224:227], v[88:91], v[136:139], v[224:227]
    ds_read_b64_tr_b16 v[114:115], v11 offset:56128
    v_mfma_f32_16x16x32_bf16 v[228:231], v[84:87], v[140:143], v[228:231]
    ds_read_b64_tr_b16 v[116:117], v10 offset:55424
    v_mfma_f32_16x16x32_bf16 v[232:235], v[88:91], v[140:143], v[232:235]
    ds_read_b64_tr_b16 v[118:119], v10 offset:56192
    v_mfma_f32_16x16x32_bf16 v[236:239], v[84:87], v[144:147], v[236:239]
    ds_read_b64_tr_b16 v[120:121], v11 offset:55424
    v_mfma_f32_16x16x32_bf16 v[240:243], v[88:91], v[144:147], v[240:243]
    ds_read_b64_tr_b16 v[122:123], v11 offset:56192
    s_waitcnt lgkmcnt(6)
    v_mfma_f32_16x16x32_bf16 v[148:151], v[92:95], v[100:103], v[148:151]
    ds_read_b64_tr_b16 v[124:125], v12 offset:55296
    v_mfma_f32_16x16x32_bf16 v[152:155], v[96:99], v[100:103], v[152:155]
    ds_read_b64_tr_b16 v[126:127], v12 offset:56064
    v_mfma_f32_16x16x32_bf16 v[156:159], v[92:95], v[104:107], v[156:159]
    ds_read_b64_tr_b16 v[128:129], v13 offset:55296
    v_mfma_f32_16x16x32_bf16 v[160:163], v[96:99], v[104:107], v[160:163]
    ds_read_b64_tr_b16 v[130:131], v13 offset:56064
    v_mfma_f32_16x16x32_bf16 v[164:167], v[92:95], v[108:111], v[164:167]
    ds_read_b64_tr_b16 v[132:133], v12 offset:55360
    v_mfma_f32_16x16x32_bf16 v[168:171], v[96:99], v[108:111], v[168:171]
    ds_read_b64_tr_b16 v[134:135], v12 offset:56128
    s_waitcnt lgkmcnt(6)
    v_mfma_f32_16x16x32_bf16 v[172:175], v[92:95], v[112:115], v[172:175]
    ds_read_b64_tr_b16 v[136:137], v13 offset:55360
    v_mfma_f32_16x16x32_bf16 v[176:179], v[96:99], v[112:115], v[176:179]
    ds_read_b64_tr_b16 v[138:139], v13 offset:56128
    v_mfma_f32_16x16x32_bf16 v[180:183], v[92:95], v[116:119], v[180:183]
    ds_read_b64_tr_b16 v[140:141], v12 offset:55424
    v_mfma_f32_16x16x32_bf16 v[184:187], v[96:99], v[116:119], v[184:187]
    ds_read_b64_tr_b16 v[142:143], v12 offset:56192
    v_mfma_f32_16x16x32_bf16 v[188:191], v[92:95], v[120:123], v[188:191]
    ds_read_b64_tr_b16 v[144:145], v13 offset:55424
    v_mfma_f32_16x16x32_bf16 v[192:195], v[96:99], v[120:123], v[192:195]
    ds_read_b64_tr_b16 v[146:147], v13 offset:56192
    s_waitcnt lgkmcnt(6)
    v_mfma_f32_16x16x32_bf16 v[196:199], v[92:95], v[124:127], v[196:199]
    v_mfma_f32_16x16x32_bf16 v[200:203], v[96:99], v[124:127], v[200:203]
    v_mfma_f32_16x16x32_bf16 v[204:207], v[92:95], v[128:131], v[204:207]
    v_mfma_f32_16x16x32_bf16 v[208:211], v[96:99], v[128:131], v[208:211]
    v_mfma_f32_16x16x32_bf16 v[212:215], v[92:95], v[132:135], v[212:215]
    v_mfma_f32_16x16x32_bf16 v[216:219], v[96:99], v[132:135], v[216:219]
    s_waitcnt lgkmcnt(0)
    v_mfma_f32_16x16x32_bf16 v[220:223], v[92:95], v[136:139], v[220:223]
    v_mfma_f32_16x16x32_bf16 v[224:227], v[96:99], v[136:139], v[224:227]
    v_mfma_f32_16x16x32_bf16 v[228:231], v[92:95], v[140:143], v[228:231]
    v_mfma_f32_16x16x32_bf16 v[232:235], v[96:99], v[140:143], v[232:235]
    v_mfma_f32_16x16x32_bf16 v[236:239], v[92:95], v[144:147], v[236:239]
    v_mfma_f32_16x16x32_bf16 v[240:243], v[96:99], v[144:147], v[240:243]
    v_pk_fma_f32 v[148:149], v[196:197], s[46:47], v[148:149]
    v_cvt_pk_bf16_f32 v100, v148, v149
    v_pk_fma_f32 v[150:151], v[198:199], s[46:47], v[150:151]
    v_cvt_pk_bf16_f32 v101, v150, v151
    v_pk_fma_f32 v[152:153], v[200:201], s[46:47], v[152:153]
    v_cvt_pk_bf16_f32 v102, v152, v153
    v_pk_fma_f32 v[154:155], v[202:203], s[46:47], v[154:155]
    v_cvt_pk_bf16_f32 v103, v154, v155
    buffer_store_dwordx4 v[100:103], v17, s[20:23], s12 offen sc1
    s_add_u32 s12, s12, 20480
    v_pk_fma_f32 v[156:157], v[204:205], s[46:47], v[156:157]
    v_cvt_pk_bf16_f32 v104, v156, v157
    v_pk_fma_f32 v[158:159], v[206:207], s[46:47], v[158:159]
    v_cvt_pk_bf16_f32 v105, v158, v159
    v_pk_fma_f32 v[160:161], v[208:209], s[46:47], v[160:161]
    v_cvt_pk_bf16_f32 v106, v160, v161
    v_pk_fma_f32 v[162:163], v[210:211], s[46:47], v[162:163]
    v_cvt_pk_bf16_f32 v107, v162, v163
    buffer_store_dwordx4 v[104:107], v17, s[20:23], s12 offen sc1
    s_add_u32 s12, s12, 20480
    v_pk_fma_f32 v[164:165], v[212:213], s[46:47], v[164:165]
    v_cvt_pk_bf16_f32 v108, v164, v165
    v_pk_fma_f32 v[166:167], v[214:215], s[46:47], v[166:167]
    v_cvt_pk_bf16_f32 v109, v166, v167
    v_pk_fma_f32 v[168:169], v[216:217], s[46:47], v[168:169]
    v_cvt_pk_bf16_f32 v110, v168, v169
    v_pk_fma_f32 v[170:171], v[218:219], s[46:47], v[170:171]
    v_cvt_pk_bf16_f32 v111, v170, v171
    buffer_store_dwordx4 v[108:111], v17, s[20:23], s12 offen sc1
    s_add_u32 s12, s12, 20480
    v_pk_fma_f32 v[172:173], v[220:221], s[46:47], v[172:173]
    v_cvt_pk_bf16_f32 v112, v172, v173
    v_pk_fma_f32 v[174:175], v[222:223], s[46:47], v[174:175]
    v_cvt_pk_bf16_f32 v113, v174, v175
    v_pk_fma_f32 v[176:177], v[224:225], s[46:47], v[176:177]
    v_cvt_pk_bf16_f32 v114, v176, v177
    v_pk_fma_f32 v[178:179], v[226:227], s[46:47], v[178:179]
    v_cvt_pk_bf16_f32 v115, v178, v179
    buffer_store_dwordx4 v[112:115], v17, s[20:23], s12 offen sc1
    s_add_u32 s12, s12, 20480
    v_pk_fma_f32 v[180:181], v[228:229], s[46:47], v[180:181]
    v_cvt_pk_bf16_f32 v116, v180, v181
    v_pk_fma_f32 v[182:183], v[230:231], s[46:47], v[182:183]
    v_cvt_pk_bf16_f32 v117, v182, v183
    v_pk_fma_f32 v[184:185], v[232:233], s[46:47], v[184:185]
    v_cvt_pk_bf16_f32 v118, v184, v185
    v_pk_fma_f32 v[186:187], v[234:235], s[46:47], v[186:187]
    v_cvt_pk_bf16_f32 v119, v186, v187
    buffer_store_dwordx4 v[116:119], v17, s[20:23], s12 offen sc1
    s_add_u32 s12, s12, 20480
    v_pk_fma_f32 v[188:189], v[236:237], s[46:47], v[188:189]
    v_cvt_pk_bf16_f32 v120, v188, v189
    v_pk_fma_f32 v[190:191], v[238:239], s[46:47], v[190:191]
    v_cvt_pk_bf16_f32 v121, v190, v191
    v_pk_fma_f32 v[192:193], v[240:241], s[46:47], v[192:193]
    v_cvt_pk_bf16_f32 v122, v192, v193
    v_pk_fma_f32 v[194:195], v[242:243], s[46:47], v[194:195]
    v_cvt_pk_bf16_f32 v123, v194, v195
    buffer_store_dwordx4 v[120:123], v17, s[20:23], s12 offen sc1
    s_add_u32 s12, s12, 20480
    s_bfe_u32 s29, s2, 0x20001
    s_lshl_b32 s29, s29, 3
    s_lshr_b32 s32, s2, 5
    s_add_u32 s29, s29, s32
    s_and_b32 s30, s2, 1
    s_lshl_b32 s30, s30, 2
    s_bfe_u32 s32, s2, 0x20003
    s_add_u32 s30, s30, s32
    v_bfe_u32 v2, v1, 2, 2
    v_and_b32_e64 v3, 3, v1
    v_lshl_add_u32 v2, v2, 3, v3
    s_mul_i32 s32, s30, 80
    v_add_u32_e64 v2, s32, v2
    v_and_b32 v3, 15, v1
    v_add_u32 v3, s32, v3
    s_movk_i32 s9, 320
    v_add_u32 v4, 0, v2
    v_subrev_u32 v5, 640, v4
    v_cmp_le_u32 vcc, s9, v4
    s_nop 0
    s_nop 0
    v_cndmask_b32 v4, v4, v5, vcc
    v_cvt_f32_i32 v4, v4
    v_mul_f32 v0, 0x3acccccd, v4
    v_add_u32 v4, 4, v2
    v_subrev_u32 v5, 640, v4
    v_cmp_le_u32 vcc, s9, v4
    s_nop 0
    s_nop 0
    v_cndmask_b32 v4, v4, v5, vcc
    v_cvt_f32_i32 v4, v4
    v_mul_f32 v252, 0x3acccccd, v4
    v_add_u32 v4, 32, v2
    v_subrev_u32 v5, 640, v4
    v_cmp_le_u32 vcc, s9, v4
    s_nop 0
    s_nop 0
    v_cndmask_b32 v4, v4, v5, vcc
    v_cvt_f32_i32 v4, v4
    v_mul_f32 v253, 0x3acccccd, v4
    v_add_u32 v4, 36, v2
    v_subrev_u32 v5, 640, v4
    v_cmp_le_u32 vcc, s9, v4
    s_nop 0
    s_nop 0
    v_cndmask_b32 v4, v4, v5, vcc
    v_cvt_f32_i32 v4, v4
    v_mul_f32 v254, 0x3acccccd, v4
    v_add_u32 v4, 64, v3
    v_subrev_u32 v5, 640, v4
    v_cmp_le_u32 vcc, s9, v4
    s_nop 0
    s_nop 0
    v_cndmask_b32 v4, v4, v5, vcc
    v_cvt_f32_i32 v4, v4
    v_mul_f32 v255, 0x3acccccd, v4
    v_lshrrev_b32 v2, 4, v1
    s_cmp_eq_u32 s28, 3
    s_cselect_b32 s9, 3, 4
    v_cmp_eq_u32 s[48:49], s9, v2
    s_mul_i32 s31, s28, 5
    s_waitcnt vmcnt(6)
kv_n0:
    v_readfirstlane_b32 s10, v18
    v_readfirstlane_b32 s11, v19
    s_add_u32 s32, s10, 1000
    s_addc_u32 s33, s11, 0
    s_sub_u32 s32, s32, s94
    s_subb_u32 s33, s33, s95
    s_cmp_ge_i32 s33, 0
    s_cbranch_scc0 kv_n2
kv_n1:
    s_lshl_b32 s32, s2, 4
    s_add_u32 s32, s32, s28
    s_lshl_b32 s32, s32, 3
    s_add_u32 s32, s32, 19136512
    v_mov_b32 v14, s10
    v_mov_b32 v15, s11
    v_mov_b32 v16, 0
    s_waitcnt vmcnt(0)
    buffer_store_dwordx2 v[14:15], v16, s[20:23], s32 offen sc1
    s_barrier
    s_branch kf_np2
kf_spare:
    s_and_b32 s32, s2, 7
    s_lshl_b32 s33, s32, 8
    s_bfe_u32 s34, s2, 0x10003
    s_lshl_b32 s35, s34, 7
    s_add_u32 s33, s33, s35
    s_lshl_b32 s35, s28, 5
    s_add_u32 s33, s33, s35
    s_mul_i32 s33, s33, 1280
    v_lshrrev_b32 v2, 4, v1
    v_mul_u32_u24 v3, 1280, v2
    v_and_b32 v4, 15, v1
    v_lshl_add_u32 v10, v4, 4, v3
    s_lshl_b32 s34, s34, 2
    s_add_u32 s34, s34, s28
    s_lshl_b32 s36, s32, 9
    s_lshl_b32 s35, s34, 4
    s_add_u32 s36, s36, s35
    s_add_u32 s36, s36, 2621440
    s_lshl_b32 s37, s32, 10
    s_lshl_b32 s35, s34, 5
    s_add_u32 s37, s37, s35
    s_add_u32 s37, s37, 2629632
    v_lshlrev_b32 v11, 2, v2
    s_mov_b32 s38, 0x3f803f80
    s_waitcnt lgkmcnt(0)
    s_mov_b32 s16, s4
    s_and_b32 s17, s5, 0xffff
    s_mov_b32 s18, 2621440
    s_mov_b32 s19, 0x20000
    s_mov_b32 s20, s14
    s_and_b32 s21, s15, 0xffff
    s_mov_b32 s22, 19398656
    s_mov_b32 s23, 0x20000
    buffer_load_dwordx4 v[84:87], v10, s[16:19], s33 offen offset:0
    buffer_load_dwordx4 v[88:91], v10, s[16:19], s33 offen offset:256
    buffer_load_dwordx4 v[92:95], v10, s[16:19], s33 offen offset:512
    buffer_load_dwordx4 v[96:99], v10, s[16:19], s33 offen offset:768
    buffer_load_dwordx4 v[100:103], v10, s[16:19], s33 offen offset:1024
    s_add_u32 s33, s33, 5120
    buffer_load_dwordx4 v[104:107], v10, s[16:19], s33 offen offset:0
    buffer_load_dwordx4 v[108:111], v10, s[16:19], s33 offen offset:256
    buffer_load_dwordx4 v[112:115], v10, s[16:19], s33 offen offset:512
    buffer_load_dwordx4 v[116:119], v10, s[16:19], s33 offen offset:768
    buffer_load_dwordx4 v[120:123], v10, s[16:19], s33 offen offset:1024
    s_add_u32 s33, s33, 5120
    buffer_load_dwordx4 v[124:127], v10, s[16:19], s33 offen offset:0
    buffer_load_dwordx4 v[128:131], v10, s[16:19], s33 offen offset:256
    v_mov_b32 v18, 0
    global_load_dwordx2 v[18:19], v18, s[62:63] sc1
    s_mov_b32 s42, 0x00010001
    s_mov_b32 s43, 0x00010001
    s_waitcnt vmcnt(8)
    v_dot2_f32_bf16 v4, v84, v84, 0
    buffer_load_dwordx4 v[132:135], v10, s[16:19], s33 offen offset:512
    v_dot2_f32_bf16 v6, v84, s38, 0
    v_dot2_f32_bf16 v5, v85, v85, 0
    v_dot2_f32_bf16 v7, v85, s38, 0
    v_dot2_f32_bf16 v4, v86, v86, v4
    v_dot2_f32_bf16 v6, v86, s38, v6
    v_dot2_f32_bf16 v5, v87, v87, v5
    v_dot2_f32_bf16 v7, v87, s38, v7
    buffer_load_dwordx4 v[136:139], v10, s[16:19], s33 offen offset:768
    v_dot2_f32_bf16 v4, v88, v88, v4
    v_dot2_f32_bf16 v6, v88, s38, v6
    v_dot2_f32_bf16 v5, v89, v89, v5
    v_dot2_f32_bf16 v7, v89, s38, v7
    v_dot2_f32_bf16 v4, v90, v90, v4
    v_dot2_f32_bf16 v6, v90, s38, v6
    v_dot2_f32_bf16 v5, v91, v91, v5
    buffer_load_dwordx4 v[140:143], v10, s[16:19], s33 offen offset:1024
    v_dot2_f32_bf16 v7, v91, s38, v7
    v_dot2_f32_bf16 v4, v92, v92, v4
    v_dot2_f32_bf16 v6, v92, s38, v6
    v_dot2_f32_bf16 v5, v93, v93, v5
    v_dot2_f32_bf16 v7, v93, s38, v7
    v_dot2_f32_bf16 v4, v94, v94, v4
    v_dot2_f32_bf16 v6, v94, s38, v6
    s_add_u32 s33, s33, 5120
    buffer_load_dwordx4 v[144:147], v10, s[16:19], s33 offen offset:0
    v_dot2_f32_bf16 v5, v95, v95, v5
    v_dot2_f32_bf16 v7, v95, s38, v7
    v_dot2_f32_bf16 v4, v96, v96, v4
    v_dot2_f32_bf16 v6, v96, s38, v6
    v_dot2_f32_bf16 v5, v97, v97, v5
    v_dot2_f32_bf16 v7, v97, s38, v7
    v_dot2_f32_bf16 v4, v98, v98, v4
    buffer_load_dwordx4 v[148:151], v10, s[16:19], s33 offen offset:256
    v_dot2_f32_bf16 v6, v98, s38, v6
    v_dot2_f32_bf16 v5, v99, v99, v5
    v_dot2_f32_bf16 v7, v99, s38, v7
    v_dot2_f32_bf16 v4, v100, v100, v4
    v_dot2_f32_bf16 v6, v100, s38, v6
    v_dot2_f32_bf16 v5, v101, v101, v5
    v_dot2_f32_bf16 v7, v101, s38, v7
    v_dot2_f32_bf16 v4, v102, v102, v4
    v_dot2_f32_bf16 v6, v102, s38, v6
    v_dot2_f32_bf16 v5, v103, v103, v5
    v_dot2_f32_bf16 v7, v103, s38, v7
    s_nop 1
    v_add_f32 v4, v4, v5
    v_add_f32 v5, v6, v7
    s_nop 0
    v_add_f32_dpp v4, v4, v4 row_ror:8 row_mask:0xf bank_mask:0xf
    v_add_f32_dpp v5, v5, v5 row_ror:8 row_mask:0xf bank_mask:0xf
    s_nop 0
    v_add_f32_dpp v4, v4, v4 row_ror:4 row_mask:0xf bank_mask:0xf
    v_add_f32_dpp v5, v5, v5 row_ror:4 row_mask:0xf bank_mask:0xf
    s_nop 0
    v_add_f32_dpp v4, v4, v4 row_ror:2 row_mask:0xf bank_mask:0xf
    v_add_f32_dpp v5, v5, v5 row_ror:2 row_mask:0xf bank_mask:0xf
    s_nop 0
    v_add_f32_dpp v4, v4, v4 row_ror:1 row_mask:0xf bank_mask:0xf
    v_add_f32_dpp v5, v5, v5 row_ror:1 row_mask:0xf bank_mask:0xf
    v_mov_b32 v8, v4
    v_mov_b32 v9, v5
    s_waitcnt vmcnt(8)
    v_dot2_f32_bf16 v4, v104, v104, 0
    buffer_load_dwordx4 v[152:155], v10, s[16:19], s33 offen offset:512
    v_dot2_f32_bf16 v6, v104, s38, 0
    v_dot2_f32_bf16 v5, v105, v105, 0
    v_dot2_f32_bf16 v7, v105, s38, 0
    v_dot2_f32_bf16 v4, v106, v106, v4
    v_dot2_f32_bf16 v6, v106, s38, v6
    v_dot2_f32_bf16 v5, v107, v107, v5
    v_dot2_f32_bf16 v7, v107, s38, v7
    buffer_load_dwordx4 v[156:159], v10, s[16:19], s33 offen offset:768
    v_dot2_f32_bf16 v4, v108, v108, v4
    v_dot2_f32_bf16 v6, v108, s38, v6
    v_dot2_f32_bf16 v5, v109, v109, v5
    v_dot2_f32_bf16 v7, v109, s38, v7
    v_dot2_f32_bf16 v4, v110, v110, v4
    v_dot2_f32_bf16 v6, v110, s38, v6
    v_dot2_f32_bf16 v5, v111, v111, v5
    buffer_load_dwordx4 v[160:163], v10, s[16:19], s33 offen offset:1024
    v_dot2_f32_bf16 v7, v111, s38, v7
    v_dot2_f32_bf16 v4, v112, v112, v4
    v_dot2_f32_bf16 v6, v112, s38, v6
    v_dot2_f32_bf16 v5, v113, v113, v5
    v_dot2_f32_bf16 v7, v113, s38, v7
    v_dot2_f32_bf16 v4, v114, v114, v4
    v_dot2_f32_bf16 v6, v114, s38, v6
    s_add_u32 s33, s33, 5120
    buffer_load_dwordx4 v[164:167], v10, s[16:19], s33 offen offset:0
    v_dot2_f32_bf16 v5, v115, v115, v5
    v_dot2_f32_bf16 v7, v115, s38, v7
    v_dot2_f32_bf16 v4, v116, v116, v4
    v_dot2_f32_bf16 v6, v116, s38, v6
    v_dot2_f32_bf16 v5, v117, v117, v5
    v_dot2_f32_bf16 v7, v117, s38, v7
    v_dot2_f32_bf16 v4, v118, v118, v4
    buffer_load_dwordx4 v[168:171], v10, s[16:19], s33 offen offset:256
    v_dot2_f32_bf16 v6, v118, s38, v6
    v_dot2_f32_bf16 v5, v119, v119, v5
    v_dot2_f32_bf16 v7, v119, s38, v7
    v_dot2_f32_bf16 v4, v120, v120, v4
    v_dot2_f32_bf16 v6, v120, s38, v6
    v_dot2_f32_bf16 v5, v121, v121, v5
    v_dot2_f32_bf16 v7, v121, s38, v7
    v_dot2_f32_bf16 v4, v122, v122, v4
    v_dot2_f32_bf16 v6, v122, s38, v6
    v_dot2_f32_bf16 v5, v123, v123, v5
    v_dot2_f32_bf16 v7, v123, s38, v7
    s_nop 1
    v_add_f32 v4, v4, v5
    v_add_f32_e64 v5, v6, v7
    s_nop 0
    v_add_f32_dpp v4, v4, v4 row_ror:8 row_mask:0xf bank_mask:0xf
    v_add_f32_dpp v5, v5, v5 row_ror:8 row_mask:0xf bank_mask:0xf
    s_nop 0
    v_add_f32_dpp v4, v4, v4 row_ror:4 row_mask:0xf bank_mask:0xf
    v_add_f32_dpp v5, v5, v5 row_ror:4 row_mask:0xf bank_mask:0xf
    s_nop 0
    v_add_f32_dpp v4, v4, v4 row_ror:2 row_mask:0xf bank_mask:0xf
    v_add_f32_dpp v5, v5, v5 row_ror:2 row_mask:0xf bank_mask:0xf
    s_nop 0
    v_add_f32_dpp v4, v4, v4 row_ror:1 row_mask:0xf bank_mask:0xf
    v_add_f32_dpp v5, v5, v5 row_ror:1 row_mask:0xf bank_mask:0xf
    s_lshl_b64 s[42:43], s[42:43], 1
    v_cndmask_b32 v8, v8, v4, s[42:43]
    v_cndmask_b32 v9, v9, v5, s[42:43]
    s_waitcnt vmcnt(7)
    v_dot2_f32_bf16 v4, v124, v124, 0
    buffer_load_dwordx4 v[172:175], v10, s[16:19], s33 offen offset:512
    v_dot2_f32_bf16 v6, v124, s38, 0
    v_dot2_f32_bf16 v5, v125, v125, 0
    v_dot2_f32_bf16 v7, v125, s38, 0
    v_dot2_f32_bf16 v4, v126, v126, v4
    v_dot2_f32_bf16 v6, v126, s38, v6
    v_dot2_f32_bf16 v5, v127, v127, v5
    v_dot2_f32_bf16 v7, v127, s38, v7
    buffer_load_dwordx4 v[176:179], v10, s[16:19], s33 offen offset:768
    v_dot2_f32_bf16 v4, v128, v128, v4
    v_dot2_f32_bf16 v6, v128, s38, v6
    v_dot2_f32_bf16 v5, v129, v129, v5
    v_dot2_f32_bf16 v7, v129, s38, v7
    v_dot2_f32_bf16 v4, v130, v130, v4
    v_dot2_f32_bf16 v6, v130, s38, v6
    v_dot2_f32_bf16 v5, v131, v131, v5
    buffer_load_dwordx4 v[180:183], v10, s[16:19], s33 offen offset:1024
    v_dot2_f32_bf16 v7, v131, s38, v7
    v_dot2_f32_bf16 v4, v132, v132, v4
    v_dot2_f32_bf16 v6, v132, s38, v6
    v_dot2_f32_bf16 v5, v133, v133, v5
    v_dot2_f32_bf16 v7, v133, s38, v7
    v_dot2_f32_bf16 v4, v134, v134, v4
    v_dot2_f32_bf16 v6, v134, s38, v6
    s_add_u32 s33, s33, 5120
    buffer_load_dwordx4 v[184:187], v10, s[16:19], s33 offen offset:0
    v_dot2_f32_bf16 v5, v135, v135, v5
    v_dot2_f32_bf16 v7, v135, s38, v7
    v_dot2_f32_bf16 v4, v136, v136, v4
    v_dot2_f32_bf16 v6, v136, s38, v6
    v_dot2_f32_bf16 v5, v137, v137, v5
    v_dot2_f32_bf16 v7, v137, s38, v7
    v_dot2_f32_bf16 v4, v138, v138, v4
    buffer_load_dwordx4 v[188:191], v10, s[16:19], s33 offen offset:256
    v_dot2_f32_bf16 v6, v138, s38, v6
    v_dot2_f32_bf16 v5, v139, v139, v5
    v_dot2_f32_bf16 v7, v139, s38, v7
    v_dot2_f32_bf16 v4, v140, v140, v4
    v_dot2_f32_bf16 v6, v140, s38, v6
    v_dot2_f32_bf16 v5, v141, v141, v5
    v_dot2_f32_bf16 v7, v141, s38, v7
    v_dot2_f32_bf16 v4, v142, v142, v4
    v_dot2_f32_bf16 v6, v142, s38, v6
    v_dot2_f32_bf16 v5, v143, v143, v5
    v_dot2_f32_bf16 v7, v143, s38, v7
    s_nop 1
    v_add_f32_e64 v4, v4, v5
    v_add_f32 v5, v6, v7
    s_nop 0
    v_add_f32_dpp v4, v4, v4 row_ror:8 row_mask:0xf bank_mask:0xf
    v_add_f32_dpp v5, v5, v5 row_ror:8 row_mask:0xf bank_mask:0xf
    s_nop 0
    v_add_f32_dpp v4, v4, v4 row_ror:4 row_mask:0xf bank_mask:0xf
    v_add_f32_dpp v5, v5, v5 row_ror:4 row_mask:0xf bank_mask:0xf
    s_nop 0
    v_add_f32_dpp v4, v4, v4 row_ror:2 row_mask:0xf bank_mask:0xf
    v_add_f32_dpp v5, v5, v5 row_ror:2 row_mask:0xf bank_mask:0xf
    s_nop 0
    v_add_f32_dpp v4, v4, v4 row_ror:1 row_mask:0xf bank_mask:0xf
    v_add_f32_dpp v5, v5, v5 row_ror:1 row_mask:0xf bank_mask:0xf
    s_lshl_b64 s[42:43], s[42:43], 1
    v_cndmask_b32 v8, v8, v4, s[42:43]
    v_cndmask_b32 v9, v9, v5, s[42:43]
    s_waitcnt vmcnt(7)
    v_dot2_f32_bf16 v4, v144, v144, 0
    buffer_load_dwordx4 v[192:195], v10, s[16:19], s33 offen offset:512
    v_dot2_f32_bf16 v6, v144, s38, 0
    v_dot2_f32_bf16 v5, v145, v145, 0
    v_dot2_f32_bf16 v7, v145, s38, 0
    v_dot2_f32_bf16 v4, v146, v146, v4
    v_dot2_f32_bf16 v6, v146, s38, v6
    v_dot2_f32_bf16 v5, v147, v147, v5
    v_dot2_f32_bf16 v7, v147, s38, v7
    buffer_load_dwordx4 v[196:199], v10, s[16:19], s33 offen offset:768
    v_dot2_f32_bf16 v4, v148, v148, v4
    v_dot2_f32_bf16 v6, v148, s38, v6
    v_dot2_f32_bf16 v5, v149, v149, v5
    v_dot2_f32_bf16 v7, v149, s38, v7
    v_dot2_f32_bf16 v4, v150, v150, v4
    v_dot2_f32_bf16 v6, v150, s38, v6
    v_dot2_f32_bf16 v5, v151, v151, v5
    buffer_load_dwordx4 v[200:203], v10, s[16:19], s33 offen offset:1024
    v_dot2_f32_bf16 v7, v151, s38, v7
    v_dot2_f32_bf16 v4, v152, v152, v4
    v_dot2_f32_bf16 v6, v152, s38, v6
    v_dot2_f32_bf16 v5, v153, v153, v5
    v_dot2_f32_bf16 v7, v153, s38, v7
    v_dot2_f32_bf16 v4, v154, v154, v4
    v_dot2_f32_bf16 v6, v154, s38, v6
    s_add_u32 s33, s33, 5120
    buffer_load_dwordx4 v[204:207], v10, s[16:19], s33 offen offset:0
    v_dot2_f32_bf16 v5, v155, v155, v5
    v_dot2_f32_bf16 v7, v155, s38, v7
    v_dot2_f32_bf16 v4, v156, v156, v4
    v_dot2_f32_bf16 v6, v156, s38, v6
    v_dot2_f32_bf16 v5, v157, v157, v5
    v_dot2_f32_bf16 v7, v157, s38, v7
    v_dot2_f32_bf16 v4, v158, v158, v4
    buffer_load_dwordx4 v[208:211], v10, s[16:19], s33 offen offset:256
    v_dot2_f32_bf16 v6, v158, s38, v6
    v_dot2_f32_bf16 v5, v159, v159, v5
    v_dot2_f32_bf16 v7, v159, s38, v7
    v_dot2_f32_bf16 v4, v160, v160, v4
    v_dot2_f32_bf16 v6, v160, s38, v6
    v_dot2_f32_bf16 v5, v161, v161, v5
    v_dot2_f32_bf16 v7, v161, s38, v7
    v_dot2_f32_bf16 v4, v162, v162, v4
    v_dot2_f32_bf16 v6, v162, s38, v6
    v_dot2_f32_bf16 v5, v163, v163, v5
    v_dot2_f32_bf16 v7, v163, s38, v7
    s_nop 1
    v_add_f32 v4, v4, v5
    v_add_f32_e64 v5, v6, v7
    s_nop 0
    v_add_f32_dpp v4, v4, v4 row_ror:8 row_mask:0xf bank_mask:0xf
    v_add_f32_dpp v5, v5, v5 row_ror:8 row_mask:0xf bank_mask:0xf
    s_nop 0
    v_add_f32_dpp v4, v4, v4 row_ror:4 row_mask:0xf bank_mask:0xf
    v_add_f32_dpp v5, v5, v5 row_ror:4 row_mask:0xf bank_mask:0xf
    s_nop 0
    v_add_f32_dpp v4, v4, v4 row_ror:2 row_mask:0xf bank_mask:0xf
    v_add_f32_dpp v5, v5, v5 row_ror:2 row_mask:0xf bank_mask:0xf
    s_nop 0
    v_add_f32_dpp v4, v4, v4 row_ror:1 row_mask:0xf bank_mask:0xf
    v_add_f32_dpp v5, v5, v5 row_ror:1 row_mask:0xf bank_mask:0xf
    s_lshl_b64 s[42:43], s[42:43], 1
    v_cndmask_b32 v8, v8, v4, s[42:43]
    v_cndmask_b32 v9, v9, v5, s[42:43]
    s_waitcnt vmcnt(7)
    v_dot2_f32_bf16 v4, v164, v164, 0
    buffer_load_dwordx4 v[212:215], v10, s[16:19], s33 offen offset:512
    v_dot2_f32_bf16 v6, v164, s38, 0
    v_dot2_f32_bf16 v5, v165, v165, 0
    v_dot2_f32_bf16 v7, v165, s38, 0
    v_dot2_f32_bf16 v4, v166, v166, v4
    v_dot2_f32_bf16 v6, v166, s38, v6
    v_dot2_f32_bf16 v5, v167, v167, v5
    v_dot2_f32_bf16 v7, v167, s38, v7
    buffer_load_dwordx4 v[216:219], v10, s[16:19], s33 offen offset:768
    v_dot2_f32_bf16 v4, v168, v168, v4
    v_dot2_f32_bf16 v6, v168, s38, v6
    v_dot2_f32_bf16 v5, v169, v169, v5
    v_dot2_f32_bf16 v7, v169, s38, v7
    v_dot2_f32_bf16 v4, v170, v170, v4
    v_dot2_f32_bf16 v6, v170, s38, v6
    v_dot2_f32_bf16 v5, v171, v171, v5
    buffer_load_dwordx4 v[220:223], v10, s[16:19], s33 offen offset:1024
    v_dot2_f32_bf16 v7, v171, s38, v7
    v_dot2_f32_bf16 v4, v172, v172, v4
    v_dot2_f32_bf16 v6, v172, s38, v6
    v_dot2_f32_bf16 v5, v173, v173, v5
    v_dot2_f32_bf16 v7, v173, s38, v7
    v_dot2_f32_bf16 v4, v174, v174, v4
    v_dot2_f32_bf16 v6, v174, s38, v6
    s_add_u32 s33, s33, 5120
    buffer_load_dwordx4 v[224:227], v10, s[16:19], s33 offen offset:0
    v_dot2_f32_bf16 v5, v175, v175, v5
    v_dot2_f32_bf16 v7, v175, s38, v7
    v_dot2_f32_bf16 v4, v176, v176, v4
    v_dot2_f32_bf16 v6, v176, s38, v6
    v_dot2_f32_bf16 v5, v177, v177, v5
    v_dot2_f32_bf16 v7, v177, s38, v7
    v_dot2_f32_bf16 v4, v178, v178, v4
    buffer_load_dwordx4 v[228:231], v10, s[16:19], s33 offen offset:256
    v_dot2_f32_bf16 v6, v178, s38, v6
    v_dot2_f32_bf16 v5, v179, v179, v5
    v_dot2_f32_bf16 v7, v179, s38, v7
    v_dot2_f32_bf16 v4, v180, v180, v4
    v_dot2_f32_bf16 v6, v180, s38, v6
    v_dot2_f32_bf16 v5, v181, v181, v5
    v_dot2_f32_bf16 v7, v181, s38, v7
    v_dot2_f32_bf16 v4, v182, v182, v4
    v_dot2_f32_bf16 v6, v182, s38, v6
    v_dot2_f32_bf16 v5, v183, v183, v5
    v_dot2_f32_bf16 v7, v183, s38, v7
    s_nop 1
    v_add_f32_e64 v4, v4, v5
    v_add_f32 v5, v6, v7
    s_nop 0
    v_add_f32_dpp v4, v4, v4 row_ror:8 row_mask:0xf bank_mask:0xf
    v_add_f32_dpp v5, v5, v5 row_ror:8 row_mask:0xf bank_mask:0xf
    s_nop 0
    v_add_f32_dpp v4, v4, v4 row_ror:4 row_mask:0xf bank_mask:0xf
    v_add_f32_dpp v5, v5, v5 row_ror:4 row_mask:0xf bank_mask:0xf
    s_nop 0
    v_add_f32_dpp v4, v4, v4 row_ror:2 row_mask:0xf bank_mask:0xf
    v_add_f32_dpp v5, v5, v5 row_ror:2 row_mask:0xf bank_mask:0xf
    s_nop 0
    v_add_f32_dpp v4, v4, v4 row_ror:1 row_mask:0xf bank_mask:0xf
    v_add_f32_dpp v5, v5, v5 row_ror:1 row_mask:0xf bank_mask:0xf
    s_lshl_b64 s[42:43], s[42:43], 1
    v_cndmask_b32 v8, v8, v4, s[42:43]
    v_cndmask_b32 v9, v9, v5, s[42:43]
    s_waitcnt vmcnt(7)
    v_dot2_f32_bf16 v4, v184, v184, 0
    buffer_load_dwordx4 v[232:235], v10, s[16:19], s33 offen offset:512
    v_dot2_f32_bf16 v6, v184, s38, 0
    v_dot2_f32_bf16 v5, v185, v185, 0
    v_dot2_f32_bf16 v7, v185, s38, 0
    v_dot2_f32_bf16 v4, v186, v186, v4
    v_dot2_f32_bf16 v6, v186, s38, v6
    v_dot2_f32_bf16 v5, v187, v187, v5
    v_dot2_f32_bf16 v7, v187, s38, v7
    buffer_load_dwordx4 v[236:239], v10, s[16:19], s33 offen offset:768
    v_dot2_f32_bf16 v4, v188, v188, v4
    v_dot2_f32_bf16 v6, v188, s38, v6
    v_dot2_f32_bf16 v5, v189, v189, v5
    v_dot2_f32_bf16 v7, v189, s38, v7
    v_dot2_f32_bf16 v4, v190, v190, v4
    v_dot2_f32_bf16 v6, v190, s38, v6
    v_dot2_f32_bf16 v5, v191, v191, v5
    buffer_load_dwordx4 v[240:243], v10, s[16:19], s33 offen offset:1024
    v_dot2_f32_bf16 v7, v191, s38, v7
    v_dot2_f32_bf16 v4, v192, v192, v4
    v_dot2_f32_bf16 v6, v192, s38, v6
    v_dot2_f32_bf16 v5, v193, v193, v5
    v_dot2_f32_bf16 v7, v193, s38, v7
    v_dot2_f32_bf16 v4, v194, v194, v4
    v_dot2_f32_bf16 v6, v194, s38, v6
    v_dot2_f32_bf16 v5, v195, v195, v5
    v_dot2_f32_bf16 v7, v195, s38, v7
    v_dot2_f32_bf16 v4, v196, v196, v4
    v_dot2_f32_bf16 v6, v196, s38, v6
    v_dot2_f32_bf16 v5, v197, v197, v5
    v_dot2_f32_bf16 v7, v197, s38, v7
    v_dot2_f32_bf16 v4, v198, v198, v4
    v_dot2_f32_bf16 v6, v198, s38, v6
    v_dot2_f32_bf16 v5, v199, v199, v5
    v_dot2_f32_bf16 v7, v199, s38, v7
    v_dot2_f32_bf16 v4, v200, v200, v4
    v_dot2_f32_bf16 v6, v200, s38, v6
    v_dot2_f32_bf16 v5, v201, v201, v5
    v_dot2_f32_bf16 v7, v201, s38, v7
    v_dot2_f32_bf16 v4, v202, v202, v4
    v_dot2_f32_bf16 v6, v202, s38, v6
    v_dot2_f32_bf16 v5, v203, v203, v5
    v_dot2_f32_bf16 v7, v203, s38, v7
    s_nop 1
    v_add_f32 v4, v4, v5
    v_add_f32_e64 v5, v6, v7
    s_nop 0
    v_add_f32_dpp v4, v4, v4 row_ror:8 row_mask:0xf bank_mask:0xf
    v_add_f32_dpp v5, v5, v5 row_ror:8 row_mask:0xf bank_mask:0xf
    s_nop 0
    v_add_f32_dpp v4, v4, v4 row_ror:4 row_mask:0xf bank_mask:0xf
    v_add_f32_dpp v5, v5, v5 row_ror:4 row_mask:0xf bank_mask:0xf
    s_nop 0
    v_add_f32_dpp v4, v4, v4 row_ror:2 row_mask:0xf bank_mask:0xf
    v_add_f32_dpp v5, v5, v5 row_ror:2 row_mask:0xf bank_mask:0xf
    s_nop 0
    v_add_f32_dpp v4, v4, v4 row_ror:1 row_mask:0xf bank_mask:0xf
    v_add_f32_dpp v5, v5, v5 row_ror:1 row_mask:0xf bank_mask:0xf
    s_lshl_b64 s[42:43], s[42:43], 1
    v_cndmask_b32 v8, v8, v4, s[42:43]
    v_cndmask_b32 v9, v9, v5, s[42:43]
    s_waitcnt vmcnt(5)
    v_dot2_f32_bf16 v4, v204, v204, 0
    v_dot2_f32_bf16 v6, v204, s38, 0
    v_dot2_f32_bf16 v5, v205, v205, 0
    v_dot2_f32_bf16 v7, v205, s38, 0
    v_dot2_f32_bf16 v4, v206, v206, v4
    v_dot2_f32_bf16 v6, v206, s38, v6
    v_dot2_f32_bf16 v5, v207, v207, v5
    v_dot2_f32_bf16 v7, v207, s38, v7
    v_dot2_f32_bf16 v4, v208, v208, v4
    v_dot2_f32_bf16 v6, v208, s38, v6
    v_dot2_f32_bf16 v5, v209, v209, v5
    v_dot2_f32_bf16 v7, v209, s38, v7
    v_dot2_f32_bf16 v4, v210, v210, v4
    v_dot2_f32_bf16 v6, v210, s38, v6
    v_dot2_f32_bf16 v5, v211, v211, v5
    v_dot2_f32_bf16 v7, v211, s38, v7
    v_dot2_f32_bf16 v4, v212, v212, v4
    v_dot2_f32_bf16 v6, v212, s38, v6
    v_dot2_f32_bf16 v5, v213, v213, v5
    v_dot2_f32_bf16 v7, v213, s38, v7
    v_dot2_f32_bf16 v4, v214, v214, v4
    v_dot2_f32_bf16 v6, v214, s38, v6
    v_dot2_f32_bf16 v5, v215, v215, v5
    v_dot2_f32_bf16 v7, v215, s38, v7
    v_dot2_f32_bf16 v4, v216, v216, v4
    v_dot2_f32_bf16 v6, v216, s38, v6
    v_dot2_f32_bf16 v5, v217, v217, v5
    v_dot2_f32_bf16 v7, v217, s38, v7
    v_dot2_f32_bf16 v4, v218, v218, v4
    v_dot2_f32_bf16 v6, v218, s38, v6
    v_dot2_f32_bf16 v5, v219, v219, v5
    v_dot2_f32_bf16 v7, v219, s38, v7
    v_dot2_f32_bf16 v4, v220, v220, v4
    v_dot2_f32_bf16 v6, v220, s38, v6
    v_dot2_f32_bf16 v5, v221, v221, v5
    v_dot2_f32_bf16 v7, v221, s38, v7
    v_dot2_f32_bf16 v4, v222, v222, v4
    v_dot2_f32_bf16 v6, v222, s38, v6
    v_dot2_f32_bf16 v5, v223, v223, v5
    v_dot2_f32_bf16 v7, v223, s38, v7
    s_nop 1
    v_add_f32_e64 v4, v4, v5
    v_add_f32 v5, v6, v7
    s_nop 0
    v_add_f32_dpp v4, v4, v4 row_ror:8 row_mask:0xf bank_mask:0xf
    v_add_f32_dpp v5, v5, v5 row_ror:8 row_mask:0xf bank_mask:0xf
    s_nop 0
    v_add_f32_dpp v4, v4, v4 row_ror:4 row_mask:0xf bank_mask:0xf
    v_add_f32_dpp v5, v5, v5 row_ror:4 row_mask:0xf bank_mask:0xf
    s_nop 0
    v_add_f32_dpp v4, v4, v4 row_ror:2 row_mask:0xf bank_mask:0xf
    v_add_f32_dpp v5, v5, v5 row_ror:2 row_mask:0xf bank_mask:0xf
    s_nop 0
    v_add_f32_dpp v4, v4, v4 row_ror:1 row_mask:0xf bank_mask:0xf
    v_add_f32_dpp v5, v5, v5 row_ror:1 row_mask:0xf bank_mask:0xf
    s_lshl_b64 s[42:43], s[42:43], 1
    v_cndmask_b32 v8, v8, v4, s[42:43]
    v_cndmask_b32 v9, v9, v5, s[42:43]
    s_waitcnt vmcnt(0)
    v_dot2_f32_bf16 v4, v224, v224, 0
    v_dot2_f32_bf16 v6, v224, s38, 0
    v_dot2_f32_bf16 v5, v225, v225, 0
    v_dot2_f32_bf16 v7, v225, s38, 0
    v_dot2_f32_bf16 v4, v226, v226, v4
    v_dot2_f32_bf16 v6, v226, s38, v6
    v_dot2_f32_bf16 v5, v227, v227, v5
    v_dot2_f32_bf16 v7, v227, s38, v7
    v_dot2_f32_bf16 v4, v228, v228, v4
    v_dot2_f32_bf16 v6, v228, s38, v6
    v_dot2_f32_bf16 v5, v229, v229, v5
    v_dot2_f32_bf16 v7, v229, s38, v7
    v_dot2_f32_bf16 v4, v230, v230, v4
    v_dot2_f32_bf16 v6, v230, s38, v6
    v_dot2_f32_bf16 v5, v231, v231, v5
    v_dot2_f32_bf16 v7, v231, s38, v7
    v_dot2_f32_bf16 v4, v232, v232, v4
    v_dot2_f32_bf16 v6, v232, s38, v6
    v_dot2_f32_bf16 v5, v233, v233, v5
    v_dot2_f32_bf16 v7, v233, s38, v7
    v_dot2_f32_bf16 v4, v234, v234, v4
    v_dot2_f32_bf16 v6, v234, s38, v6
    v_dot2_f32_bf16 v5, v235, v235, v5
    v_dot2_f32_bf16 v7, v235, s38, v7
    v_dot2_f32_bf16 v4, v236, v236, v4
    v_dot2_f32_bf16 v6, v236, s38, v6
    v_dot2_f32_bf16 v5, v237, v237, v5
    v_dot2_f32_bf16 v7, v237, s38, v7
    v_dot2_f32_bf16 v4, v238, v238, v4
    v_dot2_f32_bf16 v6, v238, s38, v6
    v_dot2_f32_bf16 v5, v239, v239, v5
    v_dot2_f32_bf16 v7, v239, s38, v7
    v_dot2_f32_bf16 v4, v240, v240, v4
    v_dot2_f32_bf16 v6, v240, s38, v6
    v_dot2_f32_bf16 v5, v241, v241, v5
    v_dot2_f32_bf16 v7, v241, s38, v7
    v_dot2_f32_bf16 v4, v242, v242, v4
    v_dot2_f32_bf16 v6, v242, s38, v6
    v_dot2_f32_bf16 v5, v243, v243, v5
    v_dot2_f32_bf16 v7, v243, s38, v7
    s_nop 1
    v_add_f32 v4, v4, v5
    v_add_f32 v5, v6, v7
    s_nop 0
    v_add_f32_dpp v4, v4, v4 row_ror:8 row_mask:0xf bank_mask:0xf
    v_add_f32_dpp v5, v5, v5 row_ror:8 row_mask:0xf bank_mask:0xf
    s_nop 0
    v_add_f32_dpp v4, v4, v4 row_ror:4 row_mask:0xf bank_mask:0xf
    v_add_f32_dpp v5, v5, v5 row_ror:4 row_mask:0xf bank_mask:0xf
    s_nop 0
    v_add_f32_dpp v4, v4, v4 row_ror:2 row_mask:0xf bank_mask:0xf
    v_add_f32_dpp v5, v5, v5 row_ror:2 row_mask:0xf bank_mask:0xf
    s_nop 0
    v_add_f32_dpp v4, v4, v4 row_ror:1 row_mask:0xf bank_mask:0xf
    v_add_f32_dpp v5, v5, v5 row_ror:1 row_mask:0xf bank_mask:0xf
    s_lshl_b64 s[42:43], s[42:43], 1
    v_cndmask_b32 v8, v8, v4, s[42:43]
    v_cndmask_b32 v9, v9, v5, s[42:43]
    v_mul_f32 v9, 0x3acccccd, v9
    v_mul_f32 v4, 0x3acccccd, v8
    v_fma_f32 v4, -v9, v9, v4
    v_max_f32 v4, 0, v4
    v_add_f32 v4, 0x3727c5ac, v4
    v_rsq_f32 v4, v4
    v_bfe_u32 v5, v1, 1, 2
    v_and_b32_e64 v6, 1, v1
    v_mul_f32 v8, 0x3a000000, v4
    v_lshl_add_u32 v12, v5, 7, v11
    v_lshl_add_u32 v12, v6, 12, v12
    v_lshl_add_u32 v13, v5, 8, v11
    v_lshl_add_u32 v13, v6, 4, v13
    s_mov_b32 s42, 0x00ff00ff
    s_mov_b32 s43, 0x00ff00ff
    s_mov_b64 exec, s[42:43]
    buffer_store_dword v8, v12, s[20:23], s36 offen sc1
    buffer_store_dword v9, v13, s[20:23], s37 offen sc1
    s_mov_b64 exec, -1
kc_n0:
    v_readfirstlane_b32 s10, v18
    v_readfirstlane_b32 s11, v19
    s_add_u32 s32, s10, 1000
    s_addc_u32 s33, s11, 0
    s_sub_u32 s32, s32, s94
    s_subb_u32 s33, s33, s95
    s_cmp_ge_i32 s33, 0
    s_cbranch_scc0 kc_n2
kc_n1:
    s_bfe_u32 s29, s2, 0x20001
    s_lshl_b32 s29, s29, 3
    s_lshr_b32 s32, s2, 5
    s_add_u32 s29, s29, s32
    s_and_b32 s30, s2, 1
    s_lshl_b32 s30, s30, 2
    s_bfe_u32 s32, s2, 0x20003
    s_add_u32 s30, s30, s32
    v_bfe_u32 v2, v1, 2, 2
    v_and_b32 v3, 3, v1
    v_lshl_add_u32 v2, v2, 3, v3
    s_mul_i32 s32, s30, 80
    v_add_u32_e64 v2, s32, v2
    v_and_b32 v3, 15, v1
    v_add_u32 v3, s32, v3
    s_movk_i32 s9, 320
    v_add_u32 v4, 0, v2
    v_subrev_u32 v5, 640, v4
    v_cmp_le_u32 vcc, s9, v4
    s_nop 0
    s_nop 0
    v_cndmask_b32 v4, v4, v5, vcc
    v_cvt_f32_i32 v4, v4
    v_mul_f32 v0, 0x3acccccd, v4
    v_add_u32 v4, 4, v2
    v_subrev_u32 v5, 640, v4
    v_cmp_le_u32 vcc, s9, v4
    s_nop 0
    s_nop 0
    v_cndmask_b32 v4, v4, v5, vcc
    v_cvt_f32_i32 v4, v4
    v_mul_f32 v252, 0x3acccccd, v4
    v_add_u32 v4, 32, v2
    v_subrev_u32 v5, 640, v4
    v_cmp_le_u32 vcc, s9, v4
    s_nop 0
    s_nop 0
    v_cndmask_b32 v4, v4, v5, vcc
    v_cvt_f32_i32 v4, v4
    v_mul_f32 v253, 0x3acccccd, v4
    v_add_u32 v4, 36, v2
    v_subrev_u32 v5, 640, v4
    v_cmp_le_u32 vcc, s9, v4
    s_nop 0
    s_nop 0
    v_cndmask_b32 v4, v4, v5, vcc
    v_cvt_f32_i32 v4, v4
    v_mul_f32 v254, 0x3acccccd, v4
    v_add_u32 v4, 64, v3
    v_subrev_u32 v5, 640, v4
    v_cmp_le_u32 vcc, s9, v4
    s_nop 0
    s_nop 0
    v_cndmask_b32 v4, v4, v5, vcc
    v_cvt_f32_i32 v4, v4
    v_mul_f32 v255, 0x3acccccd, v4
    v_lshrrev_b32 v2, 4, v1
    s_cmp_eq_u32 s28, 3
    s_cselect_b32 s9, 3, 4
    v_cmp_eq_u32 s[48:49], s9, v2
    s_mul_i32 s31, s28, 5
    v_mul_f32 v4, 4.0, v0
    v_cos_f32 v196, v4
    v_sin_f32_e64 v197, -v4
    v_mul_f32 v5, 4.0, v252
    v_cos_f32 v198, v5
    v_sin_f32_e64 v199, -v5
    v_mul_f32 v4, 4.0, v253
    v_cos_f32 v200, v4
    v_sin_f32_e64 v201, -v4
    v_mul_f32 v5, 4.0, v254
    v_cos_f32 v202, v5
    v_sin_f32_e64 v203, -v5
    v_mul_f32 v4, 4.0, v255
    v_cos_f32 v204, v4
    v_sin_f32_e64 v205, -v4
    s_waitcnt vmcnt(0)
    s_barrier
    s_cmp_lg_u32 s28, 0
    s_cbranch_scc1 ks1_f
    s_lshl_b32 s32, s2, 7
    s_add_u32 s32, s32, 19136512
    v_mov_b32 v2, s10
    v_mov_b32 v3, s11
    v_mov_b32 v4, 0
    buffer_store_dwordx2 v[2:3], v4, s[20:23], s32 offen sc1
ks1_f:
kf_np2:
    s_lshr_b32 s32, s28, 1
    s_lshl_b32 s32, s32, 3
    s_add_u32 s32, s32, s30
    s_lshl_b32 s32, s32, 7
    s_add_u32 s32, s32, 19156992
    v_min_u32 v18, 19, v1
    v_and_b32 v7, 3, v18
    v_lshrrev_b32 v18, 2, v18
    v_lshl_add_u32 v18, v18, 11, s32
    v_lshl_add_u32 v18, v7, 3, v18
    v_lshlrev_b32 v10, 4, v1
    v_add_u32 v11, 20480, v10
    v_add_u32 v12, 40960, v10
    s_mul_i32 s44, s30, 12
    s_mul_i32 s32, s28, 3
    s_add_u32 s44, s44, s32
    s_mul_i32 s44, s44, 20480
    s_add_u32 s44, s44, 3145728
    v_mul_f32 v4, 4.0, v0
    v_cos_f32 v196, v4
    v_sin_f32_e64 v197, -v4
    v_mul_f32 v5, 4.0, v252
    v_cos_f32 v198, v5
    v_sin_f32_e64 v199, -v5
    v_mul_f32 v4, 4.0, v253
    v_cos_f32 v200, v4
    v_sin_f32_e64 v201, -v4
    v_mul_f32 v5, 4.0, v254
    v_cos_f32 v202, v5
    v_sin_f32_e64 v203, -v5
    v_mul_f32 v4, 4.0, v255
    v_cos_f32 v204, v4
    v_sin_f32_e64 v205, -v4
    s_add_u32 s9, s31, 0
    s_lshr_b32 s51, s9, 2
    s_lshl_b32 s51, s51, 6
    s_and_b32 s9, s9, 3
    s_add_u32 s9, s9, s51
    s_add_u32 s9, s9, 1
    v_and_b32 v3, 48, v1
    v_add_u32 v3, s9, v3
    v_cvt_f32_u32 v3, v3
    v_mul_f32 v4, v3, v0
    v_cos_f32 v206, v4
    v_sin_f32_e64 v207, -v4
    v_mul_f32 v5, v3, v252
    v_cos_f32 v214, v5
    v_sin_f32_e64 v215, -v5
    v_mul_f32 v4, v3, v253
    v_cos_f32 v222, v4
    v_sin_f32_e64 v223, -v4
    v_mul_f32 v5, v3, v254
    v_cos_f32 v230, v5
    v_sin_f32_e64 v231, -v5
    v_mul_f32 v4, v3, v255
    v_cos_f32_e64 v238, v4
    v_sin_f32_e64 v239, -v4
    s_mov_b32 s8, 0x3b4ccccd
    v_pk_mul_f32 v[206:207], v[206:207], s[8:9] op_sel_hi:[1,0]
    v_pk_mul_f32 v[214:215], v[214:215], s[8:9] op_sel_hi:[1,0]
    v_pk_mul_f32 v[222:223], v[222:223], s[8:9] op_sel_hi:[1,0]
    v_pk_mul_f32 v[230:231], v[230:231], s[8:9] op_sel_hi:[1,0]
    v_pk_mul_f32 v[238:239], v[238:239], s[8:9] op_sel_hi:[1,0]
    v_pk_mul_f32 v[208:209], v[206:207], v[196:197] op_sel_hi:[1,0]
    v_pk_mul_f32 v[216:217], v[214:215], v[198:199] op_sel_hi:[1,0]
    v_pk_mul_f32 v[224:225], v[222:223], v[200:201] op_sel_hi:[1,0]
    v_pk_mul_f32 v[232:233], v[230:231], v[202:203] op_sel_hi:[1,0]
    v_pk_mul_f32 v[240:241], v[238:239], v[204:205] op_sel_hi:[1,0]
    v_pk_fma_f32 v[208:209], v[206:207], v[196:197], v[208:209] op_sel:[1,1,0] op_sel_hi:[0,1,1] neg_lo:[1,0,0]
    v_pk_fma_f32 v[216:217], v[214:215], v[198:199], v[216:217] op_sel:[1,1,0] op_sel_hi:[0,1,1] neg_lo:[1,0,0]
    v_pk_fma_f32 v[224:225], v[222:223], v[200:201], v[224:225] op_sel:[1,1,0] op_sel_hi:[0,1,1] neg_lo:[1,0,0]
    v_pk_fma_f32 v[232:233], v[230:231], v[202:203], v[232:233] op_sel:[1,1,0] op_sel_hi:[0,1,1] neg_lo:[1,0,0]
    v_pk_fma_f32 v[240:241], v[238:239], v[204:205], v[240:241] op_sel:[1,1,0] op_sel_hi:[0,1,1] neg_lo:[1,0,0]
    v_pk_mul_f32 v[210:211], v[208:209], v[196:197] op_sel_hi:[1,0]
    v_pk_mul_f32 v[218:219], v[216:217], v[198:199] op_sel_hi:[1,0]
    v_pk_mul_f32 v[226:227], v[224:225], v[200:201] op_sel_hi:[1,0]
    v_pk_mul_f32 v[234:235], v[232:233], v[202:203] op_sel_hi:[1,0]
    v_pk_mul_f32 v[242:243], v[240:241], v[204:205] op_sel_hi:[1,0]
    v_pk_fma_f32 v[210:211], v[208:209], v[196:197], v[210:211] op_sel:[1,1,0] op_sel_hi:[0,1,1] neg_lo:[1,0,0]
    v_pk_fma_f32 v[218:219], v[216:217], v[198:199], v[218:219] op_sel:[1,1,0] op_sel_hi:[0,1,1] neg_lo:[1,0,0]
    v_pk_fma_f32 v[226:227], v[224:225], v[200:201], v[226:227] op_sel:[1,1,0] op_sel_hi:[0,1,1] neg_lo:[1,0,0]
    v_pk_fma_f32 v[234:235], v[232:233], v[202:203], v[234:235] op_sel:[1,1,0] op_sel_hi:[0,1,1] neg_lo:[1,0,0]
    v_pk_fma_f32 v[242:243], v[240:241], v[204:205], v[242:243] op_sel:[1,1,0] op_sel_hi:[0,1,1] neg_lo:[1,0,0]
    v_pk_mul_f32 v[212:213], v[210:211], v[196:197] op_sel_hi:[1,0]
    v_pk_mul_f32 v[220:221], v[218:219], v[198:199] op_sel_hi:[1,0]
    v_pk_mul_f32 v[228:229], v[226:227], v[200:201] op_sel_hi:[1,0]
    v_pk_mul_f32 v[236:237], v[234:235], v[202:203] op_sel_hi:[1,0]
    v_pk_mul_f32 v[244:245], v[242:243], v[204:205] op_sel_hi:[1,0]
    v_pk_fma_f32 v[212:213], v[210:211], v[196:197], v[212:213] op_sel:[1,1,0] op_sel_hi:[0,1,1] neg_lo:[1,0,0]
    v_pk_fma_f32 v[220:221], v[218:219], v[198:199], v[220:221] op_sel:[1,1,0] op_sel_hi:[0,1,1] neg_lo:[1,0,0]
    v_pk_fma_f32 v[228:229], v[226:227], v[200:201], v[228:229] op_sel:[1,1,0] op_sel_hi:[0,1,1] neg_lo:[1,0,0]
    v_pk_fma_f32 v[236:237], v[234:235], v[202:203], v[236:237] op_sel:[1,1,0] op_sel_hi:[0,1,1] neg_lo:[1,0,0]
    v_pk_fma_f32 v[244:245], v[242:243], v[204:205], v[244:245] op_sel:[1,1,0] op_sel_hi:[0,1,1] neg_lo:[1,0,0]
    v_cvt_pk_bf16_f32 v20, v206, v208
    v_cvt_pk_bf16_f32 v22, v207, v209
    v_cvt_pk_bf16_f32 v21, v210, v212
    v_cvt_pk_bf16_f32 v23, v211, v213
    v_cvt_pk_bf16_f32 v24, v214, v216
    v_cvt_pk_bf16_f32 v26, v215, v217
    v_cvt_pk_bf16_f32 v25, v218, v220
    v_cvt_pk_bf16_f32 v27, v219, v221
    v_cvt_pk_bf16_f32 v28, v222, v224
    v_cvt_pk_bf16_f32 v30, v223, v225
    v_cvt_pk_bf16_f32 v29, v226, v228
    v_cvt_pk_bf16_f32 v31, v227, v229
    v_cvt_pk_bf16_f32 v32, v230, v232
    v_cvt_pk_bf16_f32 v34, v231, v233
    v_cvt_pk_bf16_f32 v33, v234, v236
    v_cvt_pk_bf16_f32 v35, v235, v237
    v_cvt_pk_bf16_f32 v36, v238, v240
    v_cvt_pk_bf16_f32 v38, v239, v241
    v_cvt_pk_bf16_f32 v37, v242, v244
    v_cvt_pk_bf16_f32 v39, v243, v245
    s_add_u32 s9, s31, 1
    s_lshr_b32 s51, s9, 2
    s_lshl_b32 s51, s51, 6
    s_and_b32 s9, s9, 3
    s_add_u32 s9, s9, s51
    s_add_u32 s9, s9, 1
    v_and_b32_e64 v3, 48, v1
    v_add_u32 v3, s9, v3
    v_cvt_f32_u32 v3, v3
    v_mul_f32 v4, v3, v0
    v_cos_f32 v206, v4
    v_sin_f32_e64 v207, -v4
    v_mul_f32 v5, v3, v252
    v_cos_f32 v214, v5
    v_sin_f32_e64 v215, -v5
    v_mul_f32 v4, v3, v253
    v_cos_f32 v222, v4
    v_sin_f32_e64 v223, -v4
    v_mul_f32 v5, v3, v254
    v_cos_f32 v230, v5
    v_sin_f32_e64 v231, -v5
    v_mul_f32 v4, v3, v255
    v_cos_f32 v238, v4
    v_sin_f32_e64 v239, -v4
    s_mov_b32 s8, 0x3b4ccccd
    v_pk_mul_f32 v[206:207], v[206:207], s[8:9] op_sel_hi:[1,0]
    v_pk_mul_f32 v[214:215], v[214:215], s[8:9] op_sel_hi:[1,0]
    v_pk_mul_f32 v[222:223], v[222:223], s[8:9] op_sel_hi:[1,0]
    v_pk_mul_f32 v[230:231], v[230:231], s[8:9] op_sel_hi:[1,0]
    v_pk_mul_f32 v[238:239], v[238:239], s[8:9] op_sel_hi:[1,0]
    v_pk_mul_f32 v[208:209], v[206:207], v[196:197] op_sel_hi:[1,0]
    v_pk_mul_f32 v[216:217], v[214:215], v[198:199] op_sel_hi:[1,0]
    v_pk_mul_f32 v[224:225], v[222:223], v[200:201] op_sel_hi:[1,0]
    v_pk_mul_f32 v[232:233], v[230:231], v[202:203] op_sel_hi:[1,0]
    v_pk_mul_f32 v[240:241], v[238:239], v[204:205] op_sel_hi:[1,0]
    v_pk_fma_f32 v[208:209], v[206:207], v[196:197], v[208:209] op_sel:[1,1,0] op_sel_hi:[0,1,1] neg_lo:[1,0,0]
    v_pk_fma_f32 v[216:217], v[214:215], v[198:199], v[216:217] op_sel:[1,1,0] op_sel_hi:[0,1,1] neg_lo:[1,0,0]
    v_pk_fma_f32 v[224:225], v[222:223], v[200:201], v[224:225] op_sel:[1,1,0] op_sel_hi:[0,1,1] neg_lo:[1,0,0]
    v_pk_fma_f32 v[232:233], v[230:231], v[202:203], v[232:233] op_sel:[1,1,0] op_sel_hi:[0,1,1] neg_lo:[1,0,0]
    v_pk_fma_f32 v[240:241], v[238:239], v[204:205], v[240:241] op_sel:[1,1,0] op_sel_hi:[0,1,1] neg_lo:[1,0,0]
    v_pk_mul_f32 v[210:211], v[208:209], v[196:197] op_sel_hi:[1,0]
    v_pk_mul_f32 v[218:219], v[216:217], v[198:199] op_sel_hi:[1,0]
    v_pk_mul_f32 v[226:227], v[224:225], v[200:201] op_sel_hi:[1,0]
    v_pk_mul_f32 v[234:235], v[232:233], v[202:203] op_sel_hi:[1,0]
    v_pk_mul_f32 v[242:243], v[240:241], v[204:205] op_sel_hi:[1,0]
    v_pk_fma_f32 v[210:211], v[208:209], v[196:197], v[210:211] op_sel:[1,1,0] op_sel_hi:[0,1,1] neg_lo:[1,0,0]
    v_pk_fma_f32 v[218:219], v[216:217], v[198:199], v[218:219] op_sel:[1,1,0] op_sel_hi:[0,1,1] neg_lo:[1,0,0]
    v_pk_fma_f32 v[226:227], v[224:225], v[200:201], v[226:227] op_sel:[1,1,0] op_sel_hi:[0,1,1] neg_lo:[1,0,0]
    v_pk_fma_f32 v[234:235], v[232:233], v[202:203], v[234:235] op_sel:[1,1,0] op_sel_hi:[0,1,1] neg_lo:[1,0,0]
    v_pk_fma_f32 v[242:243], v[240:241], v[204:205], v[242:243] op_sel:[1,1,0] op_sel_hi:[0,1,1] neg_lo:[1,0,0]
    v_pk_mul_f32 v[212:213], v[210:211], v[196:197] op_sel_hi:[1,0]
    v_pk_mul_f32 v[220:221], v[218:219], v[198:199] op_sel_hi:[1,0]
    v_pk_mul_f32 v[228:229], v[226:227], v[200:201] op_sel_hi:[1,0]
    v_pk_mul_f32 v[236:237], v[234:235], v[202:203] op_sel_hi:[1,0]
    v_pk_mul_f32 v[244:245], v[242:243], v[204:205] op_sel_hi:[1,0]
    v_pk_fma_f32 v[212:213], v[210:211], v[196:197], v[212:213] op_sel:[1,1,0] op_sel_hi:[0,1,1] neg_lo:[1,0,0]
    v_pk_fma_f32 v[220:221], v[218:219], v[198:199], v[220:221] op_sel:[1,1,0] op_sel_hi:[0,1,1] neg_lo:[1,0,0]
    v_pk_fma_f32 v[228:229], v[226:227], v[200:201], v[228:229] op_sel:[1,1,0] op_sel_hi:[0,1,1] neg_lo:[1,0,0]
    v_pk_fma_f32 v[236:237], v[234:235], v[202:203], v[236:237] op_sel:[1,1,0] op_sel_hi:[0,1,1] neg_lo:[1,0,0]
    v_pk_fma_f32 v[244:245], v[242:243], v[204:205], v[244:245] op_sel:[1,1,0] op_sel_hi:[0,1,1] neg_lo:[1,0,0]
    v_cvt_pk_bf16_f32 v40, v206, v208
    v_cvt_pk_bf16_f32 v42, v207, v209
    v_cvt_pk_bf16_f32 v41, v210, v212
    v_cvt_pk_bf16_f32 v43, v211, v213
    v_cvt_pk_bf16_f32 v44, v214, v216
    v_cvt_pk_bf16_f32 v46, v215, v217
    v_cvt_pk_bf16_f32 v45, v218, v220
    v_cvt_pk_bf16_f32 v47, v219, v221
    v_cvt_pk_bf16_f32 v48, v222, v224
    v_cvt_pk_bf16_f32 v50, v223, v225
    v_cvt_pk_bf16_f32 v49, v226, v228
    v_cvt_pk_bf16_f32 v51, v227, v229
    v_cvt_pk_bf16_f32 v52, v230, v232
    v_cvt_pk_bf16_f32 v54, v231, v233
    v_cvt_pk_bf16_f32 v53, v234, v236
    v_cvt_pk_bf16_f32 v55, v235, v237
    v_cvt_pk_bf16_f32 v56, v238, v240
    v_cvt_pk_bf16_f32 v58, v239, v241
    v_cvt_pk_bf16_f32 v57, v242, v244
    v_cvt_pk_bf16_f32 v59, v243, v245
    s_add_u32 s9, s31, 2
    s_lshr_b32 s51, s9, 2
    s_lshl_b32 s51, s51, 6
    s_and_b32 s9, s9, 3
    s_add_u32 s9, s9, s51
    s_add_u32 s9, s9, 1
    v_and_b32 v3, 48, v1
    v_add_u32 v3, s9, v3
    v_cvt_f32_u32 v3, v3
    v_mul_f32 v4, v3, v0
    v_cos_f32 v206, v4
    v_sin_f32_e64 v207, -v4
    v_mul_f32 v5, v3, v252
    v_cos_f32 v214, v5
    v_sin_f32_e64 v215, -v5
    v_mul_f32 v4, v3, v253
    v_cos_f32 v222, v4
    v_sin_f32_e64 v223, -v4
    v_mul_f32 v5, v3, v254
    v_cos_f32 v230, v5
    v_sin_f32_e64 v231, -v5
    v_mul_f32 v4, v3, v255
    v_cos_f32_e64 v238, v4
    v_sin_f32_e64 v239, -v4
    s_mov_b32 s8, 0x3b4ccccd
    v_pk_mul_f32 v[206:207], v[206:207], s[8:9] op_sel_hi:[1,0]
    v_pk_mul_f32 v[214:215], v[214:215], s[8:9] op_sel_hi:[1,0]
    v_pk_mul_f32 v[222:223], v[222:223], s[8:9] op_sel_hi:[1,0]
    v_pk_mul_f32 v[230:231], v[230:231], s[8:9] op_sel_hi:[1,0]
    v_pk_mul_f32 v[238:239], v[238:239], s[8:9] op_sel_hi:[1,0]
    v_pk_mul_f32 v[208:209], v[206:207], v[196:197] op_sel_hi:[1,0]
    v_pk_mul_f32 v[216:217], v[214:215], v[198:199] op_sel_hi:[1,0]
    v_pk_mul_f32 v[224:225], v[222:223], v[200:201] op_sel_hi:[1,0]
    v_pk_mul_f32 v[232:233], v[230:231], v[202:203] op_sel_hi:[1,0]
    v_pk_mul_f32 v[240:241], v[238:239], v[204:205] op_sel_hi:[1,0]
    v_pk_fma_f32 v[208:209], v[206:207], v[196:197], v[208:209] op_sel:[1,1,0] op_sel_hi:[0,1,1] neg_lo:[1,0,0]
    v_pk_fma_f32 v[216:217], v[214:215], v[198:199], v[216:217] op_sel:[1,1,0] op_sel_hi:[0,1,1] neg_lo:[1,0,0]
    v_pk_fma_f32 v[224:225], v[222:223], v[200:201], v[224:225] op_sel:[1,1,0] op_sel_hi:[0,1,1] neg_lo:[1,0,0]
    v_pk_fma_f32 v[232:233], v[230:231], v[202:203], v[232:233] op_sel:[1,1,0] op_sel_hi:[0,1,1] neg_lo:[1,0,0]
    v_pk_fma_f32 v[240:241], v[238:239], v[204:205], v[240:241] op_sel:[1,1,0] op_sel_hi:[0,1,1] neg_lo:[1,0,0]
    v_pk_mul_f32 v[210:211], v[208:209], v[196:197] op_sel_hi:[1,0]
    v_pk_mul_f32 v[218:219], v[216:217], v[198:199] op_sel_hi:[1,0]
    v_pk_mul_f32 v[226:227], v[224:225], v[200:201] op_sel_hi:[1,0]
    v_pk_mul_f32 v[234:235], v[232:233], v[202:203] op_sel_hi:[1,0]
    v_pk_mul_f32 v[242:243], v[240:241], v[204:205] op_sel_hi:[1,0]
    v_pk_fma_f32 v[210:211], v[208:209], v[196:197], v[210:211] op_sel:[1,1,0] op_sel_hi:[0,1,1] neg_lo:[1,0,0]
    v_pk_fma_f32 v[218:219], v[216:217], v[198:199], v[218:219] op_sel:[1,1,0] op_sel_hi:[0,1,1] neg_lo:[1,0,0]
    v_pk_fma_f32 v[226:227], v[224:225], v[200:201], v[226:227] op_sel:[1,1,0] op_sel_hi:[0,1,1] neg_lo:[1,0,0]
    v_pk_fma_f32 v[234:235], v[232:233], v[202:203], v[234:235] op_sel:[1,1,0] op_sel_hi:[0,1,1] neg_lo:[1,0,0]
    v_pk_fma_f32 v[242:243], v[240:241], v[204:205], v[242:243] op_sel:[1,1,0] op_sel_hi:[0,1,1] neg_lo:[1,0,0]
    v_pk_mul_f32 v[212:213], v[210:211], v[196:197] op_sel_hi:[1,0]
    v_pk_mul_f32 v[220:221], v[218:219], v[198:199] op_sel_hi:[1,0]
    v_pk_mul_f32 v[228:229], v[226:227], v[200:201] op_sel_hi:[1,0]
    v_pk_mul_f32 v[236:237], v[234:235], v[202:203] op_sel_hi:[1,0]
    v_pk_mul_f32 v[244:245], v[242:243], v[204:205] op_sel_hi:[1,0]
    v_pk_fma_f32 v[212:213], v[210:211], v[196:197], v[212:213] op_sel:[1,1,0] op_sel_hi:[0,1,1] neg_lo:[1,0,0]
    v_pk_fma_f32 v[220:221], v[218:219], v[198:199], v[220:221] op_sel:[1,1,0] op_sel_hi:[0,1,1] neg_lo:[1,0,0]
    v_pk_fma_f32 v[228:229], v[226:227], v[200:201], v[228:229] op_sel:[1,1,0] op_sel_hi:[0,1,1] neg_lo:[1,0,0]
    v_pk_fma_f32 v[236:237], v[234:235], v[202:203], v[236:237] op_sel:[1,1,0] op_sel_hi:[0,1,1] neg_lo:[1,0,0]
    v_pk_fma_f32 v[244:245], v[242:243], v[204:205], v[244:245] op_sel:[1,1,0] op_sel_hi:[0,1,1] neg_lo:[1,0,0]
    v_cvt_pk_bf16_f32 v60, v206, v208
    v_cvt_pk_bf16_f32 v62, v207, v209
    v_cvt_pk_bf16_f32 v61, v210, v212
    v_cvt_pk_bf16_f32 v63, v211, v213
    v_cvt_pk_bf16_f32 v64, v214, v216
    v_cvt_pk_bf16_f32 v66, v215, v217
    v_cvt_pk_bf16_f32 v65, v218, v220
    v_cvt_pk_bf16_f32 v67, v219, v221
    v_cvt_pk_bf16_f32 v68, v222, v224
    v_cvt_pk_bf16_f32 v70, v223, v225
    v_cvt_pk_bf16_f32 v69, v226, v228
    v_cvt_pk_bf16_f32 v71, v227, v229
    v_cvt_pk_bf16_f32 v72, v230, v232
    v_cvt_pk_bf16_f32 v74, v231, v233
    v_cvt_pk_bf16_f32 v73, v234, v236
    v_cvt_pk_bf16_f32 v75, v235, v237
    v_cvt_pk_bf16_f32 v76, v238, v240
    v_cvt_pk_bf16_f32 v78, v239, v241
    v_cvt_pk_bf16_f32 v77, v242, v244
    v_cvt_pk_bf16_f32 v79, v243, v245
    s_add_u32 s9, s31, 3
    s_lshr_b32 s51, s9, 2
    s_lshl_b32 s51, s51, 6
    s_and_b32 s9, s9, 3
    s_add_u32 s9, s9, s51
    s_add_u32 s9, s9, 1
    v_and_b32_e64 v3, 48, v1
    v_add_u32 v3, s9, v3
    v_cvt_f32_u32 v3, v3
    v_mul_f32 v4, v3, v0
    v_cos_f32 v206, v4
    v_sin_f32_e64 v207, -v4
    v_mul_f32 v5, v3, v252
    v_cos_f32 v214, v5
    v_sin_f32_e64 v215, -v5
    v_mul_f32 v4, v3, v253
    v_cos_f32 v222, v4
    v_sin_f32_e64 v223, -v4
    v_mul_f32 v5, v3, v254
    v_cos_f32 v230, v5
    v_sin_f32_e64 v231, -v5
    v_mul_f32 v4, v3, v255
    v_cos_f32 v238, v4
    v_sin_f32_e64 v239, -v4
    s_mov_b32 s8, 0x3b4ccccd
    v_pk_mul_f32 v[206:207], v[206:207], s[8:9] op_sel_hi:[1,0]
    v_pk_mul_f32 v[214:215], v[214:215], s[8:9] op_sel_hi:[1,0]
    v_pk_mul_f32 v[222:223], v[222:223], s[8:9] op_sel_hi:[1,0]
    v_pk_mul_f32 v[230:231], v[230:231], s[8:9] op_sel_hi:[1,0]
    v_pk_mul_f32 v[238:239], v[238:239], s[8:9] op_sel_hi:[1,0]
    v_pk_mul_f32 v[208:209], v[206:207], v[196:197] op_sel_hi:[1,0]
    v_pk_mul_f32 v[216:217], v[214:215], v[198:199] op_sel_hi:[1,0]
    v_pk_mul_f32 v[224:225], v[222:223], v[200:201] op_sel_hi:[1,0]
    v_pk_mul_f32 v[232:233], v[230:231], v[202:203] op_sel_hi:[1,0]
    v_pk_mul_f32 v[240:241], v[238:239], v[204:205] op_sel_hi:[1,0]
    v_pk_fma_f32 v[208:209], v[206:207], v[196:197], v[208:209] op_sel:[1,1,0] op_sel_hi:[0,1,1] neg_lo:[1,0,0]
    v_pk_fma_f32 v[216:217], v[214:215], v[198:199], v[216:217] op_sel:[1,1,0] op_sel_hi:[0,1,1] neg_lo:[1,0,0]
    v_pk_fma_f32 v[224:225], v[222:223], v[200:201], v[224:225] op_sel:[1,1,0] op_sel_hi:[0,1,1] neg_lo:[1,0,0]
    v_pk_fma_f32 v[232:233], v[230:231], v[202:203], v[232:233] op_sel:[1,1,0] op_sel_hi:[0,1,1] neg_lo:[1,0,0]
    v_pk_fma_f32 v[240:241], v[238:239], v[204:205], v[240:241] op_sel:[1,1,0] op_sel_hi:[0,1,1] neg_lo:[1,0,0]
    v_pk_mul_f32 v[210:211], v[208:209], v[196:197] op_sel_hi:[1,0]
    v_pk_mul_f32 v[218:219], v[216:217], v[198:199] op_sel_hi:[1,0]
    v_pk_mul_f32 v[226:227], v[224:225], v[200:201] op_sel_hi:[1,0]
    v_pk_mul_f32 v[234:235], v[232:233], v[202:203] op_sel_hi:[1,0]
    v_pk_mul_f32 v[242:243], v[240:241], v[204:205] op_sel_hi:[1,0]
    v_pk_fma_f32 v[210:211], v[208:209], v[196:197], v[210:211] op_sel:[1,1,0] op_sel_hi:[0,1,1] neg_lo:[1,0,0]
    v_pk_fma_f32 v[218:219], v[216:217], v[198:199], v[218:219] op_sel:[1,1,0] op_sel_hi:[0,1,1] neg_lo:[1,0,0]
    v_pk_fma_f32 v[226:227], v[224:225], v[200:201], v[226:227] op_sel:[1,1,0] op_sel_hi:[0,1,1] neg_lo:[1,0,0]
    v_pk_fma_f32 v[234:235], v[232:233], v[202:203], v[234:235] op_sel:[1,1,0] op_sel_hi:[0,1,1] neg_lo:[1,0,0]
    v_pk_fma_f32 v[242:243], v[240:241], v[204:205], v[242:243] op_sel:[1,1,0] op_sel_hi:[0,1,1] neg_lo:[1,0,0]
    v_pk_mul_f32 v[212:213], v[210:211], v[196:197] op_sel_hi:[1,0]
    v_pk_mul_f32 v[220:221], v[218:219], v[198:199] op_sel_hi:[1,0]
    v_pk_mul_f32 v[228:229], v[226:227], v[200:201] op_sel_hi:[1,0]
    v_pk_mul_f32 v[236:237], v[234:235], v[202:203] op_sel_hi:[1,0]
    v_pk_mul_f32 v[244:245], v[242:243], v[204:205] op_sel_hi:[1,0]
    v_pk_fma_f32 v[212:213], v[210:211], v[196:197], v[212:213] op_sel:[1,1,0] op_sel_hi:[0,1,1] neg_lo:[1,0,0]
    v_pk_fma_f32 v[220:221], v[218:219], v[198:199], v[220:221] op_sel:[1,1,0] op_sel_hi:[0,1,1] neg_lo:[1,0,0]
    v_pk_fma_f32 v[228:229], v[226:227], v[200:201], v[228:229] op_sel:[1,1,0] op_sel_hi:[0,1,1] neg_lo:[1,0,0]
    v_pk_fma_f32 v[236:237], v[234:235], v[202:203], v[236:237] op_sel:[1,1,0] op_sel_hi:[0,1,1] neg_lo:[1,0,0]
    v_pk_fma_f32 v[244:245], v[242:243], v[204:205], v[244:245] op_sel:[1,1,0] op_sel_hi:[0,1,1] neg_lo:[1,0,0]
    v_cvt_pk_bf16_f32 v80, v206, v208
    v_cvt_pk_bf16_f32 v82, v207, v209
    v_cvt_pk_bf16_f32 v81, v210, v212
    v_cvt_pk_bf16_f32 v83, v211, v213
    v_cvt_pk_bf16_f32 v84, v214, v216
    v_cvt_pk_bf16_f32 v86, v215, v217
    v_cvt_pk_bf16_f32 v85, v218, v220
    v_cvt_pk_bf16_f32 v87, v219, v221
    v_cvt_pk_bf16_f32 v88, v222, v224
    v_cvt_pk_bf16_f32 v90, v223, v225
    v_cvt_pk_bf16_f32 v89, v226, v228
    v_cvt_pk_bf16_f32 v91, v227, v229
    v_cvt_pk_bf16_f32 v92, v230, v232
    v_cvt_pk_bf16_f32 v94, v231, v233
    v_cvt_pk_bf16_f32 v93, v234, v236
    v_cvt_pk_bf16_f32 v95, v235, v237
    v_cvt_pk_bf16_f32 v96, v238, v240
    v_cvt_pk_bf16_f32 v98, v239, v241
    v_cvt_pk_bf16_f32 v97, v242, v244
    v_cvt_pk_bf16_f32 v99, v243, v245
    s_branch kn_w_q
kn_w_p:
    s_sleep 3
kn_w_q:
    buffer_load_dwordx2 v[200:201], v18, s[20:23], 0 offen sc1
    s_sub_u32 s50, s50, 1
    s_cbranch_scc1 kf_fail0
    s_waitcnt vmcnt(0)
    v_cmp_ne_u64 vcc, s[10:11], v[200:201]
    s_cbranch_vccnz kn_w_p
    v_lshlrev_b32_e64 v203, 7, v1
    s_cmp_lt_u32 s2, 224
    s_cbranch_scc1 kn_novt
    s_add_u32 s33, s44, 12288
    buffer_load_dword v200, v203, s[20:23], s33 offen sc1
    s_add_u32 s33, s44, 32768
    buffer_load_dword v201, v203, s[20:23], s33 offen sc1
    s_add_u32 s33, s44, 53248
    buffer_load_dword v202, v203, s[20:23], s33 offen sc1
kn_novt:
    s_cmp_ge_u32 s2, 224
    s_cbranch_scc1 kn_nounit
    s_sub_u32 s13, s2, 160
    s_lshr_b32 s36, s13, 3
    s_and_b32 s37, s13, 7
    s_mul_i32 s13, s37, 160
    s_and_b32 s13, s13, 63
    s_mul_i32 s38, s28, 9216
    s_add_u32 s13, s13, s38
    s_add_u32 s13, s13, 122880
    v_lshrrev_b32 v188, 2, v1
    v_mul_u32_u24 v189, 192, v188
    v_and_b32 v190, 3, v1
    v_add_u32 v189, s13, v189
    v_lshl_add_u32 v180, v190, 4, v189
    v_lshl_add_u32 v181, v190, 3, v189
    v_and_b32_e64 v188, 7, v188
    v_mul_u32_u24 v189, 192, v188
    v_add_u32 v189, s13, v189
    v_lshrrev_b32 v191, 5, v1
    v_lshl_add_u32 v182, v190, 4, v189
    v_lshl_add_u32 v182, v191, 3, v182
    v_lshl_add_u32 v183, v190, 3, v189
    s_mul_i32 s36, s36, 6
    s_mul_i32 s37, s37, 48
    s_add_u32 s36, s36, s37
    s_add_u32 s37, s36, s28
    s_mul_i32 s37, s37, 5120
    s_add_u32 s37, s37, 5242880
    s_lshr_b32 s13, s28, 1
    s_add_u32 s36, s36, s13
    s_add_u32 s36, s36, 4
    s_mul_i32 s36, s36, 5120
    s_add_u32 s36, s36, 5242880
    s_and_b32 s13, s28, 1
    s_lshl_b32 s13, s13, 9
    s_add_u32 s36, s36, s13
    v_and_b32_e64 v187, 31, v1
    v_lshlrev_b32 v187, 4, v187
    v_lshl_add_u32 v185, v191, 10, v187
    v_add_u32 v186, 4096, v10
    v_add_u32 v187, 4096, v187
    ds_read_b64_tr_b16 v[148:149], v180 offset:0
    ds_read_b64_tr_b16 v[150:151], v180 offset:3072
    ds_read_b64_tr_b16 v[152:153], v180 offset:8
    ds_read_b64_tr_b16 v[154:155], v180 offset:3080
    ds_read_b64_tr_b16 v[156:157], v180 offset:64
    ds_read_b64_tr_b16 v[158:159], v180 offset:3136
    ds_read_b64_tr_b16 v[160:161], v180 offset:72
    ds_read_b64_tr_b16 v[162:163], v180 offset:3144
    ds_read_b64_tr_b16 v[164:165], v181 offset:128
    ds_read_b64_tr_b16 v[166:167], v181 offset:3200
    ds_read_b64_tr_b16 v[168:169], v182 offset:6144
    ds_read_b64_tr_b16 v[170:171], v182 offset:7680
    ds_read_b64_tr_b16 v[172:173], v182 offset:6208
    ds_read_b64_tr_b16 v[174:175], v182 offset:7744
    s_waitcnt lgkmcnt(12)
    buffer_store_dwordx4 v[148:151], v10, s[20:23], s37 offen offset:0 sc1
    ds_read_b64_tr_b16 v[176:177], v183 offset:6272
    ds_read_b64_tr_b16 v[178:179], v183 offset:7808
    s_waitcnt lgkmcnt(12)
    buffer_store_dwordx4 v[152:155], v10, s[20:23], s37 offen offset:1024 sc1
    s_waitcnt lgkmcnt(10)
    buffer_store_dwordx4 v[156:159], v10, s[20:23], s37 offen offset:2048 sc1
    s_waitcnt lgkmcnt(8)
    buffer_store_dwordx4 v[160:163], v10, s[20:23], s37 offen offset:3072 sc1
    s_waitcnt lgkmcnt(6)
    buffer_store_dwordx4 v[164:167], v186, s[20:23], s37 offen sc1
    s_waitcnt lgkmcnt(4)
    buffer_store_dwordx4 v[168:171], v185, s[20:23], s36 offen offset:0 sc1
    s_waitcnt lgkmcnt(2)
    buffer_store_dwordx4 v[172:175], v185, s[20:23], s36 offen offset:2048 sc1
    s_waitcnt lgkmcnt(0)
    buffer_store_dwordx4 v[176:179], v187, s[20:23], s36 offen sc1
kn_nounit:
    s_add_u32 s45, s44, 0
    buffer_load_dwordx4 a[0:3], v10, s[20:23], s45 offen offset:0 sc1
    buffer_load_dwordx4 a[4:7], v11, s[20:23], s45 offen offset:0 sc1
    buffer_load_dwordx4 a[8:11], v12, s[20:23], s45 offen offset:0 sc1
    buffer_load_dwordx4 a[12:15], v10, s[20:23], s45 offen offset:1024 sc1
    buffer_load_dwordx4 a[16:19], v11, s[20:23], s45 offen offset:1024 sc1
    buffer_load_dwordx4 a[20:23], v12, s[20:23], s45 offen offset:1024 sc1
    buffer_load_dwordx4 a[24:27], v10, s[20:23], s45 offen offset:2048 sc1
    buffer_load_dwordx4 a[28:31], v11, s[20:23], s45 offen offset:2048 sc1
    buffer_load_dwordx4 a[32:35], v12, s[20:23], s45 offen offset:2048 sc1
    buffer_load_dwordx4 a[36:39], v10, s[20:23], s45 offen offset:3072 sc1
    buffer_load_dwordx4 a[40:43], v11, s[20:23], s45 offen offset:3072 sc1
    buffer_load_dwordx4 a[44:47], v12, s[20:23], s45 offen offset:3072 sc1
    s_add_u32 s45, s44, 4096
    buffer_load_dwordx4 a[48:51], v10, s[20:23], s45 offen offset:0 sc1
    buffer_load_dwordx4 a[52:55], v11, s[20:23], s45 offen offset:0 sc1
    buffer_load_dwordx4 a[56:59], v12, s[20:23], s45 offen offset:0 sc1
    buffer_load_dwordx4 a[60:63], v10, s[20:23], s45 offen offset:1024 sc1
    buffer_load_dwordx4 a[64:67], v11, s[20:23], s45 offen offset:1024 sc1
    buffer_load_dwordx4 a[68:71], v12, s[20:23], s45 offen offset:1024 sc1
    buffer_load_dwordx4 a[72:75], v10, s[20:23], s45 offen offset:2048 sc1
    buffer_load_dwordx4 a[76:79], v11, s[20:23], s45 offen offset:2048 sc1
    buffer_load_dwordx4 a[80:83], v12, s[20:23], s45 offen offset:2048 sc1
    buffer_load_dwordx4 a[84:87], v10, s[20:23], s45 offen offset:3072 sc1
    buffer_load_dwordx4 a[88:91], v11, s[20:23], s45 offen offset:3072 sc1
    buffer_load_dwordx4 a[92:95], v12, s[20:23], s45 offen offset:3072 sc1
    s_add_u32 s45, s44, 8192
    buffer_load_dwordx4 a[96:99], v10, s[20:23], s45 offen offset:0 sc1
    buffer_load_dwordx4 a[100:103], v11, s[20:23], s45 offen offset:0 sc1
    buffer_load_dwordx4 a[104:107], v12, s[20:23], s45 offen offset:0 sc1
    buffer_load_dwordx4 a[108:111], v10, s[20:23], s45 offen offset:1024 sc1
    buffer_load_dwordx4 a[112:115], v11, s[20:23], s45 offen offset:1024 sc1
    buffer_load_dwordx4 a[116:119], v12, s[20:23], s45 offen offset:1024 sc1
    buffer_load_dwordx4 a[120:123], v10, s[20:23], s45 offen offset:2048 sc1
    buffer_load_dwordx4 a[124:127], v11, s[20:23], s45 offen offset:2048 sc1
    buffer_load_dwordx4 a[128:131], v12, s[20:23], s45 offen offset:2048 sc1
    buffer_load_dwordx4 a[132:135], v10, s[20:23], s45 offen offset:3072 sc1
    s_and_b32 s32, s29, 3
    s_lshl_b32 s32, s32, 3
    s_lshr_b32 s38, s29, 2
    s_add_u32 s32, s32, s38
    s_lshl_b32 s32, s32, 7
    s_add_u32 s32, s32, 19136512
    s_lshl_b32 s38, s38, 7
    s_add_u32 s38, s38, 19167232
    v_lshrrev_b32 v206, 2, v1
    v_lshl_add_u32 v206, v206, 12, s32
    v_and_b32 v207, 3, v1
    v_lshl_add_u32 v206, v207, 3, v206
    v_and_b32 v207, 1, v1
    v_lshl_add_u32 v207, v207, 10, s38
    v_cmp_gt_u32 vcc, 20, v1
    s_nop 0
    s_nop 0
    v_cndmask_b32 v206, v207, v206, vcc
    s_sub_u32 s32, s2, 96
    s_lshl_b32 s32, s32, 7
    s_add_u32 s32, s32, 19005440
    v_mov_b32 v207, s32
    v_cmp_gt_u32 vcc, 32, v1
    s_nop 0
    s_nop 0
    v_cndmask_b32 v206, v207, v206, vcc
    buffer_load_dwordx2 v[204:205], v206, s[20:23], 0 offen sc1
    s_waitcnt vmcnt(0)
    s_barrier
    s_cmp_lg_u32 s28, 0
    s_cbranch_scc1 kn2_f
    s_lshl_b32 s32, s2, 7
    s_add_u32 s32, s32, 18972672
    v_mov_b32 v208, s10
    v_mov_b32 v209, s11
    v_mov_b32 v210, 0
    buffer_store_dwordx2 v[208:209], v210, s[20:23], s32 offen sc1
kn2_f:
    v_cmp_ne_u64 vcc, s[10:11], v[204:205]
    s_cbranch_vccz kn_u_ok
    s_branch kn_u_q
kn_u_p:
    s_sleep 6
kn_u_q:
    buffer_load_dwordx2 v[204:205], v206, s[20:23], 0 offen sc1
    s_sub_u32 s50, s50, 1
    s_cbranch_scc1 kf_fail1
    s_waitcnt vmcnt(0)
    v_cmp_ne_u64 vcc, s[10:11], v[204:205]
    s_cbranch_vccnz kn_u_p
kn_u_ok:
    s_branch kf_join
kx_n2:
    s_cmp_lt_u32 s50, 1044480
    s_cselect_b32 s32, s10, 0
    s_cmp_lg_u32 s32, 0
    s_cbranch_scc1 kx_n1
    s_sub_u32 s50, s50, 1
    s_cbranch_scc1 kf_fail2
    v_mov_b32 v250, 0
    global_load_dwordx2 v[250:251], v250, s[62:63] sc1
    s_waitcnt vmcnt(0)
    s_branch kx_n0
kv_n2:
    s_cmp_lt_u32 s50, 1044480
    s_cselect_b32 s32, s10, 0
    s_cmp_lg_u32 s32, 0
    s_cbranch_scc1 kv_n1
    s_sub_u32 s50, s50, 1
    s_cbranch_scc1 kf_fail3
    v_mov_b32 v18, 0
    global_load_dwordx2 v[18:19], v18, s[62:63] sc1
    s_waitcnt vmcnt(0)
    s_branch kv_n0
kc_n2:
    s_cmp_lt_u32 s50, 1044480
    s_cselect_b32 s32, s10, 0
    s_cmp_lg_u32 s32, 0
    s_cbranch_scc1 kc_n1
    s_sub_u32 s50, s50, 1
    s_cbranch_scc1 kf_fail4
    v_mov_b32 v18, 0
    global_load_dwordx2 v[18:19], v18, s[62:63] sc1
    s_waitcnt vmcnt(0)
    s_branch kc_n0
kf_rt_f1:
    buffer_load_dwordx2 v[150:151], v149, s[20:23], 0 offen sc1
    s_sub_u32 s50, s50, 1
    s_cbranch_scc1 kf_fail5
    s_waitcnt vmcnt(0)
    v_cmp_ne_u64 vcc, s[10:11], v[150:151]
    s_cbranch_vccnz kf_rt_f1
    s_branch kf_ok_f1
kf_rt_tf:
    buffer_load_dwordx2 v[6:7], v2, s[20:23], 0 offen sc1
    s_sub_u32 s50, s50, 1
    s_cbranch_scc1 kf_fail6
    s_waitcnt vmcnt(0)
    v_cmp_ne_u64 vcc, s[10:11], v[6:7]
    s_cbranch_vccnz kf_rt_tf
    s_branch kf_ok_tf
kf_rt_wf:
    buffer_load_dwordx2 v[8:9], v18, s[20:23], 0 offen sc1
    s_sub_u32 s50, s50, 1
    s_cbranch_scc1 kf_fail7
    s_waitcnt vmcnt(0)
    v_cmp_ne_u64 vcc, s[10:11], v[8:9]
    s_cbranch_vccnz kf_rt_wf
    s_branch kf_ok_wf
kf_rt_h0:
    s_add_u32 m0, s39, 0
    s_nop 0
    buffer_load_dwordx4 v13, s[20:23], s33 offen offset:0 sc1 lds
    s_add_u32 m0, s39, 0
    s_nop 0
    buffer_load_dwordx4 v13, s[20:23], s33 offen offset:1024 sc1 lds
    s_add_u32 m0, s39, 0
    s_nop 0
    buffer_load_dwordx4 v13, s[20:23], s33 offen offset:2048 sc1 lds
    s_add_u32 m0, s39, 0
    s_nop 0
    buffer_load_dwordx4 v13, s[20:23], s33 offen offset:3072 sc1 lds
    s_sub_u32 s50, s50, 1
    s_cbranch_scc1 kf_fail8
    s_waitcnt vmcnt(0)
    ds_read_b32 v204, v18 offset:0
    ds_read_b32 v205, v18 offset:1024
    ds_read_b32 v206, v18 offset:2048
    ds_read_b32 v207, v18 offset:3072
    s_waitcnt lgkmcnt(0)
    v_bitop3_b32 v2, v204, v205, v206 bitop3:0x80
    v_bitop3_b32 v2, v2, v207, 1 bitop3:0x80
    v_cmp_eq_u32 vcc, 0, v2
    s_cbranch_vccnz kf_rt_h0
    s_branch kf_ok_h0
kf_rt_h1:
    s_add_u32 m0, s39, 16384
    s_nop 0
    buffer_load_dwordx4 v13, s[20:23], s35 offen offset:0 sc1 lds
    s_add_u32 m0, s39, 16384
    s_nop 0
    buffer_load_dwordx4 v13, s[20:23], s35 offen offset:1024 sc1 lds
    s_add_u32 m0, s39, 16384
    s_nop 0
    buffer_load_dwordx4 v13, s[20:23], s35 offen offset:2048 sc1 lds
    s_add_u32 m0, s39, 16384
    s_nop 0
    buffer_load_dwordx4 v13, s[20:23], s35 offen offset:3072 sc1 lds
    s_sub_u32 s50, s50, 1
    s_cbranch_scc1 kf_fail9
    s_waitcnt vmcnt(0)
    ds_read_b32 v204, v18 offset:16384
    ds_read_b32 v205, v18 offset:17408
    ds_read_b32 v206, v18 offset:18432
    ds_read_b32 v207, v18 offset:19456
    s_waitcnt lgkmcnt(0)
    v_bitop3_b32 v2, v204, v205, v206 bitop3:0x80
    v_bitop3_b32 v2, v2, v207, 1 bitop3:0x80
    v_cmp_eq_u32 vcc, 0, v2
    s_cbranch_vccnz kf_rt_h1
    s_branch kf_ok_h1
kf_rt_h2:
    s_add_u32 m0, s39, 32768
    s_nop 0
    buffer_load_dwordx4 v13, s[20:23], s36 offen offset:0 sc1 lds
    s_add_u32 m0, s39, 32768
    s_nop 0
    buffer_load_dwordx4 v13, s[20:23], s36 offen offset:1024 sc1 lds
    s_add_u32 m0, s39, 32768
    s_nop 0
    buffer_load_dwordx4 v13, s[20:23], s36 offen offset:2048 sc1 lds
    s_add_u32 m0, s39, 32768
    s_nop 0
    buffer_load_dwordx4 v13, s[20:23], s36 offen offset:3072 sc1 lds
    s_sub_u32 s50, s50, 1
    s_cbranch_scc1 kf_fail10
    s_waitcnt vmcnt(0)
    ds_read_b32 v204, v18 offset:32768
    ds_read_b32 v205, v18 offset:33792
    ds_read_b32 v206, v18 offset:34816
    ds_read_b32 v207, v18 offset:35840
    s_waitcnt lgkmcnt(0)
    v_bitop3_b32 v2, v204, v205, v206 bitop3:0x80
    v_bitop3_b32 v2, v2, v207, 1 bitop3:0x80
    v_cmp_eq_u32 vcc, 0, v2
    s_cbranch_vccnz kf_rt_h2
    s_branch kf_ok_h2
kf_rt_f2:
    buffer_load_dwordx2 v[226:227], v224, s[20:23], 0 offen sc1
    s_sub_u32 s50, s50, 1
    s_cbranch_scc1 kf_fail11
    s_waitcnt vmcnt(0)
    v_cmp_ne_u64 vcc, s[10:11], v[226:227]
    s_cbranch_vccnz kf_rt_f2
    s_branch kf_ok_f2
kf_rt_h3:
    s_add_u32 m0, s39, 49152
    s_nop 0
    buffer_load_dwordx4 v13, s[20:23], s37 offen offset:0 sc1 lds
    s_add_u32 m0, s39, 49152
    s_nop 0
    buffer_load_dwordx4 v13, s[20:23], s37 offen offset:1024 sc1 lds
    s_add_u32 m0, s39, 49152
    s_nop 0
    buffer_load_dwordx4 v13, s[20:23], s37 offen offset:2048 sc1 lds
    s_add_u32 m0, s39, 49152
    s_nop 0
    buffer_load_dwordx4 v13, s[20:23], s37 offen offset:3072 sc1 lds
    s_sub_u32 s50, s50, 1
    s_cbranch_scc1 kf_fail12
    s_waitcnt vmcnt(0)
    ds_read_b32 v204, v18 offset:49152
    ds_read_b32 v205, v18 offset:50176
    ds_read_b32 v206, v18 offset:51200
    ds_read_b32 v207, v18 offset:52224
    s_waitcnt lgkmcnt(0)
    v_bitop3_b32 v2, v204, v205, v206 bitop3:0x80
    v_bitop3_b32 v2, v2, v207, 1 bitop3:0x80
    v_cmp_eq_u32 vcc, 0, v2
    s_cbranch_vccnz kf_rt_h3
    s_branch kf_ok_h3
kf_rt_h4:
    s_add_u32 m0, s39, 65536
    s_nop 0
    buffer_load_dwordx4 v13, s[20:23], s38 offen offset:0 sc1 lds
    s_add_u32 m0, s39, 65536
    s_nop 0
    buffer_load_dwordx4 v13, s[20:23], s38 offen offset:1024 sc1 lds
    s_add_u32 m0, s39, 65536
    s_nop 0
    buffer_load_dwordx4 v13, s[20:23], s38 offen offset:2048 sc1 lds
    s_add_u32 m0, s39, 65536
    s_nop 0
    buffer_load_dwordx4 v13, s[20:23], s38 offen offset:3072 sc1 lds
    s_sub_u32 s50, s50, 1
    s_cbranch_scc1 kf_fail13
    s_waitcnt vmcnt(0)
    ds_read_b32 v204, v19 offset:0
    ds_read_b32 v205, v19 offset:1024
    ds_read_b32 v206, v19 offset:2048
    ds_read_b32 v207, v19 offset:3072
    s_waitcnt lgkmcnt(0)
    v_bitop3_b32 v2, v204, v205, v206 bitop3:0x80
    v_bitop3_b32 v2, v2, v207, 1 bitop3:0x80
    v_cmp_eq_u32 vcc, 0, v2
    s_cbranch_vccnz kf_rt_h4
    s_branch kf_ok_h4
kf_rt_fa:
    buffer_load_dwordx2 v[200:201], v12, s[20:23], 0 offen sc1
    s_sub_u32 s50, s50, 1
    s_cbranch_scc1 kf_fail14
    s_waitcnt vmcnt(0)
    v_cmp_ne_u64 vcc, s[10:11], v[200:201]
    s_cbranch_vccnz kf_rt_fa
    s_branch kf_ok_fa
kf_rt_gf:
    buffer_load_dwordx2 v[18:19], v11, s[20:23], 0 offen sc1
    s_sub_u32 s50, s50, 1
    s_cbranch_scc1 kf_fail15
    s_waitcnt vmcnt(0)
    v_cmp_ne_u64 vcc, s[10:11], v[18:19]
    s_cbranch_vccnz kf_rt_gf
    s_branch kf_ok_gf
kf_fail0:
    s_movk_i32 s3, 0
    s_branch kf_fail
kf_fail1:
    s_movk_i32 s3, 1
    s_branch kf_fail
kf_fail2:
    s_movk_i32 s3, 2
    s_branch kf_fail
kf_fail3:
    s_movk_i32 s3, 3
    s_branch kf_fail
kf_fail4:
    s_movk_i32 s3, 4
    s_branch kf_fail
kf_fail5:
    s_movk_i32 s3, 5
    s_branch kf_fail
kf_fail6:
    s_movk_i32 s3, 6
    s_branch kf_fail
kf_fail7:
    s_movk_i32 s3, 7
    s_branch kf_fail
kf_fail8:
    s_movk_i32 s3, 8
    s_branch kf_fail
kf_fail9:
    s_movk_i32 s3, 9
    s_branch kf_fail
kf_fail10:
    s_movk_i32 s3, 10
    s_branch kf_fail
kf_fail11:
    s_movk_i32 s3, 11
    s_branch kf_fail
kf_fail12:
    s_movk_i32 s3, 12
    s_branch kf_fail
kf_fail13:
    s_movk_i32 s3, 13
    s_branch kf_fail
kf_fail14:
    s_movk_i32 s3, 14
    s_branch kf_fail
kf_fail15:
    s_movk_i32 s3, 15
    s_branch kf_fail
kf_fail:
    s_lshl_b32 s32, s2, 8
    s_or_b32 s32, s32, s3
    s_or_b32 s32, s32, 0x10000
    v_mov_b32 v2, s32
    s_and_b32 s32, s3, 31
    s_lshl_b32 s32, s32, 2
    s_add_u32 s32, s32, 16
    v_mov_b32 v3, s32
    global_store_dword v3, v2, s[62:63]
kf_last:
    s_endpgm
.section .rodata,"a"
.p2align 6
.amdhsa_kernel sequential_preLN__spectral_gfnet__mixer_channel_mlp__prompt_kernel
  .amdhsa_next_free_vgpr 512
  .amdhsa_next_free_sgpr 102
  .amdhsa_accum_offset 256
  .amdhsa_group_segment_fixed_size 0
  .amdhsa_kernarg_size 88
  .amdhsa_user_sgpr_count 2
  .amdhsa_user_sgpr_kernarg_segment_ptr 1
  .amdhsa_system_sgpr_workgroup_id_x 1
.end_amdhsa_kernel
```
